```python
import torch

def _softmax(x, axis=-1):
    return torch.softmax(x, dim=axis)
def _gelu(x):
    return torch.nn.functional.gelu(x, approximate="tanh")
def _silu(x):
    return torch.nn.functional.silu(x)
def _sigmoid(x):
    return torch.sigmoid(x)
def _layernorm(x, axis=-1, eps=1e-5):
    m = x.mean(dim=axis, keepdim=True)
    v = x.var(dim=axis, keepdim=True, unbiased=False)
    return (x - m) / torch.sqrt(v + eps)
def _scatter_add(tgt, idx, src, axis=0):
    return tgt.clone().index_add_(axis, idx, src)
def _segment_sum(src, seg, n):
    out = torch.zeros((n,) + src.shape[1:], dtype=src.dtype)
    return out.index_add_(0, seg, src)
def _pad(x, pw):
    flat = tuple(v for pair in reversed(pw) for v in pair)
    return torch.nn.functional.pad(x, flat)

kernel_name = 'recurrent_scan__mha_block_cached__swiglu_ffn__prompt'

def setup_inputs():

    _w = (lambda a: (lambda t: t.to(torch.bfloat16) if t.is_floating_point() else t)(torch.as_tensor(a)))
    def _A_setup():
        B, Sq, D = 1, 2048, 512
        H, Sk, Dh = 32, 2048, 128
        return {
            "x": _w((lambda *s: torch.randn(*s, dtype=torch.bfloat16) * 0.05)(B, Sq, D)),
            "k_cache": _w((lambda *s: torch.randn(*s, dtype=torch.bfloat16) * 0.8)(B, H, Sk, Dh)),
            "v_cache": _w((lambda *s: torch.randn(*s, dtype=torch.bfloat16) * 0.2)(B, H, Sk, Dh)),
            "wq": _w((lambda *s: torch.randn(*s, dtype=torch.bfloat16) * 0.8)(D, H * Dh) * (D ** -0.5)),
            "wo": _w((lambda *s: torch.randn(*s, dtype=torch.bfloat16) * 0.2)(H * Dh, D) * ((H * Dh) ** -0.5)),
        }
    _A_in = _A_setup()

    def _B_setup():
        B, S, D, F = 1, 2048, 512, 1792
        return {
            "x": _w((lambda *s: torch.randn(*s, dtype=torch.bfloat16) * 0.05)(B, S, D)),
            "w_gate": _w((lambda *s: torch.randn(*s, dtype=torch.bfloat16) * 0.1)(D, F)),
            "w_up": _w((lambda *s: torch.randn(*s, dtype=torch.bfloat16) * 0.1)(D, F)),
            "w_down": _w((lambda *s: torch.randn(*s, dtype=torch.bfloat16) * 0.1)(F, D)),
        }
    _B_in = _B_setup()

    return {
        "A_x": _A_in["x"],
        "A_k_cache": _A_in["k_cache"],
        "A_v_cache": _A_in["v_cache"],
        "A_wq": _A_in["wq"],
        "A_wo": _A_in["wo"],
        "B_x": _B_in["x"],
        "B_w_gate": _B_in["w_gate"],
        "B_w_up": _B_in["w_up"],
        "B_w_down": _B_in["w_down"],
    }

def reference(A_x, A_k_cache, A_v_cache, A_wq, A_wo, B_x, B_w_gate, B_w_up, B_w_down):
    def _A_ref(x, k_cache, v_cache, wq, wo):
        B, Sq, D = x.shape
        H, Dh = 32, 128
        q = (lambda x, *d: x.permute(*d))((x @ wq).reshape(B, Sq, H, Dh), 0, 2, 1, 3)
        scores = torch.einsum("bhqd,bhkd->bhqk", q, k_cache) * (Dh ** -0.5)
        p = _softmax(scores, axis=-1)
        o = torch.einsum("bhqk,bhkd->bhqd", p, v_cache)
        return (lambda x, *d: x.permute(*d))(o, 0, 2, 1, 3).reshape(B, Sq, H * Dh) @ wo

    def _B_ref(x, w_gate, w_up, w_down):
        g = _silu(x @ w_gate)
        u = x @ w_up
        return (g * u) @ w_down

    x = A_x
    xn = _layernorm(x, axis=-1)
    s = _A_ref(xn, A_k_cache, A_v_cache, A_wq, A_wo)
    g = _silu(_B_ref(xn, B_w_gate, B_w_up, B_w_down))
    return x + s * g
```

```asm
; @launch kernel=ln_kernel grid=(128,1,1) block=(256,1,1) lds=0
; @launch kernel=attn_kernel grid=(256,1,1) block=(256,1,1) lds=131072
.amdgcn_target "amdgcn-amd-amdhsa--gfx950"
.text
.globl ln_kernel
.p2align 8
.type ln_kernel,@function
ln_kernel:

    s_cmp_ge_u32 s2, 128
    s_cbranch_scc1 L_k0_end
    s_load_dwordx2 s[4:5], s[0:1], 0
    s_load_dwordx2 s[6:7], s[0:1], 88
    s_load_dwordx2 s[24:25], s[0:1], 24
    s_load_dwordx4 s[28:31], s[0:1], 48
    v_and_b32 v1, 15, v0
    v_lshrrev_b32 v2, 4, v0
    v_lshrrev_b32 v3, 2, v1
    v_and_b32 v4, 3, v1
    v_lshlrev_b32 v5, 10, v2
    v_lshl_add_u32 v5, v3, 6, v5
    v_lshl_add_u32 v5, v4, 3, v5
    v_lshlrev_b32 v6, 10, v3
    v_lshl_add_u32 v6, v4, 8, v6
    v_lshl_add_u32 v6, v2, 4, v6
    s_lshl_b32 s3, s2, 14
    s_waitcnt lgkmcnt(0)
    s_mov_b32 s8, s4
    s_mov_b32 s9, s5
    s_mov_b32 s10, 2097152
    s_mov_b32 s11, 0x20000
    s_mov_b32 s12, s6
    s_mov_b32 s13, s7
    s_mov_b32 s14, 4194304
    s_mov_b32 s15, 0x20000
    buffer_load_dwordx2 v[16:17], v5, s[8:11], s3 offen offset:0
    buffer_load_dwordx2 v[18:19], v5, s[8:11], s3 offen offset:32
    buffer_load_dwordx2 v[20:21], v5, s[8:11], s3 offen offset:256
    buffer_load_dwordx2 v[22:23], v5, s[8:11], s3 offen offset:288
    buffer_load_dwordx2 v[24:25], v5, s[8:11], s3 offen offset:512
    buffer_load_dwordx2 v[26:27], v5, s[8:11], s3 offen offset:544
    buffer_load_dwordx2 v[28:29], v5, s[8:11], s3 offen offset:768
    buffer_load_dwordx2 v[30:31], v5, s[8:11], s3 offen offset:800
    s_mov_b32 s26, 0x400000
    s_mov_b32 s27, 0x20000
    s_mov_b32 s32, s30
    s_mov_b32 s33, s31
    s_mov_b32 s34, 1835008
    s_mov_b32 s35, 0x20000
    s_mov_b32 s30, 1835008
    s_mov_b32 s31, 0x20000
    v_lshrrev_b32 v7, 6, v0
    v_and_b32 v8, 63, v0
    s_and_b32 s36, s2, 7
    v_readfirstlane_b32 s37, v7
    s_lshr_b32 s38, s2, 3
    s_lshl_b32 s38, s38, 2
    s_add_u32 s38, s38, s37
    v_lshlrev_b32 v9, 4, v8
    s_lshl_b32 s39, s38, 16
    s_lshl_b32 s40, s36, 10
    s_add_u32 s39, s39, s40
    buffer_load_dwordx4 v[96:99], v9, s[24:27], s39 offen
    s_add_u32 s39, s39, 8192
    buffer_load_dwordx4 v[100:103], v9, s[24:27], s39 offen
    s_add_u32 s39, s39, 8192
    buffer_load_dwordx4 v[104:107], v9, s[24:27], s39 offen
    s_add_u32 s39, s39, 8192
    buffer_load_dwordx4 v[108:111], v9, s[24:27], s39 offen
    s_add_u32 s39, s39, 8192
    buffer_load_dwordx4 v[112:115], v9, s[24:27], s39 offen
    s_add_u32 s39, s39, 8192
    buffer_load_dwordx4 v[116:119], v9, s[24:27], s39 offen
    s_add_u32 s39, s39, 8192
    buffer_load_dwordx4 v[120:123], v9, s[24:27], s39 offen
    s_add_u32 s39, s39, 8192
    buffer_load_dwordx4 v[124:127], v9, s[24:27], s39 offen
    s_add_u32 s39, s39, 8192
    v_lshrrev_b32 v10, 5, v8
    v_and_b32 v11, 31, v8
    v_lshlrev_b32 v11, 4, v11
    s_movk_i32 s40, 3584
    v_mul_lo_u32 v10, v10, s40
    v_add_u32 v10, v10, v11
    s_mul_i32 s39, s38, 28672
    s_lshl_b32 s40, s36, 9
    s_add_u32 s39, s39, s40
    buffer_load_dwordx4 v[128:131], v10, s[28:31], s39 offen
    buffer_load_dwordx4 v[132:135], v10, s[32:35], s39 offen
    s_add_u32 s39, s39, 7168
    buffer_load_dwordx4 v[136:139], v10, s[28:31], s39 offen
    buffer_load_dwordx4 v[140:143], v10, s[32:35], s39 offen
    s_add_u32 s39, s39, 7168
    buffer_load_dwordx4 v[144:147], v10, s[28:31], s39 offen
    buffer_load_dwordx4 v[148:151], v10, s[32:35], s39 offen
    s_add_u32 s39, s39, 7168
    buffer_load_dwordx4 v[152:155], v10, s[28:31], s39 offen
    buffer_load_dwordx4 v[156:159], v10, s[32:35], s39 offen
    s_add_u32 s39, s39, 7168
    s_getpc_b64 s[58:59]
L_k0_pc:
    s_add_u32 s58, s58, attn_kernel-L_k0_pc
    s_addc_u32 s59, s59, 0
    s_lshl_b32 s60, s38, 10
    v_add_u32 v15, s60, v9
    s_mov_b32 s60, L_k1_codeend-attn_kernel-16
    v_min_u32 v15, s60, v15
    global_load_dwordx4 v[200:203], v15, s[58:59]
    s_add_u32 s44, s6, 0x3C00000
    s_addc_u32 s45, s7, 0
    s_mov_b32 s46, 9216
    s_mov_b32 s47, 0x20000
    s_lshl_b32 s41, s2, 7
    v_lshlrev_b32 v12, 2, v0
    v_mov_b32 v13, 0
    v_mov_b32 v14, 0x7fffffff
    v_cmp_gt_u32 vcc, 32, v0
    s_nop 1
    v_cndmask_b32 v12, v14, v12, vcc
    buffer_store_dword v13, v12, s[44:47], s41 offen
    s_mov_b32 s20, 0xffff0000
    s_waitcnt vmcnt(24)
    v_lshlrev_b32 v32, 16, v16
    v_and_b32 v33, s20, v16
    v_lshlrev_b32 v34, 16, v17
    v_and_b32 v35, s20, v17
    v_lshlrev_b32 v36, 16, v18
    v_and_b32 v37, s20, v18
    v_lshlrev_b32 v38, 16, v19
    v_and_b32 v39, s20, v19
    s_waitcnt vmcnt(22)
    v_lshlrev_b32 v40, 16, v20
    v_and_b32 v41, s20, v20
    v_lshlrev_b32 v42, 16, v21
    v_and_b32 v43, s20, v21
    v_lshlrev_b32 v44, 16, v22
    v_and_b32 v45, s20, v22
    v_lshlrev_b32 v46, 16, v23
    v_and_b32 v47, s20, v23
    s_waitcnt vmcnt(20)
    v_lshlrev_b32 v48, 16, v24
    v_and_b32 v49, s20, v24
    v_lshlrev_b32 v50, 16, v25
    v_and_b32 v51, s20, v25
    v_lshlrev_b32 v52, 16, v26
    v_and_b32 v53, s20, v26
    v_lshlrev_b32 v54, 16, v27
    v_and_b32 v55, s20, v27
    s_waitcnt vmcnt(18)
    v_lshlrev_b32 v56, 16, v28
    v_and_b32 v57, s20, v28
    v_lshlrev_b32 v58, 16, v29
    v_and_b32 v59, s20, v29
    v_lshlrev_b32 v60, 16, v30
    v_and_b32 v61, s20, v30
    v_lshlrev_b32 v62, 16, v31
    v_and_b32 v63, s20, v31
    v_add_f32 v8, v32, v33
    v_add_f32 v9, v34, v35
    v_add_f32 v8, v8, v36
    v_add_f32 v9, v9, v37
    v_add_f32 v8, v8, v38
    v_add_f32 v9, v9, v39
    v_add_f32 v8, v8, v40
    v_add_f32 v9, v9, v41
    v_add_f32 v8, v8, v42
    v_add_f32 v9, v9, v43
    v_add_f32 v8, v8, v44
    v_add_f32 v9, v9, v45
    v_add_f32 v8, v8, v46
    v_add_f32 v9, v9, v47
    v_add_f32 v8, v8, v48
    v_add_f32 v9, v9, v49
    v_add_f32 v8, v8, v50
    v_add_f32 v9, v9, v51
    v_add_f32 v8, v8, v52
    v_add_f32 v9, v9, v53
    v_add_f32 v8, v8, v54
    v_add_f32 v9, v9, v55
    v_add_f32 v8, v8, v56
    v_add_f32 v9, v9, v57
    v_add_f32 v8, v8, v58
    v_add_f32 v9, v9, v59
    v_add_f32 v8, v8, v60
    v_add_f32 v9, v9, v61
    v_add_f32 v8, v8, v62
    v_add_f32 v9, v9, v63
    v_add_f32 v8, v8, v9
    s_nop 1
    v_add_f32_dpp v9, v8, v8 row_ror:8 row_mask:0xf bank_mask:0xf
    s_nop 1
    v_add_f32_dpp v8, v9, v9 row_ror:4 row_mask:0xf bank_mask:0xf
    s_nop 1
    v_add_f32_dpp v9, v8, v8 row_ror:2 row_mask:0xf bank_mask:0xf
    s_nop 1
    v_add_f32_dpp v8, v9, v9 row_ror:1 row_mask:0xf bank_mask:0xf
    v_mul_f32 v8, 0x3b000000, v8
    v_sub_f32 v10, v32, v8
    v_mul_f32 v11, v10, v10
    v_sub_f32 v10, v33, v8
    v_mul_f32 v12, v10, v10
    v_sub_f32 v10, v34, v8
    v_sub_f32 v13, v35, v8
    v_fmac_f32 v11, v10, v10
    v_fmac_f32 v12, v13, v13
    v_sub_f32 v10, v36, v8
    v_sub_f32 v13, v37, v8
    v_fmac_f32 v11, v10, v10
    v_fmac_f32 v12, v13, v13
    v_sub_f32 v10, v38, v8
    v_sub_f32 v13, v39, v8
    v_fmac_f32 v11, v10, v10
    v_fmac_f32 v12, v13, v13
    v_sub_f32 v10, v40, v8
    v_sub_f32 v13, v41, v8
    v_fmac_f32 v11, v10, v10
    v_fmac_f32 v12, v13, v13
    v_sub_f32 v10, v42, v8
    v_sub_f32 v13, v43, v8
    v_fmac_f32 v11, v10, v10
    v_fmac_f32 v12, v13, v13
    v_sub_f32 v10, v44, v8
    v_sub_f32 v13, v45, v8
    v_fmac_f32 v11, v10, v10
    v_fmac_f32 v12, v13, v13
    v_sub_f32 v10, v46, v8
    v_sub_f32 v13, v47, v8
    v_fmac_f32 v11, v10, v10
    v_fmac_f32 v12, v13, v13
    v_sub_f32 v10, v48, v8
    v_sub_f32 v13, v49, v8
    v_fmac_f32 v11, v10, v10
    v_fmac_f32 v12, v13, v13
    v_sub_f32 v10, v50, v8
    v_sub_f32 v13, v51, v8
    v_fmac_f32 v11, v10, v10
    v_fmac_f32 v12, v13, v13
    v_sub_f32 v10, v52, v8
    v_sub_f32 v13, v53, v8
    v_fmac_f32 v11, v10, v10
    v_fmac_f32 v12, v13, v13
    v_sub_f32 v10, v54, v8
    v_sub_f32 v13, v55, v8
    v_fmac_f32 v11, v10, v10
    v_fmac_f32 v12, v13, v13
    v_sub_f32 v10, v56, v8
    v_sub_f32 v13, v57, v8
    v_fmac_f32 v11, v10, v10
    v_fmac_f32 v12, v13, v13
    v_sub_f32 v10, v58, v8
    v_sub_f32 v13, v59, v8
    v_fmac_f32 v11, v10, v10
    v_fmac_f32 v12, v13, v13
    v_sub_f32 v10, v60, v8
    v_sub_f32 v13, v61, v8
    v_fmac_f32 v11, v10, v10
    v_fmac_f32 v12, v13, v13
    v_sub_f32 v10, v62, v8
    v_sub_f32 v13, v63, v8
    v_fmac_f32 v11, v10, v10
    v_fmac_f32 v12, v13, v13
    v_add_f32 v11, v11, v12
    s_nop 1
    v_add_f32_dpp v12, v11, v11 row_ror:8 row_mask:0xf bank_mask:0xf
    s_nop 1
    v_add_f32_dpp v11, v12, v12 row_ror:4 row_mask:0xf bank_mask:0xf
    s_nop 1
    v_add_f32_dpp v12, v11, v11 row_ror:2 row_mask:0xf bank_mask:0xf
    s_nop 1
    v_add_f32_dpp v11, v12, v12 row_ror:1 row_mask:0xf bank_mask:0xf
    v_mul_f32 v11, 0x3b000000, v11
    v_cvt_pk_bf16_f32 v12, v8, v11
    s_nop 0
    v_lshlrev_b32 v8, 16, v12
    v_and_b32 v11, s20, v12
    v_add_f32 v11, 0x3727c5ac, v11
    v_cvt_pk_bf16_f32 v12, v11, v11
    s_nop 0
    v_and_b32 v11, s20, v12
    v_sqrt_f32 v11, v11
    s_nop 0
    v_cvt_pk_bf16_f32 v12, v11, v11
    s_nop 0
    v_and_b32 v11, s20, v12
    v_rcp_f32 v11, v11
    s_nop 0
    v_mul_f32 v12, 0x3e0293ee, v11
    v_sub_f32 v32, v32, v8
    v_sub_f32 v33, v33, v8
    v_cvt_pk_bf16_f32 v13, v32, v33
    s_nop 0
    v_lshlrev_b32 v32, 16, v13
    v_and_b32 v33, s20, v13
    v_sub_f32 v34, v34, v8
    v_sub_f32 v35, v35, v8
    v_cvt_pk_bf16_f32 v13, v34, v35
    s_nop 0
    v_lshlrev_b32 v34, 16, v13
    v_and_b32 v35, s20, v13
    v_sub_f32 v36, v36, v8
    v_sub_f32 v37, v37, v8
    v_cvt_pk_bf16_f32 v13, v36, v37
    s_nop 0
    v_lshlrev_b32 v36, 16, v13
    v_and_b32 v37, s20, v13
    v_sub_f32 v38, v38, v8
    v_sub_f32 v39, v39, v8
    v_cvt_pk_bf16_f32 v13, v38, v39
    s_nop 0
    v_lshlrev_b32 v38, 16, v13
    v_and_b32 v39, s20, v13
    v_sub_f32 v40, v40, v8
    v_sub_f32 v41, v41, v8
    v_cvt_pk_bf16_f32 v13, v40, v41
    s_nop 0
    v_lshlrev_b32 v40, 16, v13
    v_and_b32 v41, s20, v13
    v_sub_f32 v42, v42, v8
    v_sub_f32 v43, v43, v8
    v_cvt_pk_bf16_f32 v13, v42, v43
    s_nop 0
    v_lshlrev_b32 v42, 16, v13
    v_and_b32 v43, s20, v13
    v_sub_f32 v44, v44, v8
    v_sub_f32 v45, v45, v8
    v_cvt_pk_bf16_f32 v13, v44, v45
    s_nop 0
    v_lshlrev_b32 v44, 16, v13
    v_and_b32 v45, s20, v13
    v_sub_f32 v46, v46, v8
    v_sub_f32 v47, v47, v8
    v_cvt_pk_bf16_f32 v13, v46, v47
    s_nop 0
    v_lshlrev_b32 v46, 16, v13
    v_and_b32 v47, s20, v13
    v_sub_f32 v48, v48, v8
    v_sub_f32 v49, v49, v8
    v_cvt_pk_bf16_f32 v13, v48, v49
    s_nop 0
    v_lshlrev_b32 v48, 16, v13
    v_and_b32 v49, s20, v13
    v_sub_f32 v50, v50, v8
    v_sub_f32 v51, v51, v8
    v_cvt_pk_bf16_f32 v13, v50, v51
    s_nop 0
    v_lshlrev_b32 v50, 16, v13
    v_and_b32 v51, s20, v13
    v_sub_f32 v52, v52, v8
    v_sub_f32 v53, v53, v8
    v_cvt_pk_bf16_f32 v13, v52, v53
    s_nop 0
    v_lshlrev_b32 v52, 16, v13
    v_and_b32 v53, s20, v13
    v_sub_f32 v54, v54, v8
    v_sub_f32 v55, v55, v8
    v_cvt_pk_bf16_f32 v13, v54, v55
    s_nop 0
    v_lshlrev_b32 v54, 16, v13
    v_and_b32 v55, s20, v13
    v_sub_f32 v56, v56, v8
    v_sub_f32 v57, v57, v8
    v_cvt_pk_bf16_f32 v13, v56, v57
    s_nop 0
    v_lshlrev_b32 v56, 16, v13
    v_and_b32 v57, s20, v13
    v_sub_f32 v58, v58, v8
    v_sub_f32 v59, v59, v8
    v_cvt_pk_bf16_f32 v13, v58, v59
    s_nop 0
    v_lshlrev_b32 v58, 16, v13
    v_and_b32 v59, s20, v13
    v_sub_f32 v60, v60, v8
    v_sub_f32 v61, v61, v8
    v_cvt_pk_bf16_f32 v13, v60, v61
    s_nop 0
    v_lshlrev_b32 v60, 16, v13
    v_and_b32 v61, s20, v13
    v_sub_f32 v62, v62, v8
    v_sub_f32 v63, v63, v8
    v_cvt_pk_bf16_f32 v13, v62, v63
    s_nop 0
    v_lshlrev_b32 v62, 16, v13
    v_and_b32 v63, s20, v13
    v_mul_f32 v13, v32, v12
    v_mul_f32 v14, v33, v12
    v_cvt_pk_bf16_f32 v64, v13, v14
    v_mul_f32 v13, v34, v12
    v_mul_f32 v14, v35, v12
    v_cvt_pk_bf16_f32 v65, v13, v14
    v_mul_f32 v13, v36, v12
    v_mul_f32 v14, v37, v12
    v_cvt_pk_bf16_f32 v66, v13, v14
    v_mul_f32 v13, v38, v12
    v_mul_f32 v14, v39, v12
    v_cvt_pk_bf16_f32 v67, v13, v14
    v_mul_f32 v13, v40, v12
    v_mul_f32 v14, v41, v12
    v_cvt_pk_bf16_f32 v68, v13, v14
    v_mul_f32 v13, v42, v12
    v_mul_f32 v14, v43, v12
    v_cvt_pk_bf16_f32 v69, v13, v14
    v_mul_f32 v13, v44, v12
    v_mul_f32 v14, v45, v12
    v_cvt_pk_bf16_f32 v70, v13, v14
    v_mul_f32 v13, v46, v12
    v_mul_f32 v14, v47, v12
    v_cvt_pk_bf16_f32 v71, v13, v14
    v_mul_f32 v13, v48, v12
    v_mul_f32 v14, v49, v12
    v_cvt_pk_bf16_f32 v72, v13, v14
    v_mul_f32 v13, v50, v12
    v_mul_f32 v14, v51, v12
    v_cvt_pk_bf16_f32 v73, v13, v14
    v_mul_f32 v13, v52, v12
    v_mul_f32 v14, v53, v12
    v_cvt_pk_bf16_f32 v74, v13, v14
    v_mul_f32 v13, v54, v12
    v_mul_f32 v14, v55, v12
    v_cvt_pk_bf16_f32 v75, v13, v14
    v_mul_f32 v13, v56, v12
    v_mul_f32 v14, v57, v12
    v_cvt_pk_bf16_f32 v76, v13, v14
    v_mul_f32 v13, v58, v12
    v_mul_f32 v14, v59, v12
    v_cvt_pk_bf16_f32 v77, v13, v14
    v_mul_f32 v13, v60, v12
    v_mul_f32 v14, v61, v12
    v_cvt_pk_bf16_f32 v78, v13, v14
    v_mul_f32 v13, v62, v12
    v_mul_f32 v14, v63, v12
    v_cvt_pk_bf16_f32 v79, v13, v14
    s_add_u32 s4, s3, 0x200000
    s_nop 0
    s_add_u32 s21, s3, 0
    buffer_store_dwordx4 v[64:67], v6, s[12:15], s21 offen
    s_add_u32 s21, s3, 4096
    buffer_store_dwordx4 v[68:71], v6, s[12:15], s21 offen
    s_add_u32 s21, s3, 8192
    buffer_store_dwordx4 v[72:75], v6, s[12:15], s21 offen
    s_add_u32 s21, s3, 12288
    buffer_store_dwordx4 v[76:79], v6, s[12:15], s21 offen
L_k0_end:
    s_endpgm

.text
.globl attn_kernel
.p2align 8
.type attn_kernel,@function
attn_kernel:

    s_cmp_ge_u32 s2, 256
    s_cbranch_scc1 L_k1_end
    s_load_dwordx2 s[28:29], s[0:1], 88
    s_load_dwordx4 s[20:23], s[0:1], 48
    s_load_dwordx4 s[8:11], s[0:1], 8
    s_load_dwordx2 s[16:17], s[0:1], 24
    s_load_dwordx2 s[94:95], s[0:1], 32
    s_load_dwordx2 s[96:97], s[0:1], 64
    v_lshrrev_b32 v1, 6, v0
    v_and_b32 v2, 63, v0
    s_and_b32 s50, s2, 7
    v_readfirstlane_b32 s3, v1
    s_lshr_b32 s51, s2, 3
    s_lshr_b32 s52, s51, 3
    s_lshl_b32 s4, s50, 2
    s_add_u32 s4, s4, s52
    s_and_b32 s5, s51, 7
    s_min_u32 s6, s4, 27
    v_and_b32 v3, 15, v2
    v_lshrrev_b32 v4, 4, v2
    v_lshlrev_b32 v54, 4, v2
    v_mov_b32 v53, v54
    s_lshl_b32 s44, s3, 12
    s_lshl_b32 s45, s3, 11
    v_lshrrev_b32 v5, 3, v2
    s_lshl_b32 s50, s3, 4
    v_add_u32 v5, s50, v5
    s_movk_i32 s51, 3584
    v_mul_lo_u32 v5, v5, s51
    v_and_b32 v6, 7, v2
    v_lshlrev_b32 v7, 1, v4
    v_xor_b32 v6, v6, v7
    v_lshl_add_u32 v52, v6, 4, v5
    s_lshl_b32 s50, s5, 4
    s_lshl_b32 s51, s3, 2
    s_add_u32 s49, s50, s51
    s_add_u32 s51, s49, 0
    s_lshl_b32 s40, s51, 14
    s_add_u32 s51, s49, 1
    s_lshl_b32 s41, s51, 14
    s_add_u32 s51, s49, 2
    s_lshl_b32 s42, s51, 14
    s_add_u32 s51, s49, 3
    s_lshl_b32 s43, s51, 14
    s_lshl_b32 s50, s3, 17
    v_add_u32 v5, 0, v4
    v_lshlrev_b32 v5, 1, v5
    v_xor_b32 v5, v5, v3
    v_lshlrev_b32 v5, 4, v5
    v_lshl_add_u32 v6, v4, 13, v5
    v_add_u32 v50, s50, v6
    v_add_u32 v5, 4, v4
    v_lshlrev_b32 v5, 1, v5
    v_xor_b32 v5, v5, v3
    v_lshlrev_b32 v5, 4, v5
    v_lshl_add_u32 v6, v4, 13, v5
    v_add_u32 v51, s50, v6
    s_lshl_b32 s52, s4, 8
    s_lshl_b32 s51, s6, 7
    s_waitcnt lgkmcnt(0)
    s_add_u32 s16, s16, s52
    s_addc_u32 s17, s17, 0
    s_sub_u32 s18, 0x400000, s52
    s_mov_b32 s19, 0x20000
    s_add_u32 s24, s22, s51
    s_addc_u32 s25, s23, 0
    s_sub_u32 s26, 1835008, s51
    s_mov_b32 s27, 0x20000
    s_add_u32 s20, s20, s51
    s_addc_u32 s21, s21, 0
    s_sub_u32 s22, 1835008, s51
    s_mov_b32 s23, 0x20000
    s_mov_b32 s30, 0x200000
    s_mov_b32 s31, 0x20000
    s_add_u32 m0, s45, 0
    s_mov_b32 s50, 0
    buffer_load_dwordx4 v52, s[20:23], s50 offen offset:0 lds
    s_mov_b32 s51, 27648
    buffer_load_dwordx4 v52, s[20:23], s51 offen offset:1024 lds
    s_add_u32 m0, s45, 8192
    s_mov_b32 s50, 0
    buffer_load_dwordx4 v52, s[24:27], s50 offen offset:0 lds
    s_mov_b32 s51, 27648
    buffer_load_dwordx4 v52, s[24:27], s51 offen offset:1024 lds
    buffer_load_dwordx4 a[128:131], v53, s[28:31], s40 offen offset:0
    buffer_load_dwordx4 a[136:139], v53, s[28:31], s41 offen offset:0
    buffer_load_dwordx4 a[144:147], v53, s[28:31], s42 offen offset:0
    buffer_load_dwordx4 a[152:155], v53, s[28:31], s43 offen offset:0
    s_add_u32 m0, s44, 16384
    s_mov_b32 s50, 0
    buffer_load_dwordx4 v50, s[16:19], s50 offen offset:0 lds
    s_mov_b32 s51, 31744
    buffer_load_dwordx4 v51, s[16:19], s51 offen offset:1024 lds
    s_mov_b32 s50, 63488
    buffer_load_dwordx4 v50, s[16:19], s50 offen offset:2048 lds
    s_mov_b32 s51, 95232
    buffer_load_dwordx4 v51, s[16:19], s51 offen offset:3072 lds
    buffer_load_dwordx4 a[132:135], v53, s[28:31], s40 offen offset:1024
    buffer_load_dwordx4 a[140:143], v53, s[28:31], s41 offen offset:1024
    buffer_load_dwordx4 a[148:151], v53, s[28:31], s42 offen offset:1024
    buffer_load_dwordx4 a[156:159], v53, s[28:31], s43 offen offset:1024
    v_add_u32 v53, 2048, v53
    s_add_u32 m0, s45, 32768
    s_mov_b32 s50, 229376
    buffer_load_dwordx4 v52, s[20:23], s50 offen offset:0 lds
    s_mov_b32 s51, 257024
    buffer_load_dwordx4 v52, s[20:23], s51 offen offset:1024 lds
    s_add_u32 m0, s45, 40960
    s_mov_b32 s50, 229376
    buffer_load_dwordx4 v52, s[24:27], s50 offen offset:0 lds
    s_mov_b32 s51, 257024
    buffer_load_dwordx4 v52, s[24:27], s51 offen offset:1024 lds
    buffer_load_dwordx4 a[160:163], v53, s[28:31], s40 offen offset:0
    buffer_load_dwordx4 a[168:171], v53, s[28:31], s41 offen offset:0
    buffer_load_dwordx4 a[176:179], v53, s[28:31], s42 offen offset:0
    buffer_load_dwordx4 a[184:187], v53, s[28:31], s43 offen offset:0
    s_add_u32 m0, s44, 49152
    s_mov_b32 s50, 524288
    buffer_load_dwordx4 v50, s[16:19], s50 offen offset:0 lds
    s_mov_b32 s51, 556032
    buffer_load_dwordx4 v51, s[16:19], s51 offen offset:1024 lds
    s_mov_b32 s50, 587776
    buffer_load_dwordx4 v50, s[16:19], s50 offen offset:2048 lds
    s_mov_b32 s51, 619520
    buffer_load_dwordx4 v51, s[16:19], s51 offen offset:3072 lds
    buffer_load_dwordx4 a[164:167], v53, s[28:31], s40 offen offset:1024
    buffer_load_dwordx4 a[172:175], v53, s[28:31], s41 offen offset:1024
    buffer_load_dwordx4 a[180:183], v53, s[28:31], s42 offen offset:1024
    buffer_load_dwordx4 a[188:191], v53, s[28:31], s43 offen offset:1024
    v_add_u32 v5, 0, v4
    v_xor_b32 v5, v5, v3
    v_lshlrev_b32 v5, 4, v5
    v_lshl_add_u32 v40, v3, 8, v5
    v_add_u32 v5, 4, v4
    v_xor_b32 v5, v5, v3
    v_lshlrev_b32 v5, 4, v5
    v_lshl_add_u32 v41, v3, 8, v5
    v_add_u32 v5, 8, v4
    v_xor_b32 v5, v5, v3
    v_lshlrev_b32 v5, 4, v5
    v_lshl_add_u32 v42, v3, 8, v5
    v_add_u32 v5, 12, v4
    v_xor_b32 v5, v5, v3
    v_lshlrev_b32 v5, 4, v5
    v_lshl_add_u32 v43, v3, 8, v5
    v_lshrrev_b32 v5, 2, v3
    v_and_b32 v6, 3, v3
    v_lshl_add_u32 v7, v4, 2, v5
    v_and_b32 v8, 7, v7
    v_lshlrev_b32 v8, 1, v8
    v_lshrrev_b32 v9, 1, v6
    v_and_b32 v10, 1, v6
    v_lshlrev_b32 v10, 3, v10
    v_lshl_add_u32 v10, v7, 8, v10
    v_add_u32 v11, 0, v9
    v_xor_b32 v11, v11, v8
    v_lshl_add_u32 v24, v11, 4, v10
    v_add_u32 v16, 0x10000, v24
    v_add_u32 v11, 2, v9
    v_xor_b32 v11, v11, v8
    v_lshl_add_u32 v25, v11, 4, v10
    v_add_u32 v17, 0x10000, v25
    v_add_u32 v11, 4, v9
    v_xor_b32 v11, v11, v8
    v_lshl_add_u32 v26, v11, 4, v10
    v_add_u32 v18, 0x10000, v26
    v_add_u32 v11, 6, v9
    v_xor_b32 v11, v11, v8
    v_lshl_add_u32 v27, v11, 4, v10
    v_add_u32 v19, 0x10000, v27
    v_add_u32 v11, 8, v9
    v_xor_b32 v11, v11, v8
    v_lshl_add_u32 v28, v11, 4, v10
    v_add_u32 v20, 0x10000, v28
    v_add_u32 v11, 10, v9
    v_xor_b32 v11, v11, v8
    v_lshl_add_u32 v29, v11, 4, v10
    v_add_u32 v21, 0x10000, v29
    v_add_u32 v11, 12, v9
    v_xor_b32 v11, v11, v8
    v_lshl_add_u32 v30, v11, 4, v10
    v_add_u32 v22, 0x10000, v30
    v_add_u32 v11, 14, v9
    v_xor_b32 v11, v11, v8
    v_lshl_add_u32 v31, v11, 4, v10
    v_add_u32 v23, 0x10000, v31
    v_lshrrev_b32 v8, 1, v7
    v_and_b32 v8, 3, v8
    v_lshlrev_b32 v8, 1, v8
    v_and_b32 v10, 1, v6
    v_lshlrev_b32 v10, 3, v10
    v_lshl_add_u32 v10, v7, 7, v10
    v_add_u32 v11, 0, v9
    v_xor_b32 v11, v11, v8
    v_lshl_add_u32 v32, v11, 4, v10
    v_add_u32 v36, 0x10000, v32
    v_add_u32 v11, 2, v9
    v_xor_b32 v11, v11, v8
    v_lshl_add_u32 v33, v11, 4, v10
    v_add_u32 v37, 0x10000, v33
    v_add_u32 v11, 4, v9
    v_xor_b32 v11, v11, v8
    v_lshl_add_u32 v34, v11, 4, v10
    v_add_u32 v38, 0x10000, v34
    v_add_u32 v11, 6, v9
    v_xor_b32 v11, v11, v8
    v_lshl_add_u32 v35, v11, 4, v10
    v_add_u32 v39, 0x10000, v35
    v_add_u32 v5, 0, v4
    v_xor_b32 v5, v5, v3
    v_lshlrev_b32 v5, 4, v5
    v_lshl_add_u32 v5, v4, 8, v5
    v_add_u32 v44, s44, v5
    v_add_u32 v5, 4, v4
    v_xor_b32 v5, v5, v3
    v_lshlrev_b32 v5, 4, v5
    v_lshl_add_u32 v5, v4, 8, v5
    v_add_u32 v45, s44, v5
    v_add_u32 v5, 8, v4
    v_xor_b32 v5, v5, v3
    v_lshlrev_b32 v5, 4, v5
    v_lshl_add_u32 v5, v4, 8, v5
    v_add_u32 v46, s44, v5
    v_add_u32 v5, 12, v4
    v_xor_b32 v5, v5, v3
    v_lshlrev_b32 v5, 4, v5
    v_lshl_add_u32 v5, v4, 8, v5
    v_add_u32 v47, s44, v5
    v_add_u32 v5, 0, v4
    v_lshlrev_b32 v5, 1, v5
    v_xor_b32 v5, v5, v3
    v_lshlrev_b32 v5, 4, v5
    v_lshl_add_u32 v6, v4, 8, v5
    v_add_u32 v48, s44, v6
    v_add_u32 v5, 4, v4
    v_lshlrev_b32 v5, 1, v5
    v_xor_b32 v5, v5, v3
    v_lshlrev_b32 v5, 4, v5
    v_lshl_add_u32 v6, v4, 8, v5
    v_add_u32 v49, s44, v6
    s_add_u32 s51, s49, 0
    s_mul_i32 s54, s51, 57344
    s_lshl_b32 s58, s51, 17
    s_add_u32 s51, s49, 1
    s_mul_i32 s55, s51, 57344
    s_lshl_b32 s59, s51, 17
    s_add_u32 s51, s49, 2
    s_mul_i32 s56, s51, 57344
    s_lshl_b32 s60, s51, 17
    s_add_u32 s51, s49, 3
    s_mul_i32 s57, s51, 57344
    s_lshl_b32 s61, s51, 17
    s_mov_b32 s64, 0xffff0000
    s_lshl_b32 s50, s4, 19
    s_add_u32 s12, s10, s50
    s_addc_u32 s13, s11, 0
    s_mov_b32 s14, 0x80000
    s_mov_b32 s15, 0x20000
    s_add_u32 s8, s8, s50
    s_addc_u32 s9, s9, 0
    s_mov_b32 s10, 0x80000
    s_mov_b32 s11, 0x20000
    s_lshl_b32 s51, s6, 11
    s_add_u32 s54, s54, s51
    s_add_u32 s55, s55, s51
    s_add_u32 s56, s56, s51
    s_add_u32 s57, s57, s51
    s_lshl_b32 s51, s4, 12
    s_add_u32 s58, s58, s51
    s_add_u32 s59, s59, s51
    s_add_u32 s60, s60, s51
    s_add_u32 s61, s61, s51
    s_add_u32 s32, s28, 4194304
    s_addc_u32 s33, s29, 0
    s_mov_b32 s34, 7340032
    s_cmp_lt_u32 s4, 28
    s_cselect_b32 s34, s34, 0
    s_mov_b32 s35, 0x20000
    s_add_u32 s36, s28, 16777216
    s_addc_u32 s37, s29, 0
    s_mov_b32 s38, 16777216
    s_mov_b32 s39, 0x20000
    s_waitcnt vmcnt(20)
    s_barrier
    ds_read_b64_tr_b16 v[64:65], v32 offset:0
    ds_read_b64_tr_b16 v[66:67], v32 offset:2048
    ds_read_b64_tr_b16 v[68:69], v33 offset:0
    ds_read_b64_tr_b16 v[70:71], v33 offset:2048
    ds_read_b64_tr_b16 v[72:73], v34 offset:0
    ds_read_b64_tr_b16 v[74:75], v34 offset:2048
    ds_read_b64_tr_b16 v[76:77], v35 offset:0
    ds_read_b64_tr_b16 v[78:79], v35 offset:2048
    ds_read_b64_tr_b16 v[80:81], v32 offset:8192
    ds_read_b64_tr_b16 v[82:83], v32 offset:10240
    ds_read_b64_tr_b16 v[84:85], v33 offset:8192
    ds_read_b64_tr_b16 v[86:87], v33 offset:10240
    ds_read_b64_tr_b16 v[88:89], v34 offset:8192
    ds_read_b64_tr_b16 v[90:91], v34 offset:10240
    ds_read_b64_tr_b16 v[92:93], v35 offset:8192
    ds_read_b64_tr_b16 v[94:95], v35 offset:10240
    s_waitcnt vmcnt(16) lgkmcnt(0)
    v_mfma_f32_16x16x32_bf16 a[0:3], v[64:67], a[128:131], 0
    ds_read_b64_tr_b16 v[96:97], v24 offset:16384
    v_mfma_f32_16x16x32_bf16 a[4:7], v[64:67], a[136:139], 0
    ds_read_b64_tr_b16 v[98:99], v24 offset:20480
    v_mfma_f32_16x16x32_bf16 a[8:11], v[64:67], a[144:147], 0
    s_add_u32 m0, s45, 65536
    s_mov_b32 s50, 458752
    buffer_load_dwordx4 v52, s[20:23], s50 offen offset:0 lds
    v_mfma_f32_16x16x32_bf16 a[12:15], v[64:67], a[152:155], 0
    ds_read_b64_tr_b16 v[100:101], v25 offset:16384
    v_mfma_f32_16x16x32_bf16 a[16:19], v[68:71], a[128:131], 0
    ds_read_b64_tr_b16 v[102:103], v25 offset:20480
    v_mfma_f32_16x16x32_bf16 a[20:23], v[68:71], a[136:139], 0
    v_mfma_f32_16x16x32_bf16 a[24:27], v[68:71], a[144:147], 0
    ds_read_b64_tr_b16 v[104:105], v26 offset:16384
    v_mfma_f32_16x16x32_bf16 a[28:31], v[68:71], a[152:155], 0
    ds_read_b64_tr_b16 v[106:107], v26 offset:20480
    v_mfma_f32_16x16x32_bf16 a[32:35], v[72:75], a[128:131], 0
    s_mov_b32 s51, 486400
    buffer_load_dwordx4 v52, s[20:23], s51 offen offset:1024 lds
    v_mfma_f32_16x16x32_bf16 a[36:39], v[72:75], a[136:139], 0
    ds_read_b64_tr_b16 v[108:109], v27 offset:16384
    v_mfma_f32_16x16x32_bf16 a[40:43], v[72:75], a[144:147], 0
    ds_read_b64_tr_b16 v[110:111], v27 offset:20480
    v_mfma_f32_16x16x32_bf16 a[44:47], v[72:75], a[152:155], 0
    v_mfma_f32_16x16x32_bf16 a[48:51], v[76:79], a[128:131], 0
    ds_read_b64_tr_b16 v[112:113], v28 offset:16384
    v_mfma_f32_16x16x32_bf16 a[52:55], v[76:79], a[136:139], 0
    ds_read_b64_tr_b16 v[114:115], v28 offset:20480
    v_mfma_f32_16x16x32_bf16 a[56:59], v[76:79], a[144:147], 0
    s_add_u32 m0, s45, 73728
    s_mov_b32 s50, 458752
    buffer_load_dwordx4 v52, s[24:27], s50 offen offset:0 lds
    v_mfma_f32_16x16x32_bf16 a[60:63], v[76:79], a[152:155], 0
    ds_read_b64_tr_b16 v[116:117], v29 offset:16384
    v_mfma_f32_16x16x32_bf16 a[64:67], v[80:83], a[128:131], 0
    ds_read_b64_tr_b16 v[118:119], v29 offset:20480
    v_mfma_f32_16x16x32_bf16 a[68:71], v[80:83], a[136:139], 0
    v_mfma_f32_16x16x32_bf16 a[72:75], v[80:83], a[144:147], 0
    ds_read_b64_tr_b16 v[120:121], v30 offset:16384
    v_mfma_f32_16x16x32_bf16 a[76:79], v[80:83], a[152:155], 0
    ds_read_b64_tr_b16 v[122:123], v30 offset:20480
    v_mfma_f32_16x16x32_bf16 a[80:83], v[84:87], a[128:131], 0
    s_mov_b32 s51, 486400
    buffer_load_dwordx4 v52, s[24:27], s51 offen offset:1024 lds
    v_mfma_f32_16x16x32_bf16 a[84:87], v[84:87], a[136:139], 0
    ds_read_b64_tr_b16 v[124:125], v31 offset:16384
    v_mfma_f32_16x16x32_bf16 a[88:91], v[84:87], a[144:147], 0
    ds_read_b64_tr_b16 v[126:127], v31 offset:20480
    v_mfma_f32_16x16x32_bf16 a[92:95], v[84:87], a[152:155], 0
    v_mfma_f32_16x16x32_bf16 a[96:99], v[88:91], a[128:131], 0
    v_mfma_f32_16x16x32_bf16 a[100:103], v[88:91], a[136:139], 0
    v_mfma_f32_16x16x32_bf16 a[104:107], v[88:91], a[144:147], 0
    v_mfma_f32_16x16x32_bf16 a[108:111], v[88:91], a[152:155], 0
    v_mfma_f32_16x16x32_bf16 a[112:115], v[92:95], a[128:131], 0
    v_mfma_f32_16x16x32_bf16 a[116:119], v[92:95], a[136:139], 0
    v_mfma_f32_16x16x32_bf16 a[120:123], v[92:95], a[144:147], 0
    v_mfma_f32_16x16x32_bf16 a[124:127], v[92:95], a[152:155], 0
    s_waitcnt lgkmcnt(0)
    v_mfma_f32_16x16x32_bf16 v[128:131], v[96:99], a[128:131], 0
    ds_read_b64_tr_b16 v[64:65], v32 offset:4096
    v_mfma_f32_16x16x32_bf16 v[132:135], v[96:99], a[136:139], 0
    ds_read_b64_tr_b16 v[66:67], v32 offset:6144
    v_mfma_f32_16x16x32_bf16 v[136:139], v[96:99], a[144:147], 0
    v_add_u32 v53, 2048, v53
    buffer_load_dwordx4 a[192:195], v53, s[28:31], s40 offen offset:0
    v_mfma_f32_16x16x32_bf16 v[140:143], v[96:99], a[152:155], 0
    ds_read_b64_tr_b16 v[68:69], v33 offset:4096
    v_mfma_f32_16x16x32_bf16 v[144:147], v[100:103], a[128:131], 0
    ds_read_b64_tr_b16 v[70:71], v33 offset:6144
    v_mfma_f32_16x16x32_bf16 v[148:151], v[100:103], a[136:139], 0
    v_mfma_f32_16x16x32_bf16 v[152:155], v[100:103], a[144:147], 0
    ds_read_b64_tr_b16 v[72:73], v34 offset:4096
    v_mfma_f32_16x16x32_bf16 v[156:159], v[100:103], a[152:155], 0
    ds_read_b64_tr_b16 v[74:75], v34 offset:6144
    v_mfma_f32_16x16x32_bf16 v[160:163], v[104:107], a[128:131], 0
    buffer_load_dwordx4 a[200:203], v53, s[28:31], s41 offen offset:0
    v_mfma_f32_16x16x32_bf16 v[164:167], v[104:107], a[136:139], 0
    ds_read_b64_tr_b16 v[76:77], v35 offset:4096
    v_mfma_f32_16x16x32_bf16 v[168:171], v[104:107], a[144:147], 0
    ds_read_b64_tr_b16 v[78:79], v35 offset:6144
    v_mfma_f32_16x16x32_bf16 v[172:175], v[104:107], a[152:155], 0
    v_mfma_f32_16x16x32_bf16 v[176:179], v[108:111], a[128:131], 0
    ds_read_b64_tr_b16 v[80:81], v32 offset:12288
    v_mfma_f32_16x16x32_bf16 v[180:183], v[108:111], a[136:139], 0
    ds_read_b64_tr_b16 v[82:83], v32 offset:14336
    v_mfma_f32_16x16x32_bf16 v[184:187], v[108:111], a[144:147], 0
    buffer_load_dwordx4 a[208:211], v53, s[28:31], s42 offen offset:0
    v_mfma_f32_16x16x32_bf16 v[188:191], v[108:111], a[152:155], 0
    ds_read_b64_tr_b16 v[84:85], v33 offset:12288
    v_mfma_f32_16x16x32_bf16 v[192:195], v[112:115], a[128:131], 0
    ds_read_b64_tr_b16 v[86:87], v33 offset:14336
    v_mfma_f32_16x16x32_bf16 v[196:199], v[112:115], a[136:139], 0
    v_mfma_f32_16x16x32_bf16 v[200:203], v[112:115], a[144:147], 0
    ds_read_b64_tr_b16 v[88:89], v34 offset:12288
    v_mfma_f32_16x16x32_bf16 v[204:207], v[112:115], a[152:155], 0
    ds_read_b64_tr_b16 v[90:91], v34 offset:14336
    v_mfma_f32_16x16x32_bf16 v[208:211], v[116:119], a[128:131], 0
    buffer_load_dwordx4 a[216:219], v53, s[28:31], s43 offen offset:0
    v_mfma_f32_16x16x32_bf16 v[212:215], v[116:119], a[136:139], 0
    ds_read_b64_tr_b16 v[92:93], v35 offset:12288
    v_mfma_f32_16x16x32_bf16 v[216:219], v[116:119], a[144:147], 0
    ds_read_b64_tr_b16 v[94:95], v35 offset:14336
    v_mfma_f32_16x16x32_bf16 v[220:223], v[116:119], a[152:155], 0
    v_mfma_f32_16x16x32_bf16 v[224:227], v[120:123], a[128:131], 0
    v_mfma_f32_16x16x32_bf16 v[228:231], v[120:123], a[136:139], 0
    v_mfma_f32_16x16x32_bf16 v[232:235], v[120:123], a[144:147], 0
    v_mfma_f32_16x16x32_bf16 v[236:239], v[120:123], a[152:155], 0
    v_mfma_f32_16x16x32_bf16 v[240:243], v[124:127], a[128:131], 0
    v_mfma_f32_16x16x32_bf16 v[244:247], v[124:127], a[136:139], 0
    v_mfma_f32_16x16x32_bf16 v[248:251], v[124:127], a[144:147], 0
    v_mfma_f32_16x16x32_bf16 v[252:255], v[124:127], a[152:155], 0
    s_waitcnt lgkmcnt(0)
    v_mfma_f32_16x16x32_bf16 a[0:3], v[64:67], a[132:135], a[0:3]
    ds_read_b64_tr_b16 v[96:97], v24 offset:24576
    v_mfma_f32_16x16x32_bf16 a[4:7], v[64:67], a[140:143], a[4:7]
    ds_read_b64_tr_b16 v[98:99], v24 offset:28672
    v_mfma_f32_16x16x32_bf16 a[8:11], v[64:67], a[148:151], a[8:11]
    s_add_u32 m0, s44, 81920
    s_mov_b32 s50, 1048576
    buffer_load_dwordx4 v50, s[16:19], s50 offen offset:0 lds
    v_mfma_f32_16x16x32_bf16 a[12:15], v[64:67], a[156:159], a[12:15]
    ds_read_b64_tr_b16 v[100:101], v25 offset:24576
    v_mfma_f32_16x16x32_bf16 a[16:19], v[68:71], a[132:135], a[16:19]
    ds_read_b64_tr_b16 v[102:103], v25 offset:28672
    v_mfma_f32_16x16x32_bf16 a[20:23], v[68:71], a[140:143], a[20:23]
    v_mfma_f32_16x16x32_bf16 a[24:27], v[68:71], a[148:151], a[24:27]
    ds_read_b64_tr_b16 v[104:105], v26 offset:24576
    v_mfma_f32_16x16x32_bf16 a[28:31], v[68:71], a[156:159], a[28:31]
    ds_read_b64_tr_b16 v[106:107], v26 offset:28672
    v_mfma_f32_16x16x32_bf16 a[32:35], v[72:75], a[132:135], a[32:35]
    s_mov_b32 s51, 1080320
    buffer_load_dwordx4 v51, s[16:19], s51 offen offset:1024 lds
    v_mfma_f32_16x16x32_bf16 a[36:39], v[72:75], a[140:143], a[36:39]
    ds_read_b64_tr_b16 v[108:109], v27 offset:24576
    v_mfma_f32_16x16x32_bf16 a[40:43], v[72:75], a[148:151], a[40:43]
    ds_read_b64_tr_b16 v[110:111], v27 offset:28672
    v_mfma_f32_16x16x32_bf16 a[44:47], v[72:75], a[156:159], a[44:47]
    v_mfma_f32_16x16x32_bf16 a[48:51], v[76:79], a[132:135], a[48:51]
    ds_read_b64_tr_b16 v[112:113], v28 offset:24576
    v_mfma_f32_16x16x32_bf16 a[52:55], v[76:79], a[140:143], a[52:55]
    ds_read_b64_tr_b16 v[114:115], v28 offset:28672
    v_mfma_f32_16x16x32_bf16 a[56:59], v[76:79], a[148:151], a[56:59]
    s_mov_b32 s50, 1112064
    buffer_load_dwordx4 v50, s[16:19], s50 offen offset:2048 lds
    v_mfma_f32_16x16x32_bf16 a[60:63], v[76:79], a[156:159], a[60:63]
    ds_read_b64_tr_b16 v[116:117], v29 offset:24576
    v_mfma_f32_16x16x32_bf16 a[64:67], v[80:83], a[132:135], a[64:67]
    ds_read_b64_tr_b16 v[118:119], v29 offset:28672
    v_mfma_f32_16x16x32_bf16 a[68:71], v[80:83], a[140:143], a[68:71]
    v_mfma_f32_16x16x32_bf16 a[72:75], v[80:83], a[148:151], a[72:75]
    ds_read_b64_tr_b16 v[120:121], v30 offset:24576
    v_mfma_f32_16x16x32_bf16 a[76:79], v[80:83], a[156:159], a[76:79]
    ds_read_b64_tr_b16 v[122:123], v30 offset:28672
    v_mfma_f32_16x16x32_bf16 a[80:83], v[84:87], a[132:135], a[80:83]
    s_mov_b32 s51, 1143808
    buffer_load_dwordx4 v51, s[16:19], s51 offen offset:3072 lds
    v_mfma_f32_16x16x32_bf16 a[84:87], v[84:87], a[140:143], a[84:87]
    ds_read_b64_tr_b16 v[124:125], v31 offset:24576
    v_mfma_f32_16x16x32_bf16 a[88:91], v[84:87], a[148:151], a[88:91]
    ds_read_b64_tr_b16 v[126:127], v31 offset:28672
    v_mfma_f32_16x16x32_bf16 a[92:95], v[84:87], a[156:159], a[92:95]
    v_mfma_f32_16x16x32_bf16 a[96:99], v[88:91], a[132:135], a[96:99]
    v_mfma_f32_16x16x32_bf16 a[100:103], v[88:91], a[140:143], a[100:103]
    v_mfma_f32_16x16x32_bf16 a[104:107], v[88:91], a[148:151], a[104:107]
    v_mfma_f32_16x16x32_bf16 a[108:111], v[88:91], a[156:159], a[108:111]
    v_mfma_f32_16x16x32_bf16 a[112:115], v[92:95], a[132:135], a[112:115]
    v_mfma_f32_16x16x32_bf16 a[116:119], v[92:95], a[140:143], a[116:119]
    v_mfma_f32_16x16x32_bf16 a[120:123], v[92:95], a[148:151], a[120:123]
    v_mfma_f32_16x16x32_bf16 a[124:127], v[92:95], a[156:159], a[124:127]
    s_waitcnt vmcnt(16) lgkmcnt(0)
    s_barrier
    v_mfma_f32_16x16x32_bf16 v[128:131], v[96:99], a[132:135], v[128:131]
    ds_read_b64_tr_b16 v[64:65], v32 offset:32768
    v_mfma_f32_16x16x32_bf16 v[132:135], v[96:99], a[140:143], v[132:135]
    ds_read_b64_tr_b16 v[66:67], v32 offset:34816
    v_mfma_f32_16x16x32_bf16 v[136:139], v[96:99], a[148:151], v[136:139]
    buffer_load_dwordx4 a[196:199], v53, s[28:31], s40 offen offset:1024
    v_mfma_f32_16x16x32_bf16 v[140:143], v[96:99], a[156:159], v[140:143]
    ds_read_b64_tr_b16 v[68:69], v33 offset:32768
    v_mfma_f32_16x16x32_bf16 v[144:147], v[100:103], a[132:135], v[144:147]
    ds_read_b64_tr_b16 v[70:71], v33 offset:34816
    v_mfma_f32_16x16x32_bf16 v[148:151], v[100:103], a[140:143], v[148:151]
    v_mfma_f32_16x16x32_bf16 v[152:155], v[100:103], a[148:151], v[152:155]
    ds_read_b64_tr_b16 v[72:73], v34 offset:32768
    v_mfma_f32_16x16x32_bf16 v[156:159], v[100:103], a[156:159], v[156:159]
    ds_read_b64_tr_b16 v[74:75], v34 offset:34816
    v_mfma_f32_16x16x32_bf16 v[160:163], v[104:107], a[132:135], v[160:163]
    buffer_load_dwordx4 a[204:207], v53, s[28:31], s41 offen offset:1024
    v_mfma_f32_16x16x32_bf16 v[164:167], v[104:107], a[140:143], v[164:167]
    ds_read_b64_tr_b16 v[76:77], v35 offset:32768
    v_mfma_f32_16x16x32_bf16 v[168:171], v[104:107], a[148:151], v[168:171]
    ds_read_b64_tr_b16 v[78:79], v35 offset:34816
    v_mfma_f32_16x16x32_bf16 v[172:175], v[104:107], a[156:159], v[172:175]
    v_mfma_f32_16x16x32_bf16 v[176:179], v[108:111], a[132:135], v[176:179]
    ds_read_b64_tr_b16 v[80:81], v32 offset:40960
    v_mfma_f32_16x16x32_bf16 v[180:183], v[108:111], a[140:143], v[180:183]
    ds_read_b64_tr_b16 v[82:83], v32 offset:43008
    v_mfma_f32_16x16x32_bf16 v[184:187], v[108:111], a[148:151], v[184:187]
    buffer_load_dwordx4 a[212:215], v53, s[28:31], s42 offen offset:1024
    v_mfma_f32_16x16x32_bf16 v[188:191], v[108:111], a[156:159], v[188:191]
    ds_read_b64_tr_b16 v[84:85], v33 offset:40960
    v_mfma_f32_16x16x32_bf16 v[192:195], v[112:115], a[132:135], v[192:195]
    ds_read_b64_tr_b16 v[86:87], v33 offset:43008
    v_mfma_f32_16x16x32_bf16 v[196:199], v[112:115], a[140:143], v[196:199]
    v_mfma_f32_16x16x32_bf16 v[200:203], v[112:115], a[148:151], v[200:203]
    ds_read_b64_tr_b16 v[88:89], v34 offset:40960
    v_mfma_f32_16x16x32_bf16 v[204:207], v[112:115], a[156:159], v[204:207]
    ds_read_b64_tr_b16 v[90:91], v34 offset:43008
    v_mfma_f32_16x16x32_bf16 v[208:211], v[116:119], a[132:135], v[208:211]
    buffer_load_dwordx4 a[220:223], v53, s[28:31], s43 offen offset:1024
    v_mfma_f32_16x16x32_bf16 v[212:215], v[116:119], a[140:143], v[212:215]
    ds_read_b64_tr_b16 v[92:93], v35 offset:40960
    v_mfma_f32_16x16x32_bf16 v[216:219], v[116:119], a[148:151], v[216:219]
    ds_read_b64_tr_b16 v[94:95], v35 offset:43008
    v_mfma_f32_16x16x32_bf16 v[220:223], v[116:119], a[156:159], v[220:223]
    v_mfma_f32_16x16x32_bf16 v[224:227], v[120:123], a[132:135], v[224:227]
    v_mfma_f32_16x16x32_bf16 v[228:231], v[120:123], a[140:143], v[228:231]
    v_mfma_f32_16x16x32_bf16 v[232:235], v[120:123], a[148:151], v[232:235]
    v_mfma_f32_16x16x32_bf16 v[236:239], v[120:123], a[156:159], v[236:239]
    v_mfma_f32_16x16x32_bf16 v[240:243], v[124:127], a[132:135], v[240:243]
    v_mfma_f32_16x16x32_bf16 v[244:247], v[124:127], a[140:143], v[244:247]
    v_mfma_f32_16x16x32_bf16 v[248:251], v[124:127], a[148:151], v[248:251]
    v_mfma_f32_16x16x32_bf16 v[252:255], v[124:127], a[156:159], v[252:255]
    s_waitcnt vmcnt(16) lgkmcnt(0)
    v_mfma_f32_16x16x32_bf16 a[0:3], v[64:67], a[160:163], a[0:3]
    ds_read_b64_tr_b16 v[96:97], v24 offset:49152
    v_mfma_f32_16x16x32_bf16 a[4:7], v[64:67], a[168:171], a[4:7]
    ds_read_b64_tr_b16 v[98:99], v24 offset:53248
    v_mfma_f32_16x16x32_bf16 a[8:11], v[64:67], a[176:179], a[8:11]
    s_add_u32 m0, s45, 98304
    s_mov_b32 s50, 688128
    buffer_load_dwordx4 v52, s[20:23], s50 offen offset:0 lds
    v_mfma_f32_16x16x32_bf16 a[12:15], v[64:67], a[184:187], a[12:15]
    ds_read_b64_tr_b16 v[100:101], v25 offset:49152
    v_mfma_f32_16x16x32_bf16 a[16:19], v[68:71], a[160:163], a[16:19]
    ds_read_b64_tr_b16 v[102:103], v25 offset:53248
    v_mfma_f32_16x16x32_bf16 a[20:23], v[68:71], a[168:171], a[20:23]
    v_mfma_f32_16x16x32_bf16 a[24:27], v[68:71], a[176:179], a[24:27]
    ds_read_b64_tr_b16 v[104:105], v26 offset:49152
    v_mfma_f32_16x16x32_bf16 a[28:31], v[68:71], a[184:187], a[28:31]
    ds_read_b64_tr_b16 v[106:107], v26 offset:53248
    v_mfma_f32_16x16x32_bf16 a[32:35], v[72:75], a[160:163], a[32:35]
    s_mov_b32 s51, 715776
    buffer_load_dwordx4 v52, s[20:23], s51 offen offset:1024 lds
    v_mfma_f32_16x16x32_bf16 a[36:39], v[72:75], a[168:171], a[36:39]
    ds_read_b64_tr_b16 v[108:109], v27 offset:49152
    v_mfma_f32_16x16x32_bf16 a[40:43], v[72:75], a[176:179], a[40:43]
    ds_read_b64_tr_b16 v[110:111], v27 offset:53248
    v_mfma_f32_16x16x32_bf16 a[44:47], v[72:75], a[184:187], a[44:47]
    v_mfma_f32_16x16x32_bf16 a[48:51], v[76:79], a[160:163], a[48:51]
    ds_read_b64_tr_b16 v[112:113], v28 offset:49152
    v_mfma_f32_16x16x32_bf16 a[52:55], v[76:79], a[168:171], a[52:55]
    ds_read_b64_tr_b16 v[114:115], v28 offset:53248
    v_mfma_f32_16x16x32_bf16 a[56:59], v[76:79], a[176:179], a[56:59]
    s_add_u32 m0, s45, 106496
    s_mov_b32 s50, 688128
    buffer_load_dwordx4 v52, s[24:27], s50 offen offset:0 lds
    v_mfma_f32_16x16x32_bf16 a[60:63], v[76:79], a[184:187], a[60:63]
    ds_read_b64_tr_b16 v[116:117], v29 offset:49152
    v_mfma_f32_16x16x32_bf16 a[64:67], v[80:83], a[160:163], a[64:67]
    ds_read_b64_tr_b16 v[118:119], v29 offset:53248
    v_mfma_f32_16x16x32_bf16 a[68:71], v[80:83], a[168:171], a[68:71]
    v_mfma_f32_16x16x32_bf16 a[72:75], v[80:83], a[176:179], a[72:75]
    ds_read_b64_tr_b16 v[120:121], v30 offset:49152
    v_mfma_f32_16x16x32_bf16 a[76:79], v[80:83], a[184:187], a[76:79]
    ds_read_b64_tr_b16 v[122:123], v30 offset:53248
    v_mfma_f32_16x16x32_bf16 a[80:83], v[84:87], a[160:163], a[80:83]
    s_mov_b32 s51, 715776
    buffer_load_dwordx4 v52, s[24:27], s51 offen offset:1024 lds
    v_mfma_f32_16x16x32_bf16 a[84:87], v[84:87], a[168:171], a[84:87]
    ds_read_b64_tr_b16 v[124:125], v31 offset:49152
    v_mfma_f32_16x16x32_bf16 a[88:91], v[84:87], a[176:179], a[88:91]
    ds_read_b64_tr_b16 v[126:127], v31 offset:53248
    v_mfma_f32_16x16x32_bf16 a[92:95], v[84:87], a[184:187], a[92:95]
    v_mfma_f32_16x16x32_bf16 a[96:99], v[88:91], a[160:163], a[96:99]
    v_mfma_f32_16x16x32_bf16 a[100:103], v[88:91], a[168:171], a[100:103]
    v_mfma_f32_16x16x32_bf16 a[104:107], v[88:91], a[176:179], a[104:107]
    v_mfma_f32_16x16x32_bf16 a[108:111], v[88:91], a[184:187], a[108:111]
    v_mfma_f32_16x16x32_bf16 a[112:115], v[92:95], a[160:163], a[112:115]
    v_mfma_f32_16x16x32_bf16 a[116:119], v[92:95], a[168:171], a[116:119]
    v_mfma_f32_16x16x32_bf16 a[120:123], v[92:95], a[176:179], a[120:123]
    v_mfma_f32_16x16x32_bf16 a[124:127], v[92:95], a[184:187], a[124:127]
    s_waitcnt lgkmcnt(0)
    v_mfma_f32_16x16x32_bf16 v[128:131], v[96:99], a[160:163], v[128:131]
    ds_read_b64_tr_b16 v[64:65], v32 offset:36864
    v_mfma_f32_16x16x32_bf16 v[132:135], v[96:99], a[168:171], v[132:135]
    ds_read_b64_tr_b16 v[66:67], v32 offset:38912
    v_mfma_f32_16x16x32_bf16 v[136:139], v[96:99], a[176:179], v[136:139]
    v_add_u32 v53, 2048, v53
    buffer_load_dwordx4 a[224:227], v53, s[28:31], s40 offen offset:0
    v_mfma_f32_16x16x32_bf16 v[140:143], v[96:99], a[184:187], v[140:143]
    ds_read_b64_tr_b16 v[68:69], v33 offset:36864
    v_mfma_f32_16x16x32_bf16 v[144:147], v[100:103], a[160:163], v[144:147]
    ds_read_b64_tr_b16 v[70:71], v33 offset:38912
    v_mfma_f32_16x16x32_bf16 v[148:151], v[100:103], a[168:171], v[148:151]
    v_mfma_f32_16x16x32_bf16 v[152:155], v[100:103], a[176:179], v[152:155]
    ds_read_b64_tr_b16 v[72:73], v34 offset:36864
    v_mfma_f32_16x16x32_bf16 v[156:159], v[100:103], a[184:187], v[156:159]
    ds_read_b64_tr_b16 v[74:75], v34 offset:38912
    v_mfma_f32_16x16x32_bf16 v[160:163], v[104:107], a[160:163], v[160:163]
    buffer_load_dwordx4 a[232:235], v53, s[28:31], s41 offen offset:0
    v_mfma_f32_16x16x32_bf16 v[164:167], v[104:107], a[168:171], v[164:167]
    ds_read_b64_tr_b16 v[76:77], v35 offset:36864
    v_mfma_f32_16x16x32_bf16 v[168:171], v[104:107], a[176:179], v[168:171]
    ds_read_b64_tr_b16 v[78:79], v35 offset:38912
    v_mfma_f32_16x16x32_bf16 v[172:175], v[104:107], a[184:187], v[172:175]
    v_mfma_f32_16x16x32_bf16 v[176:179], v[108:111], a[160:163], v[176:179]
    ds_read_b64_tr_b16 v[80:81], v32 offset:45056
    v_mfma_f32_16x16x32_bf16 v[180:183], v[108:111], a[168:171], v[180:183]
    ds_read_b64_tr_b16 v[82:83], v32 offset:47104
    v_mfma_f32_16x16x32_bf16 v[184:187], v[108:111], a[176:179], v[184:187]
    buffer_load_dwordx4 a[240:243], v53, s[28:31], s42 offen offset:0
    v_mfma_f32_16x16x32_bf16 v[188:191], v[108:111], a[184:187], v[188:191]
    ds_read_b64_tr_b16 v[84:85], v33 offset:45056
    v_mfma_f32_16x16x32_bf16 v[192:195], v[112:115], a[160:163], v[192:195]
    ds_read_b64_tr_b16 v[86:87], v33 offset:47104
    v_mfma_f32_16x16x32_bf16 v[196:199], v[112:115], a[168:171], v[196:199]
    v_mfma_f32_16x16x32_bf16 v[200:203], v[112:115], a[176:179], v[200:203]
    ds_read_b64_tr_b16 v[88:89], v34 offset:45056
    v_mfma_f32_16x16x32_bf16 v[204:207], v[112:115], a[184:187], v[204:207]
    ds_read_b64_tr_b16 v[90:91], v34 offset:47104
    v_mfma_f32_16x16x32_bf16 v[208:211], v[116:119], a[160:163], v[208:211]
    buffer_load_dwordx4 a[248:251], v53, s[28:31], s43 offen offset:0
    v_mfma_f32_16x16x32_bf16 v[212:215], v[116:119], a[168:171], v[212:215]
    ds_read_b64_tr_b16 v[92:93], v35 offset:45056
    v_mfma_f32_16x16x32_bf16 v[216:219], v[116:119], a[176:179], v[216:219]
    ds_read_b64_tr_b16 v[94:95], v35 offset:47104
    v_mfma_f32_16x16x32_bf16 v[220:223], v[116:119], a[184:187], v[220:223]
    v_mfma_f32_16x16x32_bf16 v[224:227], v[120:123], a[160:163], v[224:227]
    v_mfma_f32_16x16x32_bf16 v[228:231], v[120:123], a[168:171], v[228:231]
    v_mfma_f32_16x16x32_bf16 v[232:235], v[120:123], a[176:179], v[232:235]
    v_mfma_f32_16x16x32_bf16 v[236:239], v[120:123], a[184:187], v[236:239]
    v_mfma_f32_16x16x32_bf16 v[240:243], v[124:127], a[160:163], v[240:243]
    v_mfma_f32_16x16x32_bf16 v[244:247], v[124:127], a[168:171], v[244:247]
    v_mfma_f32_16x16x32_bf16 v[248:251], v[124:127], a[176:179], v[248:251]
    v_mfma_f32_16x16x32_bf16 v[252:255], v[124:127], a[184:187], v[252:255]
    s_waitcnt lgkmcnt(0)
    v_mfma_f32_16x16x32_bf16 a[0:3], v[64:67], a[164:167], a[0:3]
    ds_read_b64_tr_b16 v[96:97], v24 offset:57344
    v_mfma_f32_16x16x32_bf16 a[4:7], v[64:67], a[172:175], a[4:7]
    ds_read_b64_tr_b16 v[98:99], v24 offset:61440
    v_mfma_f32_16x16x32_bf16 a[8:11], v[64:67], a[180:183], a[8:11]
    s_add_u32 m0, s44, 114688
    s_mov_b32 s50, 1572864
    buffer_load_dwordx4 v50, s[16:19], s50 offen offset:0 lds
    v_mfma_f32_16x16x32_bf16 a[12:15], v[64:67], a[188:191], a[12:15]
    ds_read_b64_tr_b16 v[100:101], v25 offset:57344
    v_mfma_f32_16x16x32_bf16 a[16:19], v[68:71], a[164:167], a[16:19]
    ds_read_b64_tr_b16 v[102:103], v25 offset:61440
    v_mfma_f32_16x16x32_bf16 a[20:23], v[68:71], a[172:175], a[20:23]
    v_mfma_f32_16x16x32_bf16 a[24:27], v[68:71], a[180:183], a[24:27]
    ds_read_b64_tr_b16 v[104:105], v26 offset:57344
    v_mfma_f32_16x16x32_bf16 a[28:31], v[68:71], a[188:191], a[28:31]
    ds_read_b64_tr_b16 v[106:107], v26 offset:61440
    v_mfma_f32_16x16x32_bf16 a[32:35], v[72:75], a[164:167], a[32:35]
    s_mov_b32 s51, 1604608
    buffer_load_dwordx4 v51, s[16:19], s51 offen offset:1024 lds
    v_mfma_f32_16x16x32_bf16 a[36:39], v[72:75], a[172:175], a[36:39]
    ds_read_b64_tr_b16 v[108:109], v27 offset:57344
    v_mfma_f32_16x16x32_bf16 a[40:43], v[72:75], a[180:183], a[40:43]
    ds_read_b64_tr_b16 v[110:111], v27 offset:61440
    v_mfma_f32_16x16x32_bf16 a[44:47], v[72:75], a[188:191], a[44:47]
    v_mfma_f32_16x16x32_bf16 a[48:51], v[76:79], a[164:167], a[48:51]
    ds_read_b64_tr_b16 v[112:113], v28 offset:57344
    v_mfma_f32_16x16x32_bf16 a[52:55], v[76:79], a[172:175], a[52:55]
    ds_read_b64_tr_b16 v[114:115], v28 offset:61440
    v_mfma_f32_16x16x32_bf16 a[56:59], v[76:79], a[180:183], a[56:59]
    s_mov_b32 s50, 1636352
    buffer_load_dwordx4 v50, s[16:19], s50 offen offset:2048 lds
    v_mfma_f32_16x16x32_bf16 a[60:63], v[76:79], a[188:191], a[60:63]
    ds_read_b64_tr_b16 v[116:117], v29 offset:57344
    v_mfma_f32_16x16x32_bf16 a[64:67], v[80:83], a[164:167], a[64:67]
    ds_read_b64_tr_b16 v[118:119], v29 offset:61440
    v_mfma_f32_16x16x32_bf16 a[68:71], v[80:83], a[172:175], a[68:71]
    v_mfma_f32_16x16x32_bf16 a[72:75], v[80:83], a[180:183], a[72:75]
    ds_read_b64_tr_b16 v[120:121], v30 offset:57344
    v_mfma_f32_16x16x32_bf16 a[76:79], v[80:83], a[188:191], a[76:79]
    ds_read_b64_tr_b16 v[122:123], v30 offset:61440
    v_mfma_f32_16x16x32_bf16 a[80:83], v[84:87], a[164:167], a[80:83]
    s_mov_b32 s51, 1668096
    buffer_load_dwordx4 v51, s[16:19], s51 offen offset:3072 lds
    v_mfma_f32_16x16x32_bf16 a[84:87], v[84:87], a[172:175], a[84:87]
    ds_read_b64_tr_b16 v[124:125], v31 offset:57344
    v_mfma_f32_16x16x32_bf16 a[88:91], v[84:87], a[180:183], a[88:91]
    ds_read_b64_tr_b16 v[126:127], v31 offset:61440
    v_mfma_f32_16x16x32_bf16 a[92:95], v[84:87], a[188:191], a[92:95]
    v_mfma_f32_16x16x32_bf16 a[96:99], v[88:91], a[164:167], a[96:99]
    v_mfma_f32_16x16x32_bf16 a[100:103], v[88:91], a[172:175], a[100:103]
    v_mfma_f32_16x16x32_bf16 a[104:107], v[88:91], a[180:183], a[104:107]
    v_mfma_f32_16x16x32_bf16 a[108:111], v[88:91], a[188:191], a[108:111]
    v_mfma_f32_16x16x32_bf16 a[112:115], v[92:95], a[164:167], a[112:115]
    v_mfma_f32_16x16x32_bf16 a[116:119], v[92:95], a[172:175], a[116:119]
    v_mfma_f32_16x16x32_bf16 a[120:123], v[92:95], a[180:183], a[120:123]
    v_mfma_f32_16x16x32_bf16 a[124:127], v[92:95], a[188:191], a[124:127]
    s_waitcnt vmcnt(16) lgkmcnt(0)
    s_barrier
    v_mfma_f32_16x16x32_bf16 v[128:131], v[96:99], a[164:167], v[128:131]
    ds_read_b64_tr_b16 v[64:65], v36 offset:0
    v_mfma_f32_16x16x32_bf16 v[132:135], v[96:99], a[172:175], v[132:135]
    ds_read_b64_tr_b16 v[66:67], v36 offset:2048
    v_mfma_f32_16x16x32_bf16 v[136:139], v[96:99], a[180:183], v[136:139]
    buffer_load_dwordx4 a[228:231], v53, s[28:31], s40 offen offset:1024
    v_mfma_f32_16x16x32_bf16 v[140:143], v[96:99], a[188:191], v[140:143]
    ds_read_b64_tr_b16 v[68:69], v37 offset:0
    v_mfma_f32_16x16x32_bf16 v[144:147], v[100:103], a[164:167], v[144:147]
    ds_read_b64_tr_b16 v[70:71], v37 offset:2048
    v_mfma_f32_16x16x32_bf16 v[148:151], v[100:103], a[172:175], v[148:151]
    v_mfma_f32_16x16x32_bf16 v[152:155], v[100:103], a[180:183], v[152:155]
    ds_read_b64_tr_b16 v[72:73], v38 offset:0
    v_mfma_f32_16x16x32_bf16 v[156:159], v[100:103], a[188:191], v[156:159]
    ds_read_b64_tr_b16 v[74:75], v38 offset:2048
    v_mfma_f32_16x16x32_bf16 v[160:163], v[104:107], a[164:167], v[160:163]
    buffer_load_dwordx4 a[236:239], v53, s[28:31], s41 offen offset:1024
    v_mfma_f32_16x16x32_bf16 v[164:167], v[104:107], a[172:175], v[164:167]
    ds_read_b64_tr_b16 v[76:77], v39 offset:0
    v_mfma_f32_16x16x32_bf16 v[168:171], v[104:107], a[180:183], v[168:171]
    ds_read_b64_tr_b16 v[78:79], v39 offset:2048
    v_mfma_f32_16x16x32_bf16 v[172:175], v[104:107], a[188:191], v[172:175]
    v_mfma_f32_16x16x32_bf16 v[176:179], v[108:111], a[164:167], v[176:179]
    ds_read_b64_tr_b16 v[80:81], v36 offset:8192
    v_mfma_f32_16x16x32_bf16 v[180:183], v[108:111], a[172:175], v[180:183]
    ds_read_b64_tr_b16 v[82:83], v36 offset:10240
    v_mfma_f32_16x16x32_bf16 v[184:187], v[108:111], a[180:183], v[184:187]
    buffer_load_dwordx4 a[244:247], v53, s[28:31], s42 offen offset:1024
    v_mfma_f32_16x16x32_bf16 v[188:191], v[108:111], a[188:191], v[188:191]
    ds_read_b64_tr_b16 v[84:85], v37 offset:8192
    v_mfma_f32_16x16x32_bf16 v[192:195], v[112:115], a[164:167], v[192:195]
    ds_read_b64_tr_b16 v[86:87], v37 offset:10240
    v_mfma_f32_16x16x32_bf16 v[196:199], v[112:115], a[172:175], v[196:199]
    v_mfma_f32_16x16x32_bf16 v[200:203], v[112:115], a[180:183], v[200:203]
    ds_read_b64_tr_b16 v[88:89], v38 offset:8192
    v_mfma_f32_16x16x32_bf16 v[204:207], v[112:115], a[188:191], v[204:207]
    ds_read_b64_tr_b16 v[90:91], v38 offset:10240
    v_mfma_f32_16x16x32_bf16 v[208:211], v[116:119], a[164:167], v[208:211]
    buffer_load_dwordx4 a[252:255], v53, s[28:31], s43 offen offset:1024
    v_mfma_f32_16x16x32_bf16 v[212:215], v[116:119], a[172:175], v[212:215]
    ds_read_b64_tr_b16 v[92:93], v39 offset:8192
    v_mfma_f32_16x16x32_bf16 v[216:219], v[116:119], a[180:183], v[216:219]
    ds_read_b64_tr_b16 v[94:95], v39 offset:10240
    v_mfma_f32_16x16x32_bf16 v[220:223], v[116:119], a[188:191], v[220:223]
    v_mfma_f32_16x16x32_bf16 v[224:227], v[120:123], a[164:167], v[224:227]
    v_mfma_f32_16x16x32_bf16 v[228:231], v[120:123], a[172:175], v[228:231]
    v_mfma_f32_16x16x32_bf16 v[232:235], v[120:123], a[180:183], v[232:235]
    v_mfma_f32_16x16x32_bf16 v[236:239], v[120:123], a[188:191], v[236:239]
    v_mfma_f32_16x16x32_bf16 v[240:243], v[124:127], a[164:167], v[240:243]
    v_mfma_f32_16x16x32_bf16 v[244:247], v[124:127], a[172:175], v[244:247]
    v_mfma_f32_16x16x32_bf16 v[248:251], v[124:127], a[180:183], v[248:251]
    v_mfma_f32_16x16x32_bf16 v[252:255], v[124:127], a[188:191], v[252:255]
    s_waitcnt vmcnt(16) lgkmcnt(0)
    v_mfma_f32_16x16x32_bf16 a[0:3], v[64:67], a[192:195], a[0:3]
    ds_read_b64_tr_b16 v[96:97], v16 offset:16384
    v_mfma_f32_16x16x32_bf16 a[4:7], v[64:67], a[200:203], a[4:7]
    ds_read_b64_tr_b16 v[98:99], v16 offset:20480
    v_mfma_f32_16x16x32_bf16 a[8:11], v[64:67], a[208:211], a[8:11]
    s_add_u32 m0, s45, 0
    s_mov_b32 s50, 917504
    buffer_load_dwordx4 v52, s[20:23], s50 offen offset:0 lds
    v_mfma_f32_16x16x32_bf16 a[12:15], v[64:67], a[216:219], a[12:15]
    ds_read_b64_tr_b16 v[100:101], v17 offset:16384
    v_mfma_f32_16x16x32_bf16 a[16:19], v[68:71], a[192:195], a[16:19]
    ds_read_b64_tr_b16 v[102:103], v17 offset:20480
    v_mfma_f32_16x16x32_bf16 a[20:23], v[68:71], a[200:203], a[20:23]
    v_mfma_f32_16x16x32_bf16 a[24:27], v[68:71], a[208:211], a[24:27]
    ds_read_b64_tr_b16 v[104:105], v18 offset:16384
    v_mfma_f32_16x16x32_bf16 a[28:31], v[68:71], a[216:219], a[28:31]
    ds_read_b64_tr_b16 v[106:107], v18 offset:20480
    v_mfma_f32_16x16x32_bf16 a[32:35], v[72:75], a[192:195], a[32:35]
    s_mov_b32 s51, 945152
    buffer_load_dwordx4 v52, s[20:23], s51 offen offset:1024 lds
    v_mfma_f32_16x16x32_bf16 a[36:39], v[72:75], a[200:203], a[36:39]
    ds_read_b64_tr_b16 v[108:109], v19 offset:16384
    v_mfma_f32_16x16x32_bf16 a[40:43], v[72:75], a[208:211], a[40:43]
    ds_read_b64_tr_b16 v[110:111], v19 offset:20480
    v_mfma_f32_16x16x32_bf16 a[44:47], v[72:75], a[216:219], a[44:47]
    v_mfma_f32_16x16x32_bf16 a[48:51], v[76:79], a[192:195], a[48:51]
    ds_read_b64_tr_b16 v[112:113], v20 offset:16384
    v_mfma_f32_16x16x32_bf16 a[52:55], v[76:79], a[200:203], a[52:55]
    ds_read_b64_tr_b16 v[114:115], v20 offset:20480
    v_mfma_f32_16x16x32_bf16 a[56:59], v[76:79], a[208:211], a[56:59]
    s_add_u32 m0, s45, 8192
    s_mov_b32 s50, 917504
    buffer_load_dwordx4 v52, s[24:27], s50 offen offset:0 lds
    v_mfma_f32_16x16x32_bf16 a[60:63], v[76:79], a[216:219], a[60:63]
    ds_read_b64_tr_b16 v[116:117], v21 offset:16384
    v_mfma_f32_16x16x32_bf16 a[64:67], v[80:83], a[192:195], a[64:67]
    ds_read_b64_tr_b16 v[118:119], v21 offset:20480
    v_mfma_f32_16x16x32_bf16 a[68:71], v[80:83], a[200:203], a[68:71]
    v_mfma_f32_16x16x32_bf16 a[72:75], v[80:83], a[208:211], a[72:75]
    ds_read_b64_tr_b16 v[120:121], v22 offset:16384
    v_mfma_f32_16x16x32_bf16 a[76:79], v[80:83], a[216:219], a[76:79]
    ds_read_b64_tr_b16 v[122:123], v22 offset:20480
    v_mfma_f32_16x16x32_bf16 a[80:83], v[84:87], a[192:195], a[80:83]
    s_mov_b32 s51, 945152
    buffer_load_dwordx4 v52, s[24:27], s51 offen offset:1024 lds
    v_mfma_f32_16x16x32_bf16 a[84:87], v[84:87], a[200:203], a[84:87]
    ds_read_b64_tr_b16 v[124:125], v23 offset:16384
    v_mfma_f32_16x16x32_bf16 a[88:91], v[84:87], a[208:211], a[88:91]
    ds_read_b64_tr_b16 v[126:127], v23 offset:20480
    v_mfma_f32_16x16x32_bf16 a[92:95], v[84:87], a[216:219], a[92:95]
    v_mfma_f32_16x16x32_bf16 a[96:99], v[88:91], a[192:195], a[96:99]
    v_mfma_f32_16x16x32_bf16 a[100:103], v[88:91], a[200:203], a[100:103]
    v_mfma_f32_16x16x32_bf16 a[104:107], v[88:91], a[208:211], a[104:107]
    v_mfma_f32_16x16x32_bf16 a[108:111], v[88:91], a[216:219], a[108:111]
    v_mfma_f32_16x16x32_bf16 a[112:115], v[92:95], a[192:195], a[112:115]
    v_mfma_f32_16x16x32_bf16 a[116:119], v[92:95], a[200:203], a[116:119]
    v_mfma_f32_16x16x32_bf16 a[120:123], v[92:95], a[208:211], a[120:123]
    v_mfma_f32_16x16x32_bf16 a[124:127], v[92:95], a[216:219], a[124:127]
    s_waitcnt lgkmcnt(0)
    v_mfma_f32_16x16x32_bf16 v[128:131], v[96:99], a[192:195], v[128:131]
    ds_read_b64_tr_b16 v[64:65], v36 offset:4096
    v_mfma_f32_16x16x32_bf16 v[132:135], v[96:99], a[200:203], v[132:135]
    ds_read_b64_tr_b16 v[66:67], v36 offset:6144
    v_mfma_f32_16x16x32_bf16 v[136:139], v[96:99], a[208:211], v[136:139]
    v_add_u32 v53, 2048, v53
    buffer_load_dwordx4 a[128:131], v53, s[28:31], s40 offen offset:0
    v_mfma_f32_16x16x32_bf16 v[140:143], v[96:99], a[216:219], v[140:143]
    ds_read_b64_tr_b16 v[68:69], v37 offset:4096
    v_mfma_f32_16x16x32_bf16 v[144:147], v[100:103], a[192:195], v[144:147]
    ds_read_b64_tr_b16 v[70:71], v37 offset:6144
    v_mfma_f32_16x16x32_bf16 v[148:151], v[100:103], a[200:203], v[148:151]
    v_mfma_f32_16x16x32_bf16 v[152:155], v[100:103], a[208:211], v[152:155]
    ds_read_b64_tr_b16 v[72:73], v38 offset:4096
    v_mfma_f32_16x16x32_bf16 v[156:159], v[100:103], a[216:219], v[156:159]
    ds_read_b64_tr_b16 v[74:75], v38 offset:6144
    v_mfma_f32_16x16x32_bf16 v[160:163], v[104:107], a[192:195], v[160:163]
    buffer_load_dwordx4 a[136:139], v53, s[28:31], s41 offen offset:0
    v_mfma_f32_16x16x32_bf16 v[164:167], v[104:107], a[200:203], v[164:167]
    ds_read_b64_tr_b16 v[76:77], v39 offset:4096
    v_mfma_f32_16x16x32_bf16 v[168:171], v[104:107], a[208:211], v[168:171]
    ds_read_b64_tr_b16 v[78:79], v39 offset:6144
    v_mfma_f32_16x16x32_bf16 v[172:175], v[104:107], a[216:219], v[172:175]
    v_mfma_f32_16x16x32_bf16 v[176:179], v[108:111], a[192:195], v[176:179]
    ds_read_b64_tr_b16 v[80:81], v36 offset:12288
    v_mfma_f32_16x16x32_bf16 v[180:183], v[108:111], a[200:203], v[180:183]
    ds_read_b64_tr_b16 v[82:83], v36 offset:14336
    v_mfma_f32_16x16x32_bf16 v[184:187], v[108:111], a[208:211], v[184:187]
    buffer_load_dwordx4 a[144:147], v53, s[28:31], s42 offen offset:0
    v_mfma_f32_16x16x32_bf16 v[188:191], v[108:111], a[216:219], v[188:191]
    ds_read_b64_tr_b16 v[84:85], v37 offset:12288
    v_mfma_f32_16x16x32_bf16 v[192:195], v[112:115], a[192:195], v[192:195]
    ds_read_b64_tr_b16 v[86:87], v37 offset:14336
    v_mfma_f32_16x16x32_bf16 v[196:199], v[112:115], a[200:203], v[196:199]
    v_mfma_f32_16x16x32_bf16 v[200:203], v[112:115], a[208:211], v[200:203]
    ds_read_b64_tr_b16 v[88:89], v38 offset:12288
    v_mfma_f32_16x16x32_bf16 v[204:207], v[112:115], a[216:219], v[204:207]
    ds_read_b64_tr_b16 v[90:91], v38 offset:14336
    v_mfma_f32_16x16x32_bf16 v[208:211], v[116:119], a[192:195], v[208:211]
    buffer_load_dwordx4 a[152:155], v53, s[28:31], s43 offen offset:0
    v_mfma_f32_16x16x32_bf16 v[212:215], v[116:119], a[200:203], v[212:215]
    ds_read_b64_tr_b16 v[92:93], v39 offset:12288
    v_mfma_f32_16x16x32_bf16 v[216:219], v[116:119], a[208:211], v[216:219]
    ds_read_b64_tr_b16 v[94:95], v39 offset:14336
    v_mfma_f32_16x16x32_bf16 v[220:223], v[116:119], a[216:219], v[220:223]
    v_mfma_f32_16x16x32_bf16 v[224:227], v[120:123], a[192:195], v[224:227]
    v_mfma_f32_16x16x32_bf16 v[228:231], v[120:123], a[200:203], v[228:231]
    v_mfma_f32_16x16x32_bf16 v[232:235], v[120:123], a[208:211], v[232:235]
    v_mfma_f32_16x16x32_bf16 v[236:239], v[120:123], a[216:219], v[236:239]
    v_mfma_f32_16x16x32_bf16 v[240:243], v[124:127], a[192:195], v[240:243]
    v_mfma_f32_16x16x32_bf16 v[244:247], v[124:127], a[200:203], v[244:247]
    v_mfma_f32_16x16x32_bf16 v[248:251], v[124:127], a[208:211], v[248:251]
    v_mfma_f32_16x16x32_bf16 v[252:255], v[124:127], a[216:219], v[252:255]
    s_waitcnt lgkmcnt(0)
    v_mfma_f32_16x16x32_bf16 a[0:3], v[64:67], a[196:199], a[0:3]
    ds_read_b64_tr_b16 v[96:97], v16 offset:24576
    v_mfma_f32_16x16x32_bf16 a[4:7], v[64:67], a[204:207], a[4:7]
    ds_read_b64_tr_b16 v[98:99], v16 offset:28672
    v_mfma_f32_16x16x32_bf16 a[8:11], v[64:67], a[212:215], a[8:11]
    s_add_u32 m0, s44, 16384
    s_mov_b32 s50, 2097152
    buffer_load_dwordx4 v50, s[16:19], s50 offen offset:0 lds
    v_mfma_f32_16x16x32_bf16 a[12:15], v[64:67], a[220:223], a[12:15]
    ds_read_b64_tr_b16 v[100:101], v17 offset:24576
    v_mfma_f32_16x16x32_bf16 a[16:19], v[68:71], a[196:199], a[16:19]
    ds_read_b64_tr_b16 v[102:103], v17 offset:28672
    v_mfma_f32_16x16x32_bf16 a[20:23], v[68:71], a[204:207], a[20:23]
    v_mfma_f32_16x16x32_bf16 a[24:27], v[68:71], a[212:215], a[24:27]
    ds_read_b64_tr_b16 v[104:105], v18 offset:24576
    v_mfma_f32_16x16x32_bf16 a[28:31], v[68:71], a[220:223], a[28:31]
    ds_read_b64_tr_b16 v[106:107], v18 offset:28672
    v_mfma_f32_16x16x32_bf16 a[32:35], v[72:75], a[196:199], a[32:35]
    s_mov_b32 s51, 2128896
    buffer_load_dwordx4 v51, s[16:19], s51 offen offset:1024 lds
    v_mfma_f32_16x16x32_bf16 a[36:39], v[72:75], a[204:207], a[36:39]
    ds_read_b64_tr_b16 v[108:109], v19 offset:24576
    v_mfma_f32_16x16x32_bf16 a[40:43], v[72:75], a[212:215], a[40:43]
    ds_read_b64_tr_b16 v[110:111], v19 offset:28672
    v_mfma_f32_16x16x32_bf16 a[44:47], v[72:75], a[220:223], a[44:47]
    v_mfma_f32_16x16x32_bf16 a[48:51], v[76:79], a[196:199], a[48:51]
    ds_read_b64_tr_b16 v[112:113], v20 offset:24576
    v_mfma_f32_16x16x32_bf16 a[52:55], v[76:79], a[204:207], a[52:55]
    ds_read_b64_tr_b16 v[114:115], v20 offset:28672
    v_mfma_f32_16x16x32_bf16 a[56:59], v[76:79], a[212:215], a[56:59]
    s_mov_b32 s50, 2160640
    buffer_load_dwordx4 v50, s[16:19], s50 offen offset:2048 lds
    v_mfma_f32_16x16x32_bf16 a[60:63], v[76:79], a[220:223], a[60:63]
    ds_read_b64_tr_b16 v[116:117], v21 offset:24576
    v_mfma_f32_16x16x32_bf16 a[64:67], v[80:83], a[196:199], a[64:67]
    ds_read_b64_tr_b16 v[118:119], v21 offset:28672
    v_mfma_f32_16x16x32_bf16 a[68:71], v[80:83], a[204:207], a[68:71]
    v_mfma_f32_16x16x32_bf16 a[72:75], v[80:83], a[212:215], a[72:75]
    ds_read_b64_tr_b16 v[120:121], v22 offset:24576
    v_mfma_f32_16x16x32_bf16 a[76:79], v[80:83], a[220:223], a[76:79]
    ds_read_b64_tr_b16 v[122:123], v22 offset:28672
    v_mfma_f32_16x16x32_bf16 a[80:83], v[84:87], a[196:199], a[80:83]
    s_mov_b32 s51, 2192384
    buffer_load_dwordx4 v51, s[16:19], s51 offen offset:3072 lds
    v_mfma_f32_16x16x32_bf16 a[84:87], v[84:87], a[204:207], a[84:87]
    ds_read_b64_tr_b16 v[124:125], v23 offset:24576
    v_mfma_f32_16x16x32_bf16 a[88:91], v[84:87], a[212:215], a[88:91]
    ds_read_b64_tr_b16 v[126:127], v23 offset:28672
    v_mfma_f32_16x16x32_bf16 a[92:95], v[84:87], a[220:223], a[92:95]
    v_mfma_f32_16x16x32_bf16 a[96:99], v[88:91], a[196:199], a[96:99]
    v_mfma_f32_16x16x32_bf16 a[100:103], v[88:91], a[204:207], a[100:103]
    v_mfma_f32_16x16x32_bf16 a[104:107], v[88:91], a[212:215], a[104:107]
    v_mfma_f32_16x16x32_bf16 a[108:111], v[88:91], a[220:223], a[108:111]
    v_mfma_f32_16x16x32_bf16 a[112:115], v[92:95], a[196:199], a[112:115]
    v_mfma_f32_16x16x32_bf16 a[116:119], v[92:95], a[204:207], a[116:119]
    v_mfma_f32_16x16x32_bf16 a[120:123], v[92:95], a[212:215], a[120:123]
    v_mfma_f32_16x16x32_bf16 a[124:127], v[92:95], a[220:223], a[124:127]
    s_waitcnt vmcnt(16) lgkmcnt(0)
    s_barrier
    v_mfma_f32_16x16x32_bf16 v[128:131], v[96:99], a[196:199], v[128:131]
    ds_read_b64_tr_b16 v[64:65], v36 offset:32768
    v_mfma_f32_16x16x32_bf16 v[132:135], v[96:99], a[204:207], v[132:135]
    ds_read_b64_tr_b16 v[66:67], v36 offset:34816
    v_mfma_f32_16x16x32_bf16 v[136:139], v[96:99], a[212:215], v[136:139]
    buffer_load_dwordx4 a[132:135], v53, s[28:31], s40 offen offset:1024
    v_mfma_f32_16x16x32_bf16 v[140:143], v[96:99], a[220:223], v[140:143]
    ds_read_b64_tr_b16 v[68:69], v37 offset:32768
    v_mfma_f32_16x16x32_bf16 v[144:147], v[100:103], a[196:199], v[144:147]
    ds_read_b64_tr_b16 v[70:71], v37 offset:34816
    v_mfma_f32_16x16x32_bf16 v[148:151], v[100:103], a[204:207], v[148:151]
    v_mfma_f32_16x16x32_bf16 v[152:155], v[100:103], a[212:215], v[152:155]
    ds_read_b64_tr_b16 v[72:73], v38 offset:32768
    v_mfma_f32_16x16x32_bf16 v[156:159], v[100:103], a[220:223], v[156:159]
    ds_read_b64_tr_b16 v[74:75], v38 offset:34816
    v_mfma_f32_16x16x32_bf16 v[160:163], v[104:107], a[196:199], v[160:163]
    buffer_load_dwordx4 a[140:143], v53, s[28:31], s41 offen offset:1024
    v_mfma_f32_16x16x32_bf16 v[164:167], v[104:107], a[204:207], v[164:167]
    ds_read_b64_tr_b16 v[76:77], v39 offset:32768
    v_mfma_f32_16x16x32_bf16 v[168:171], v[104:107], a[212:215], v[168:171]
    ds_read_b64_tr_b16 v[78:79], v39 offset:34816
    v_mfma_f32_16x16x32_bf16 v[172:175], v[104:107], a[220:223], v[172:175]
    v_mfma_f32_16x16x32_bf16 v[176:179], v[108:111], a[196:199], v[176:179]
    ds_read_b64_tr_b16 v[80:81], v36 offset:40960
    v_mfma_f32_16x16x32_bf16 v[180:183], v[108:111], a[204:207], v[180:183]
    ds_read_b64_tr_b16 v[82:83], v36 offset:43008
    v_mfma_f32_16x16x32_bf16 v[184:187], v[108:111], a[212:215], v[184:187]
    buffer_load_dwordx4 a[148:151], v53, s[28:31], s42 offen offset:1024
    v_mfma_f32_16x16x32_bf16 v[188:191], v[108:111], a[220:223], v[188:191]
    ds_read_b64_tr_b16 v[84:85], v37 offset:40960
    v_mfma_f32_16x16x32_bf16 v[192:195], v[112:115], a[196:199], v[192:195]
    ds_read_b64_tr_b16 v[86:87], v37 offset:43008
    v_mfma_f32_16x16x32_bf16 v[196:199], v[112:115], a[204:207], v[196:199]
    v_mfma_f32_16x16x32_bf16 v[200:203], v[112:115], a[212:215], v[200:203]
    ds_read_b64_tr_b16 v[88:89], v38 offset:40960
    v_mfma_f32_16x16x32_bf16 v[204:207], v[112:115], a[220:223], v[204:207]
    ds_read_b64_tr_b16 v[90:91], v38 offset:43008
    v_mfma_f32_16x16x32_bf16 v[208:211], v[116:119], a[196:199], v[208:211]
    buffer_load_dwordx4 a[156:159], v53, s[28:31], s43 offen offset:1024
    v_mfma_f32_16x16x32_bf16 v[212:215], v[116:119], a[204:207], v[212:215]
    ds_read_b64_tr_b16 v[92:93], v39 offset:40960
    v_mfma_f32_16x16x32_bf16 v[216:219], v[116:119], a[212:215], v[216:219]
    ds_read_b64_tr_b16 v[94:95], v39 offset:43008
    v_mfma_f32_16x16x32_bf16 v[220:223], v[116:119], a[220:223], v[220:223]
    v_mfma_f32_16x16x32_bf16 v[224:227], v[120:123], a[196:199], v[224:227]
    v_mfma_f32_16x16x32_bf16 v[228:231], v[120:123], a[204:207], v[228:231]
    v_mfma_f32_16x16x32_bf16 v[232:235], v[120:123], a[212:215], v[232:235]
    v_mfma_f32_16x16x32_bf16 v[236:239], v[120:123], a[220:223], v[236:239]
    v_mfma_f32_16x16x32_bf16 v[240:243], v[124:127], a[196:199], v[240:243]
    v_mfma_f32_16x16x32_bf16 v[244:247], v[124:127], a[204:207], v[244:247]
    v_mfma_f32_16x16x32_bf16 v[248:251], v[124:127], a[212:215], v[248:251]
    v_mfma_f32_16x16x32_bf16 v[252:255], v[124:127], a[220:223], v[252:255]
    s_waitcnt vmcnt(16) lgkmcnt(0)
    v_mfma_f32_16x16x32_bf16 a[0:3], v[64:67], a[224:227], a[0:3]
    ds_read_b64_tr_b16 v[96:97], v16 offset:49152
    v_mfma_f32_16x16x32_bf16 a[4:7], v[64:67], a[232:235], a[4:7]
    ds_read_b64_tr_b16 v[98:99], v16 offset:53248
    v_mfma_f32_16x16x32_bf16 a[8:11], v[64:67], a[240:243], a[8:11]
    s_add_u32 m0, s45, 32768
    s_mov_b32 s50, 1146880
    buffer_load_dwordx4 v52, s[20:23], s50 offen offset:0 lds
    v_mfma_f32_16x16x32_bf16 a[12:15], v[64:67], a[248:251], a[12:15]
    ds_read_b64_tr_b16 v[100:101], v17 offset:49152
    v_mfma_f32_16x16x32_bf16 a[16:19], v[68:71], a[224:227], a[16:19]
    ds_read_b64_tr_b16 v[102:103], v17 offset:53248
    v_mfma_f32_16x16x32_bf16 a[20:23], v[68:71], a[232:235], a[20:23]
    v_mfma_f32_16x16x32_bf16 a[24:27], v[68:71], a[240:243], a[24:27]
    ds_read_b64_tr_b16 v[104:105], v18 offset:49152
    v_mfma_f32_16x16x32_bf16 a[28:31], v[68:71], a[248:251], a[28:31]
    ds_read_b64_tr_b16 v[106:107], v18 offset:53248
    v_mfma_f32_16x16x32_bf16 a[32:35], v[72:75], a[224:227], a[32:35]
    s_mov_b32 s51, 1174528
    buffer_load_dwordx4 v52, s[20:23], s51 offen offset:1024 lds
    v_mfma_f32_16x16x32_bf16 a[36:39], v[72:75], a[232:235], a[36:39]
    ds_read_b64_tr_b16 v[108:109], v19 offset:49152
    v_mfma_f32_16x16x32_bf16 a[40:43], v[72:75], a[240:243], a[40:43]
    ds_read_b64_tr_b16 v[110:111], v19 offset:53248
    v_mfma_f32_16x16x32_bf16 a[44:47], v[72:75], a[248:251], a[44:47]
    v_mfma_f32_16x16x32_bf16 a[48:51], v[76:79], a[224:227], a[48:51]
    ds_read_b64_tr_b16 v[112:113], v20 offset:49152
    v_mfma_f32_16x16x32_bf16 a[52:55], v[76:79], a[232:235], a[52:55]
    ds_read_b64_tr_b16 v[114:115], v20 offset:53248
    v_mfma_f32_16x16x32_bf16 a[56:59], v[76:79], a[240:243], a[56:59]
    s_add_u32 m0, s45, 40960
    s_mov_b32 s50, 1146880
    buffer_load_dwordx4 v52, s[24:27], s50 offen offset:0 lds
    v_mfma_f32_16x16x32_bf16 a[60:63], v[76:79], a[248:251], a[60:63]
    ds_read_b64_tr_b16 v[116:117], v21 offset:49152
    v_mfma_f32_16x16x32_bf16 a[64:67], v[80:83], a[224:227], a[64:67]
    ds_read_b64_tr_b16 v[118:119], v21 offset:53248
    v_mfma_f32_16x16x32_bf16 a[68:71], v[80:83], a[232:235], a[68:71]
    v_mfma_f32_16x16x32_bf16 a[72:75], v[80:83], a[240:243], a[72:75]
    ds_read_b64_tr_b16 v[120:121], v22 offset:49152
    v_mfma_f32_16x16x32_bf16 a[76:79], v[80:83], a[248:251], a[76:79]
    ds_read_b64_tr_b16 v[122:123], v22 offset:53248
    v_mfma_f32_16x16x32_bf16 a[80:83], v[84:87], a[224:227], a[80:83]
    s_mov_b32 s51, 1174528
    buffer_load_dwordx4 v52, s[24:27], s51 offen offset:1024 lds
    v_mfma_f32_16x16x32_bf16 a[84:87], v[84:87], a[232:235], a[84:87]
    ds_read_b64_tr_b16 v[124:125], v23 offset:49152
    v_mfma_f32_16x16x32_bf16 a[88:91], v[84:87], a[240:243], a[88:91]
    ds_read_b64_tr_b16 v[126:127], v23 offset:53248
    v_mfma_f32_16x16x32_bf16 a[92:95], v[84:87], a[248:251], a[92:95]
    v_mfma_f32_16x16x32_bf16 a[96:99], v[88:91], a[224:227], a[96:99]
    v_mfma_f32_16x16x32_bf16 a[100:103], v[88:91], a[232:235], a[100:103]
    v_mfma_f32_16x16x32_bf16 a[104:107], v[88:91], a[240:243], a[104:107]
    v_mfma_f32_16x16x32_bf16 a[108:111], v[88:91], a[248:251], a[108:111]
    v_mfma_f32_16x16x32_bf16 a[112:115], v[92:95], a[224:227], a[112:115]
    v_mfma_f32_16x16x32_bf16 a[116:119], v[92:95], a[232:235], a[116:119]
    v_mfma_f32_16x16x32_bf16 a[120:123], v[92:95], a[240:243], a[120:123]
    v_mfma_f32_16x16x32_bf16 a[124:127], v[92:95], a[248:251], a[124:127]
    s_waitcnt lgkmcnt(0)
    v_mfma_f32_16x16x32_bf16 v[128:131], v[96:99], a[224:227], v[128:131]
    ds_read_b64_tr_b16 v[64:65], v36 offset:36864
    v_mfma_f32_16x16x32_bf16 v[132:135], v[96:99], a[232:235], v[132:135]
    ds_read_b64_tr_b16 v[66:67], v36 offset:38912
    v_mfma_f32_16x16x32_bf16 v[136:139], v[96:99], a[240:243], v[136:139]
    v_add_u32 v53, 2048, v53
    buffer_load_dwordx4 a[160:163], v53, s[28:31], s40 offen offset:0
    v_mfma_f32_16x16x32_bf16 v[140:143], v[96:99], a[248:251], v[140:143]
    ds_read_b64_tr_b16 v[68:69], v37 offset:36864
    v_mfma_f32_16x16x32_bf16 v[144:147], v[100:103], a[224:227], v[144:147]
    ds_read_b64_tr_b16 v[70:71], v37 offset:38912
    v_mfma_f32_16x16x32_bf16 v[148:151], v[100:103], a[232:235], v[148:151]
    v_mfma_f32_16x16x32_bf16 v[152:155], v[100:103], a[240:243], v[152:155]
    ds_read_b64_tr_b16 v[72:73], v38 offset:36864
    v_mfma_f32_16x16x32_bf16 v[156:159], v[100:103], a[248:251], v[156:159]
    ds_read_b64_tr_b16 v[74:75], v38 offset:38912
    v_mfma_f32_16x16x32_bf16 v[160:163], v[104:107], a[224:227], v[160:163]
    buffer_load_dwordx4 a[168:171], v53, s[28:31], s41 offen offset:0
    v_mfma_f32_16x16x32_bf16 v[164:167], v[104:107], a[232:235], v[164:167]
    ds_read_b64_tr_b16 v[76:77], v39 offset:36864
    v_mfma_f32_16x16x32_bf16 v[168:171], v[104:107], a[240:243], v[168:171]
    ds_read_b64_tr_b16 v[78:79], v39 offset:38912
    v_mfma_f32_16x16x32_bf16 v[172:175], v[104:107], a[248:251], v[172:175]
    v_mfma_f32_16x16x32_bf16 v[176:179], v[108:111], a[224:227], v[176:179]
    ds_read_b64_tr_b16 v[80:81], v36 offset:45056
    v_mfma_f32_16x16x32_bf16 v[180:183], v[108:111], a[232:235], v[180:183]
    ds_read_b64_tr_b16 v[82:83], v36 offset:47104
    v_mfma_f32_16x16x32_bf16 v[184:187], v[108:111], a[240:243], v[184:187]
    buffer_load_dwordx4 a[176:179], v53, s[28:31], s42 offen offset:0
    v_mfma_f32_16x16x32_bf16 v[188:191], v[108:111], a[248:251], v[188:191]
    ds_read_b64_tr_b16 v[84:85], v37 offset:45056
    v_mfma_f32_16x16x32_bf16 v[192:195], v[112:115], a[224:227], v[192:195]
    ds_read_b64_tr_b16 v[86:87], v37 offset:47104
    v_mfma_f32_16x16x32_bf16 v[196:199], v[112:115], a[232:235], v[196:199]
    v_mfma_f32_16x16x32_bf16 v[200:203], v[112:115], a[240:243], v[200:203]
    ds_read_b64_tr_b16 v[88:89], v38 offset:45056
    v_mfma_f32_16x16x32_bf16 v[204:207], v[112:115], a[248:251], v[204:207]
    ds_read_b64_tr_b16 v[90:91], v38 offset:47104
    v_mfma_f32_16x16x32_bf16 v[208:211], v[116:119], a[224:227], v[208:211]
    buffer_load_dwordx4 a[184:187], v53, s[28:31], s43 offen offset:0
    v_mfma_f32_16x16x32_bf16 v[212:215], v[116:119], a[232:235], v[212:215]
    ds_read_b64_tr_b16 v[92:93], v39 offset:45056
    v_mfma_f32_16x16x32_bf16 v[216:219], v[116:119], a[240:243], v[216:219]
    ds_read_b64_tr_b16 v[94:95], v39 offset:47104
    v_mfma_f32_16x16x32_bf16 v[220:223], v[116:119], a[248:251], v[220:223]
    v_mfma_f32_16x16x32_bf16 v[224:227], v[120:123], a[224:227], v[224:227]
    v_mfma_f32_16x16x32_bf16 v[228:231], v[120:123], a[232:235], v[228:231]
    v_mfma_f32_16x16x32_bf16 v[232:235], v[120:123], a[240:243], v[232:235]
    v_mfma_f32_16x16x32_bf16 v[236:239], v[120:123], a[248:251], v[236:239]
    v_mfma_f32_16x16x32_bf16 v[240:243], v[124:127], a[224:227], v[240:243]
    v_mfma_f32_16x16x32_bf16 v[244:247], v[124:127], a[232:235], v[244:247]
    v_mfma_f32_16x16x32_bf16 v[248:251], v[124:127], a[240:243], v[248:251]
    v_mfma_f32_16x16x32_bf16 v[252:255], v[124:127], a[248:251], v[252:255]
    s_waitcnt lgkmcnt(0)
    v_mfma_f32_16x16x32_bf16 a[0:3], v[64:67], a[228:231], a[0:3]
    ds_read_b64_tr_b16 v[96:97], v16 offset:57344
    v_mfma_f32_16x16x32_bf16 a[4:7], v[64:67], a[236:239], a[4:7]
    ds_read_b64_tr_b16 v[98:99], v16 offset:61440
    v_mfma_f32_16x16x32_bf16 a[8:11], v[64:67], a[244:247], a[8:11]
    s_add_u32 m0, s44, 49152
    s_mov_b32 s50, 2621440
    buffer_load_dwordx4 v50, s[16:19], s50 offen offset:0 lds
    v_mfma_f32_16x16x32_bf16 a[12:15], v[64:67], a[252:255], a[12:15]
    ds_read_b64_tr_b16 v[100:101], v17 offset:57344
    v_mfma_f32_16x16x32_bf16 a[16:19], v[68:71], a[228:231], a[16:19]
    ds_read_b64_tr_b16 v[102:103], v17 offset:61440
    v_mfma_f32_16x16x32_bf16 a[20:23], v[68:71], a[236:239], a[20:23]
    v_mfma_f32_16x16x32_bf16 a[24:27], v[68:71], a[244:247], a[24:27]
    ds_read_b64_tr_b16 v[104:105], v18 offset:57344
    v_mfma_f32_16x16x32_bf16 a[28:31], v[68:71], a[252:255], a[28:31]
    ds_read_b64_tr_b16 v[106:107], v18 offset:61440
    v_mfma_f32_16x16x32_bf16 a[32:35], v[72:75], a[228:231], a[32:35]
    s_mov_b32 s51, 2653184
    buffer_load_dwordx4 v51, s[16:19], s51 offen offset:1024 lds
    v_mfma_f32_16x16x32_bf16 a[36:39], v[72:75], a[236:239], a[36:39]
    ds_read_b64_tr_b16 v[108:109], v19 offset:57344
    v_mfma_f32_16x16x32_bf16 a[40:43], v[72:75], a[244:247], a[40:43]
    ds_read_b64_tr_b16 v[110:111], v19 offset:61440
    v_mfma_f32_16x16x32_bf16 a[44:47], v[72:75], a[252:255], a[44:47]
    v_mfma_f32_16x16x32_bf16 a[48:51], v[76:79], a[228:231], a[48:51]
    ds_read_b64_tr_b16 v[112:113], v20 offset:57344
    v_mfma_f32_16x16x32_bf16 a[52:55], v[76:79], a[236:239], a[52:55]
    ds_read_b64_tr_b16 v[114:115], v20 offset:61440
    v_mfma_f32_16x16x32_bf16 a[56:59], v[76:79], a[244:247], a[56:59]
    s_mov_b32 s50, 2684928
    buffer_load_dwordx4 v50, s[16:19], s50 offen offset:2048 lds
    v_mfma_f32_16x16x32_bf16 a[60:63], v[76:79], a[252:255], a[60:63]
    ds_read_b64_tr_b16 v[116:117], v21 offset:57344
    v_mfma_f32_16x16x32_bf16 a[64:67], v[80:83], a[228:231], a[64:67]
    ds_read_b64_tr_b16 v[118:119], v21 offset:61440
    v_mfma_f32_16x16x32_bf16 a[68:71], v[80:83], a[236:239], a[68:71]
    v_mfma_f32_16x16x32_bf16 a[72:75], v[80:83], a[244:247], a[72:75]
    ds_read_b64_tr_b16 v[120:121], v22 offset:57344
    v_mfma_f32_16x16x32_bf16 a[76:79], v[80:83], a[252:255], a[76:79]
    ds_read_b64_tr_b16 v[122:123], v22 offset:61440
    v_mfma_f32_16x16x32_bf16 a[80:83], v[84:87], a[228:231], a[80:83]
    s_mov_b32 s51, 2716672
    buffer_load_dwordx4 v51, s[16:19], s51 offen offset:3072 lds
    v_mfma_f32_16x16x32_bf16 a[84:87], v[84:87], a[236:239], a[84:87]
    ds_read_b64_tr_b16 v[124:125], v23 offset:57344
    v_mfma_f32_16x16x32_bf16 a[88:91], v[84:87], a[244:247], a[88:91]
    ds_read_b64_tr_b16 v[126:127], v23 offset:61440
    v_mfma_f32_16x16x32_bf16 a[92:95], v[84:87], a[252:255], a[92:95]
    v_mfma_f32_16x16x32_bf16 a[96:99], v[88:91], a[228:231], a[96:99]
    v_mfma_f32_16x16x32_bf16 a[100:103], v[88:91], a[236:239], a[100:103]
    v_mfma_f32_16x16x32_bf16 a[104:107], v[88:91], a[244:247], a[104:107]
    v_mfma_f32_16x16x32_bf16 a[108:111], v[88:91], a[252:255], a[108:111]
    v_mfma_f32_16x16x32_bf16 a[112:115], v[92:95], a[228:231], a[112:115]
    v_mfma_f32_16x16x32_bf16 a[116:119], v[92:95], a[236:239], a[116:119]
    v_mfma_f32_16x16x32_bf16 a[120:123], v[92:95], a[244:247], a[120:123]
    v_mfma_f32_16x16x32_bf16 a[124:127], v[92:95], a[252:255], a[124:127]
    s_waitcnt vmcnt(16) lgkmcnt(0)
    s_barrier
    v_mfma_f32_16x16x32_bf16 v[128:131], v[96:99], a[228:231], v[128:131]
    ds_read_b64_tr_b16 v[64:65], v32 offset:0
    v_mfma_f32_16x16x32_bf16 v[132:135], v[96:99], a[236:239], v[132:135]
    ds_read_b64_tr_b16 v[66:67], v32 offset:2048
    v_mfma_f32_16x16x32_bf16 v[136:139], v[96:99], a[244:247], v[136:139]
    buffer_load_dwordx4 a[164:167], v53, s[28:31], s40 offen offset:1024
    v_mfma_f32_16x16x32_bf16 v[140:143], v[96:99], a[252:255], v[140:143]
    ds_read_b64_tr_b16 v[68:69], v33 offset:0
    v_mfma_f32_16x16x32_bf16 v[144:147], v[100:103], a[228:231], v[144:147]
    ds_read_b64_tr_b16 v[70:71], v33 offset:2048
    v_mfma_f32_16x16x32_bf16 v[148:151], v[100:103], a[236:239], v[148:151]
    v_mfma_f32_16x16x32_bf16 v[152:155], v[100:103], a[244:247], v[152:155]
    ds_read_b64_tr_b16 v[72:73], v34 offset:0
    v_mfma_f32_16x16x32_bf16 v[156:159], v[100:103], a[252:255], v[156:159]
    ds_read_b64_tr_b16 v[74:75], v34 offset:2048
    v_mfma_f32_16x16x32_bf16 v[160:163], v[104:107], a[228:231], v[160:163]
    buffer_load_dwordx4 a[172:175], v53, s[28:31], s41 offen offset:1024
    v_mfma_f32_16x16x32_bf16 v[164:167], v[104:107], a[236:239], v[164:167]
    ds_read_b64_tr_b16 v[76:77], v35 offset:0
    v_mfma_f32_16x16x32_bf16 v[168:171], v[104:107], a[244:247], v[168:171]
    ds_read_b64_tr_b16 v[78:79], v35 offset:2048
    v_mfma_f32_16x16x32_bf16 v[172:175], v[104:107], a[252:255], v[172:175]
    v_mfma_f32_16x16x32_bf16 v[176:179], v[108:111], a[228:231], v[176:179]
    ds_read_b64_tr_b16 v[80:81], v32 offset:8192
    v_mfma_f32_16x16x32_bf16 v[180:183], v[108:111], a[236:239], v[180:183]
    ds_read_b64_tr_b16 v[82:83], v32 offset:10240
    v_mfma_f32_16x16x32_bf16 v[184:187], v[108:111], a[244:247], v[184:187]
    buffer_load_dwordx4 a[180:183], v53, s[28:31], s42 offen offset:1024
    v_mfma_f32_16x16x32_bf16 v[188:191], v[108:111], a[252:255], v[188:191]
    ds_read_b64_tr_b16 v[84:85], v33 offset:8192
    v_mfma_f32_16x16x32_bf16 v[192:195], v[112:115], a[228:231], v[192:195]
    ds_read_b64_tr_b16 v[86:87], v33 offset:10240
    v_mfma_f32_16x16x32_bf16 v[196:199], v[112:115], a[236:239], v[196:199]
    v_mfma_f32_16x16x32_bf16 v[200:203], v[112:115], a[244:247], v[200:203]
    ds_read_b64_tr_b16 v[88:89], v34 offset:8192
    v_mfma_f32_16x16x32_bf16 v[204:207], v[112:115], a[252:255], v[204:207]
    ds_read_b64_tr_b16 v[90:91], v34 offset:10240
    v_mfma_f32_16x16x32_bf16 v[208:211], v[116:119], a[228:231], v[208:211]
    buffer_load_dwordx4 a[188:191], v53, s[28:31], s43 offen offset:1024
    v_mfma_f32_16x16x32_bf16 v[212:215], v[116:119], a[236:239], v[212:215]
    ds_read_b64_tr_b16 v[92:93], v35 offset:8192
    v_mfma_f32_16x16x32_bf16 v[216:219], v[116:119], a[244:247], v[216:219]
    ds_read_b64_tr_b16 v[94:95], v35 offset:10240
    v_mfma_f32_16x16x32_bf16 v[220:223], v[116:119], a[252:255], v[220:223]
    v_mfma_f32_16x16x32_bf16 v[224:227], v[120:123], a[228:231], v[224:227]
    v_mfma_f32_16x16x32_bf16 v[228:231], v[120:123], a[236:239], v[228:231]
    v_mfma_f32_16x16x32_bf16 v[232:235], v[120:123], a[244:247], v[232:235]
    v_mfma_f32_16x16x32_bf16 v[236:239], v[120:123], a[252:255], v[236:239]
    v_mfma_f32_16x16x32_bf16 v[240:243], v[124:127], a[228:231], v[240:243]
    v_mfma_f32_16x16x32_bf16 v[244:247], v[124:127], a[236:239], v[244:247]
    v_mfma_f32_16x16x32_bf16 v[248:251], v[124:127], a[244:247], v[248:251]
    v_mfma_f32_16x16x32_bf16 v[252:255], v[124:127], a[252:255], v[252:255]
    s_waitcnt vmcnt(16) lgkmcnt(0)
    v_mfma_f32_16x16x32_bf16 a[0:3], v[64:67], a[128:131], a[0:3]
    ds_read_b64_tr_b16 v[96:97], v24 offset:16384
    v_mfma_f32_16x16x32_bf16 a[4:7], v[64:67], a[136:139], a[4:7]
    ds_read_b64_tr_b16 v[98:99], v24 offset:20480
    v_mfma_f32_16x16x32_bf16 a[8:11], v[64:67], a[144:147], a[8:11]
    s_add_u32 m0, s45, 65536
    s_mov_b32 s50, 1376256
    buffer_load_dwordx4 v52, s[20:23], s50 offen offset:0 lds
    v_mfma_f32_16x16x32_bf16 a[12:15], v[64:67], a[152:155], a[12:15]
    ds_read_b64_tr_b16 v[100:101], v25 offset:16384
    v_mfma_f32_16x16x32_bf16 a[16:19], v[68:71], a[128:131], a[16:19]
    ds_read_b64_tr_b16 v[102:103], v25 offset:20480
    v_mfma_f32_16x16x32_bf16 a[20:23], v[68:71], a[136:139], a[20:23]
    v_mfma_f32_16x16x32_bf16 a[24:27], v[68:71], a[144:147], a[24:27]
    ds_read_b64_tr_b16 v[104:105], v26 offset:16384
    v_mfma_f32_16x16x32_bf16 a[28:31], v[68:71], a[152:155], a[28:31]
    ds_read_b64_tr_b16 v[106:107], v26 offset:20480
    v_mfma_f32_16x16x32_bf16 a[32:35], v[72:75], a[128:131], a[32:35]
    s_mov_b32 s51, 1403904
    buffer_load_dwordx4 v52, s[20:23], s51 offen offset:1024 lds
    v_mfma_f32_16x16x32_bf16 a[36:39], v[72:75], a[136:139], a[36:39]
    ds_read_b64_tr_b16 v[108:109], v27 offset:16384
    v_mfma_f32_16x16x32_bf16 a[40:43], v[72:75], a[144:147], a[40:43]
    ds_read_b64_tr_b16 v[110:111], v27 offset:20480
    v_mfma_f32_16x16x32_bf16 a[44:47], v[72:75], a[152:155], a[44:47]
    v_mfma_f32_16x16x32_bf16 a[48:51], v[76:79], a[128:131], a[48:51]
    ds_read_b64_tr_b16 v[112:113], v28 offset:16384
    v_mfma_f32_16x16x32_bf16 a[52:55], v[76:79], a[136:139], a[52:55]
    ds_read_b64_tr_b16 v[114:115], v28 offset:20480
    v_mfma_f32_16x16x32_bf16 a[56:59], v[76:79], a[144:147], a[56:59]
    s_add_u32 m0, s45, 73728
    s_mov_b32 s50, 1376256
    buffer_load_dwordx4 v52, s[24:27], s50 offen offset:0 lds
    v_mfma_f32_16x16x32_bf16 a[60:63], v[76:79], a[152:155], a[60:63]
    ds_read_b64_tr_b16 v[116:117], v29 offset:16384
    v_mfma_f32_16x16x32_bf16 a[64:67], v[80:83], a[128:131], a[64:67]
    ds_read_b64_tr_b16 v[118:119], v29 offset:20480
    v_mfma_f32_16x16x32_bf16 a[68:71], v[80:83], a[136:139], a[68:71]
    v_mfma_f32_16x16x32_bf16 a[72:75], v[80:83], a[144:147], a[72:75]
    ds_read_b64_tr_b16 v[120:121], v30 offset:16384
    v_mfma_f32_16x16x32_bf16 a[76:79], v[80:83], a[152:155], a[76:79]
    ds_read_b64_tr_b16 v[122:123], v30 offset:20480
    v_mfma_f32_16x16x32_bf16 a[80:83], v[84:87], a[128:131], a[80:83]
    s_mov_b32 s51, 1403904
    buffer_load_dwordx4 v52, s[24:27], s51 offen offset:1024 lds
    v_mfma_f32_16x16x32_bf16 a[84:87], v[84:87], a[136:139], a[84:87]
    ds_read_b64_tr_b16 v[124:125], v31 offset:16384
    v_mfma_f32_16x16x32_bf16 a[88:91], v[84:87], a[144:147], a[88:91]
    ds_read_b64_tr_b16 v[126:127], v31 offset:20480
    v_mfma_f32_16x16x32_bf16 a[92:95], v[84:87], a[152:155], a[92:95]
    v_mfma_f32_16x16x32_bf16 a[96:99], v[88:91], a[128:131], a[96:99]
    v_mfma_f32_16x16x32_bf16 a[100:103], v[88:91], a[136:139], a[100:103]
    v_mfma_f32_16x16x32_bf16 a[104:107], v[88:91], a[144:147], a[104:107]
    v_mfma_f32_16x16x32_bf16 a[108:111], v[88:91], a[152:155], a[108:111]
    v_mfma_f32_16x16x32_bf16 a[112:115], v[92:95], a[128:131], a[112:115]
    v_mfma_f32_16x16x32_bf16 a[116:119], v[92:95], a[136:139], a[116:119]
    v_mfma_f32_16x16x32_bf16 a[120:123], v[92:95], a[144:147], a[120:123]
    v_mfma_f32_16x16x32_bf16 a[124:127], v[92:95], a[152:155], a[124:127]
    s_waitcnt lgkmcnt(0)
    v_mfma_f32_16x16x32_bf16 v[128:131], v[96:99], a[128:131], v[128:131]
    ds_read_b64_tr_b16 v[64:65], v32 offset:4096
    v_mfma_f32_16x16x32_bf16 v[132:135], v[96:99], a[136:139], v[132:135]
    ds_read_b64_tr_b16 v[66:67], v32 offset:6144
    v_mfma_f32_16x16x32_bf16 v[136:139], v[96:99], a[144:147], v[136:139]
    v_add_u32 v53, 2048, v53
    buffer_load_dwordx4 a[192:195], v53, s[28:31], s40 offen offset:0
    v_mfma_f32_16x16x32_bf16 v[140:143], v[96:99], a[152:155], v[140:143]
    ds_read_b64_tr_b16 v[68:69], v33 offset:4096
    v_mfma_f32_16x16x32_bf16 v[144:147], v[100:103], a[128:131], v[144:147]
    ds_read_b64_tr_b16 v[70:71], v33 offset:6144
    v_mfma_f32_16x16x32_bf16 v[148:151], v[100:103], a[136:139], v[148:151]
    v_mfma_f32_16x16x32_bf16 v[152:155], v[100:103], a[144:147], v[152:155]
    ds_read_b64_tr_b16 v[72:73], v34 offset:4096
    v_mfma_f32_16x16x32_bf16 v[156:159], v[100:103], a[152:155], v[156:159]
    ds_read_b64_tr_b16 v[74:75], v34 offset:6144
    v_mfma_f32_16x16x32_bf16 v[160:163], v[104:107], a[128:131], v[160:163]
    buffer_load_dwordx4 a[200:203], v53, s[28:31], s41 offen offset:0
    v_mfma_f32_16x16x32_bf16 v[164:167], v[104:107], a[136:139], v[164:167]
    ds_read_b64_tr_b16 v[76:77], v35 offset:4096
    v_mfma_f32_16x16x32_bf16 v[168:171], v[104:107], a[144:147], v[168:171]
    ds_read_b64_tr_b16 v[78:79], v35 offset:6144
    v_mfma_f32_16x16x32_bf16 v[172:175], v[104:107], a[152:155], v[172:175]
    v_mfma_f32_16x16x32_bf16 v[176:179], v[108:111], a[128:131], v[176:179]
    ds_read_b64_tr_b16 v[80:81], v32 offset:12288
    v_mfma_f32_16x16x32_bf16 v[180:183], v[108:111], a[136:139], v[180:183]
    ds_read_b64_tr_b16 v[82:83], v32 offset:14336
    v_mfma_f32_16x16x32_bf16 v[184:187], v[108:111], a[144:147], v[184:187]
    buffer_load_dwordx4 a[208:211], v53, s[28:31], s42 offen offset:0
    v_mfma_f32_16x16x32_bf16 v[188:191], v[108:111], a[152:155], v[188:191]
    ds_read_b64_tr_b16 v[84:85], v33 offset:12288
    v_mfma_f32_16x16x32_bf16 v[192:195], v[112:115], a[128:131], v[192:195]
    ds_read_b64_tr_b16 v[86:87], v33 offset:14336
    v_mfma_f32_16x16x32_bf16 v[196:199], v[112:115], a[136:139], v[196:199]
    v_mfma_f32_16x16x32_bf16 v[200:203], v[112:115], a[144:147], v[200:203]
    ds_read_b64_tr_b16 v[88:89], v34 offset:12288
    v_mfma_f32_16x16x32_bf16 v[204:207], v[112:115], a[152:155], v[204:207]
    ds_read_b64_tr_b16 v[90:91], v34 offset:14336
    v_mfma_f32_16x16x32_bf16 v[208:211], v[116:119], a[128:131], v[208:211]
    buffer_load_dwordx4 a[216:219], v53, s[28:31], s43 offen offset:0
    v_mfma_f32_16x16x32_bf16 v[212:215], v[116:119], a[136:139], v[212:215]
    ds_read_b64_tr_b16 v[92:93], v35 offset:12288
    v_mfma_f32_16x16x32_bf16 v[216:219], v[116:119], a[144:147], v[216:219]
    ds_read_b64_tr_b16 v[94:95], v35 offset:14336
    v_mfma_f32_16x16x32_bf16 v[220:223], v[116:119], a[152:155], v[220:223]
    v_mfma_f32_16x16x32_bf16 v[224:227], v[120:123], a[128:131], v[224:227]
    v_mfma_f32_16x16x32_bf16 v[228:231], v[120:123], a[136:139], v[228:231]
    v_mfma_f32_16x16x32_bf16 v[232:235], v[120:123], a[144:147], v[232:235]
    v_mfma_f32_16x16x32_bf16 v[236:239], v[120:123], a[152:155], v[236:239]
    v_mfma_f32_16x16x32_bf16 v[240:243], v[124:127], a[128:131], v[240:243]
    v_mfma_f32_16x16x32_bf16 v[244:247], v[124:127], a[136:139], v[244:247]
    v_mfma_f32_16x16x32_bf16 v[248:251], v[124:127], a[144:147], v[248:251]
    v_mfma_f32_16x16x32_bf16 v[252:255], v[124:127], a[152:155], v[252:255]
    s_waitcnt lgkmcnt(0)
    v_mfma_f32_16x16x32_bf16 a[0:3], v[64:67], a[132:135], a[0:3]
    ds_read_b64_tr_b16 v[96:97], v24 offset:24576
    v_mfma_f32_16x16x32_bf16 a[4:7], v[64:67], a[140:143], a[4:7]
    ds_read_b64_tr_b16 v[98:99], v24 offset:28672
    v_mfma_f32_16x16x32_bf16 a[8:11], v[64:67], a[148:151], a[8:11]
    s_add_u32 m0, s44, 81920
    s_mov_b32 s50, 3145728
    buffer_load_dwordx4 v50, s[16:19], s50 offen offset:0 lds
    v_mfma_f32_16x16x32_bf16 a[12:15], v[64:67], a[156:159], a[12:15]
    ds_read_b64_tr_b16 v[100:101], v25 offset:24576
    v_mfma_f32_16x16x32_bf16 a[16:19], v[68:71], a[132:135], a[16:19]
    ds_read_b64_tr_b16 v[102:103], v25 offset:28672
    v_mfma_f32_16x16x32_bf16 a[20:23], v[68:71], a[140:143], a[20:23]
    v_mfma_f32_16x16x32_bf16 a[24:27], v[68:71], a[148:151], a[24:27]
    ds_read_b64_tr_b16 v[104:105], v26 offset:24576
    v_mfma_f32_16x16x32_bf16 a[28:31], v[68:71], a[156:159], a[28:31]
    ds_read_b64_tr_b16 v[106:107], v26 offset:28672
    v_mfma_f32_16x16x32_bf16 a[32:35], v[72:75], a[132:135], a[32:35]
    s_mov_b32 s51, 3177472
    buffer_load_dwordx4 v51, s[16:19], s51 offen offset:1024 lds
    v_mfma_f32_16x16x32_bf16 a[36:39], v[72:75], a[140:143], a[36:39]
    ds_read_b64_tr_b16 v[108:109], v27 offset:24576
    v_mfma_f32_16x16x32_bf16 a[40:43], v[72:75], a[148:151], a[40:43]
    ds_read_b64_tr_b16 v[110:111], v27 offset:28672
    v_mfma_f32_16x16x32_bf16 a[44:47], v[72:75], a[156:159], a[44:47]
    v_mfma_f32_16x16x32_bf16 a[48:51], v[76:79], a[132:135], a[48:51]
    ds_read_b64_tr_b16 v[112:113], v28 offset:24576
    v_mfma_f32_16x16x32_bf16 a[52:55], v[76:79], a[140:143], a[52:55]
    ds_read_b64_tr_b16 v[114:115], v28 offset:28672
    v_mfma_f32_16x16x32_bf16 a[56:59], v[76:79], a[148:151], a[56:59]
    s_mov_b32 s50, 3209216
    buffer_load_dwordx4 v50, s[16:19], s50 offen offset:2048 lds
    v_mfma_f32_16x16x32_bf16 a[60:63], v[76:79], a[156:159], a[60:63]
    ds_read_b64_tr_b16 v[116:117], v29 offset:24576
    v_mfma_f32_16x16x32_bf16 a[64:67], v[80:83], a[132:135], a[64:67]
    ds_read_b64_tr_b16 v[118:119], v29 offset:28672
    v_mfma_f32_16x16x32_bf16 a[68:71], v[80:83], a[140:143], a[68:71]
    v_mfma_f32_16x16x32_bf16 a[72:75], v[80:83], a[148:151], a[72:75]
    ds_read_b64_tr_b16 v[120:121], v30 offset:24576
    v_mfma_f32_16x16x32_bf16 a[76:79], v[80:83], a[156:159], a[76:79]
    ds_read_b64_tr_b16 v[122:123], v30 offset:28672
    v_mfma_f32_16x16x32_bf16 a[80:83], v[84:87], a[132:135], a[80:83]
    s_mov_b32 s51, 3240960
    buffer_load_dwordx4 v51, s[16:19], s51 offen offset:3072 lds
    v_mfma_f32_16x16x32_bf16 a[84:87], v[84:87], a[140:143], a[84:87]
    ds_read_b64_tr_b16 v[124:125], v31 offset:24576
    v_mfma_f32_16x16x32_bf16 a[88:91], v[84:87], a[148:151], a[88:91]
    ds_read_b64_tr_b16 v[126:127], v31 offset:28672
    v_mfma_f32_16x16x32_bf16 a[92:95], v[84:87], a[156:159], a[92:95]
    v_mfma_f32_16x16x32_bf16 a[96:99], v[88:91], a[132:135], a[96:99]
    v_mfma_f32_16x16x32_bf16 a[100:103], v[88:91], a[140:143], a[100:103]
    v_mfma_f32_16x16x32_bf16 a[104:107], v[88:91], a[148:151], a[104:107]
    v_mfma_f32_16x16x32_bf16 a[108:111], v[88:91], a[156:159], a[108:111]
    v_mfma_f32_16x16x32_bf16 a[112:115], v[92:95], a[132:135], a[112:115]
    v_mfma_f32_16x16x32_bf16 a[116:119], v[92:95], a[140:143], a[116:119]
    v_mfma_f32_16x16x32_bf16 a[120:123], v[92:95], a[148:151], a[120:123]
    v_mfma_f32_16x16x32_bf16 a[124:127], v[92:95], a[156:159], a[124:127]
    s_waitcnt vmcnt(16) lgkmcnt(0)
    s_barrier
    v_mfma_f32_16x16x32_bf16 v[128:131], v[96:99], a[132:135], v[128:131]
    ds_read_b64_tr_b16 v[64:65], v32 offset:32768
    v_mfma_f32_16x16x32_bf16 v[132:135], v[96:99], a[140:143], v[132:135]
    ds_read_b64_tr_b16 v[66:67], v32 offset:34816
    v_mfma_f32_16x16x32_bf16 v[136:139], v[96:99], a[148:151], v[136:139]
    buffer_load_dwordx4 a[196:199], v53, s[28:31], s40 offen offset:1024
    v_mfma_f32_16x16x32_bf16 v[140:143], v[96:99], a[156:159], v[140:143]
    ds_read_b64_tr_b16 v[68:69], v33 offset:32768
    v_mfma_f32_16x16x32_bf16 v[144:147], v[100:103], a[132:135], v[144:147]
    ds_read_b64_tr_b16 v[70:71], v33 offset:34816
    v_mfma_f32_16x16x32_bf16 v[148:151], v[100:103], a[140:143], v[148:151]
    buffer_load_dwordx4 a[204:207], v53, s[28:31], s41 offen offset:1024
    v_mfma_f32_16x16x32_bf16 v[152:155], v[100:103], a[148:151], v[152:155]
    ds_read_b64_tr_b16 v[72:73], v34 offset:32768
    v_mfma_f32_16x16x32_bf16 v[156:159], v[100:103], a[156:159], v[156:159]
    ds_read_b64_tr_b16 v[74:75], v34 offset:34816
    v_mfma_f32_16x16x32_bf16 v[160:163], v[104:107], a[132:135], v[160:163]
    buffer_load_dwordx4 a[212:215], v53, s[28:31], s42 offen offset:1024
    v_mfma_f32_16x16x32_bf16 v[164:167], v[104:107], a[140:143], v[164:167]
    ds_read_b64_tr_b16 v[76:77], v35 offset:32768
    v_mfma_f32_16x16x32_bf16 v[168:171], v[104:107], a[148:151], v[168:171]
    ds_read_b64_tr_b16 v[78:79], v35 offset:34816
    v_mfma_f32_16x16x32_bf16 v[172:175], v[104:107], a[156:159], v[172:175]
    buffer_load_dwordx4 a[220:223], v53, s[28:31], s43 offen offset:1024
    v_mfma_f32_16x16x32_bf16 v[176:179], v[108:111], a[132:135], v[176:179]
    ds_read_b64_tr_b16 v[80:81], v32 offset:40960
    v_mfma_f32_16x16x32_bf16 v[180:183], v[108:111], a[140:143], v[180:183]
    ds_read_b64_tr_b16 v[82:83], v32 offset:43008
    v_mfma_f32_16x16x32_bf16 v[184:187], v[108:111], a[148:151], v[184:187]
    s_add_u32 m0, s44, 0
    s_mov_b32 s52, 0
    buffer_load_dwordx4 v44, s[8:11], s52 offen offset:0 lds
    v_mfma_f32_16x16x32_bf16 v[188:191], v[108:111], a[156:159], v[188:191]
    ds_read_b64_tr_b16 v[84:85], v33 offset:40960
    v_mfma_f32_16x16x32_bf16 v[192:195], v[112:115], a[132:135], v[192:195]
    ds_read_b64_tr_b16 v[86:87], v33 offset:43008
    v_mfma_f32_16x16x32_bf16 v[196:199], v[112:115], a[140:143], v[196:199]
    buffer_load_dwordx4 v45, s[8:11], s52 offen offset:1024 lds
    v_mfma_f32_16x16x32_bf16 v[200:203], v[112:115], a[148:151], v[200:203]
    ds_read_b64_tr_b16 v[88:89], v34 offset:40960
    v_mfma_f32_16x16x32_bf16 v[204:207], v[112:115], a[156:159], v[204:207]
    ds_read_b64_tr_b16 v[90:91], v34 offset:43008
    v_mfma_f32_16x16x32_bf16 v[208:211], v[116:119], a[132:135], v[208:211]
    buffer_load_dwordx4 v46, s[8:11], s52 offen offset:2048 lds
    v_mfma_f32_16x16x32_bf16 v[212:215], v[116:119], a[140:143], v[212:215]
    ds_read_b64_tr_b16 v[92:93], v35 offset:40960
    v_mfma_f32_16x16x32_bf16 v[216:219], v[116:119], a[148:151], v[216:219]
    ds_read_b64_tr_b16 v[94:95], v35 offset:43008
    v_mfma_f32_16x16x32_bf16 v[220:223], v[116:119], a[156:159], v[220:223]
    buffer_load_dwordx4 v47, s[8:11], s52 offen offset:3072 lds
    v_mfma_f32_16x16x32_bf16 v[224:227], v[120:123], a[132:135], v[224:227]
    v_mfma_f32_16x16x32_bf16 v[228:231], v[120:123], a[140:143], v[228:231]
    v_mfma_f32_16x16x32_bf16 v[232:235], v[120:123], a[148:151], v[232:235]
    v_mfma_f32_16x16x32_bf16 v[236:239], v[120:123], a[156:159], v[236:239]
    v_mfma_f32_16x16x32_bf16 v[240:243], v[124:127], a[132:135], v[240:243]
    v_mfma_f32_16x16x32_bf16 v[244:247], v[124:127], a[140:143], v[244:247]
    v_mfma_f32_16x16x32_bf16 v[248:251], v[124:127], a[148:151], v[248:251]
    v_mfma_f32_16x16x32_bf16 v[252:255], v[124:127], a[156:159], v[252:255]
    s_waitcnt vmcnt(20) lgkmcnt(0)
    v_mfma_f32_16x16x32_bf16 a[0:3], v[64:67], a[160:163], a[0:3]
    ds_read_b64_tr_b16 v[96:97], v24 offset:49152
    v_mfma_f32_16x16x32_bf16 a[4:7], v[64:67], a[168:171], a[4:7]
    ds_read_b64_tr_b16 v[98:99], v24 offset:53248
    v_mfma_f32_16x16x32_bf16 a[8:11], v[64:67], a[176:179], a[8:11]
    s_add_u32 m0, s45, 98304
    s_mov_b32 s50, 1605632
    buffer_load_dwordx4 v52, s[20:23], s50 offen offset:0 lds
    v_mfma_f32_16x16x32_bf16 a[12:15], v[64:67], a[184:187], a[12:15]
    ds_read_b64_tr_b16 v[100:101], v25 offset:49152
    v_mfma_f32_16x16x32_bf16 a[16:19], v[68:71], a[160:163], a[16:19]
    ds_read_b64_tr_b16 v[102:103], v25 offset:53248
    v_mfma_f32_16x16x32_bf16 a[20:23], v[68:71], a[168:171], a[20:23]
    s_mov_b32 s51, 1633280
    buffer_load_dwordx4 v52, s[20:23], s51 offen offset:1024 lds
    v_mfma_f32_16x16x32_bf16 a[24:27], v[68:71], a[176:179], a[24:27]
    ds_read_b64_tr_b16 v[104:105], v26 offset:49152
    v_mfma_f32_16x16x32_bf16 a[28:31], v[68:71], a[184:187], a[28:31]
    ds_read_b64_tr_b16 v[106:107], v26 offset:53248
    v_mfma_f32_16x16x32_bf16 a[32:35], v[72:75], a[160:163], a[32:35]
    s_add_u32 m0, s45, 106496
    s_mov_b32 s50, 1605632
    buffer_load_dwordx4 v52, s[24:27], s50 offen offset:0 lds
    v_mfma_f32_16x16x32_bf16 a[36:39], v[72:75], a[168:171], a[36:39]
    ds_read_b64_tr_b16 v[108:109], v27 offset:49152
    v_mfma_f32_16x16x32_bf16 a[40:43], v[72:75], a[176:179], a[40:43]
    ds_read_b64_tr_b16 v[110:111], v27 offset:53248
    v_mfma_f32_16x16x32_bf16 a[44:47], v[72:75], a[184:187], a[44:47]
    s_mov_b32 s51, 1633280
    buffer_load_dwordx4 v52, s[24:27], s51 offen offset:1024 lds
    v_mfma_f32_16x16x32_bf16 a[48:51], v[76:79], a[160:163], a[48:51]
    ds_read_b64_tr_b16 v[112:113], v28 offset:49152
    v_mfma_f32_16x16x32_bf16 a[52:55], v[76:79], a[168:171], a[52:55]
    ds_read_b64_tr_b16 v[114:115], v28 offset:53248
    v_mfma_f32_16x16x32_bf16 a[56:59], v[76:79], a[176:179], a[56:59]
    s_add_u32 m0, s44, 16384
    s_mov_b32 s52, 16384
    buffer_load_dwordx4 v44, s[8:11], s52 offen offset:0 lds
    v_mfma_f32_16x16x32_bf16 a[60:63], v[76:79], a[184:187], a[60:63]
    ds_read_b64_tr_b16 v[116:117], v29 offset:49152
    v_mfma_f32_16x16x32_bf16 a[64:67], v[80:83], a[160:163], a[64:67]
    ds_read_b64_tr_b16 v[118:119], v29 offset:53248
    v_mfma_f32_16x16x32_bf16 a[68:71], v[80:83], a[168:171], a[68:71]
    buffer_load_dwordx4 v45, s[8:11], s52 offen offset:1024 lds
    v_mfma_f32_16x16x32_bf16 a[72:75], v[80:83], a[176:179], a[72:75]
    ds_read_b64_tr_b16 v[120:121], v30 offset:49152
    v_mfma_f32_16x16x32_bf16 a[76:79], v[80:83], a[184:187], a[76:79]
    ds_read_b64_tr_b16 v[122:123], v30 offset:53248
    v_mfma_f32_16x16x32_bf16 a[80:83], v[84:87], a[160:163], a[80:83]
    buffer_load_dwordx4 v46, s[8:11], s52 offen offset:2048 lds
    v_mfma_f32_16x16x32_bf16 a[84:87], v[84:87], a[168:171], a[84:87]
    ds_read_b64_tr_b16 v[124:125], v31 offset:49152
    v_mfma_f32_16x16x32_bf16 a[88:91], v[84:87], a[176:179], a[88:91]
    ds_read_b64_tr_b16 v[126:127], v31 offset:53248
    v_mfma_f32_16x16x32_bf16 a[92:95], v[84:87], a[184:187], a[92:95]
    buffer_load_dwordx4 v47, s[8:11], s52 offen offset:3072 lds
    v_mfma_f32_16x16x32_bf16 a[96:99], v[88:91], a[160:163], a[96:99]
    v_mfma_f32_16x16x32_bf16 a[100:103], v[88:91], a[168:171], a[100:103]
    v_mfma_f32_16x16x32_bf16 a[104:107], v[88:91], a[176:179], a[104:107]
    v_mfma_f32_16x16x32_bf16 a[108:111], v[88:91], a[184:187], a[108:111]
    v_mfma_f32_16x16x32_bf16 a[112:115], v[92:95], a[160:163], a[112:115]
    v_mfma_f32_16x16x32_bf16 a[116:119], v[92:95], a[168:171], a[116:119]
    v_mfma_f32_16x16x32_bf16 a[120:123], v[92:95], a[176:179], a[120:123]
    v_mfma_f32_16x16x32_bf16 a[124:127], v[92:95], a[184:187], a[124:127]
    s_waitcnt lgkmcnt(0)
    v_mfma_f32_16x16x32_bf16 v[128:131], v[96:99], a[160:163], v[128:131]
    ds_read_b64_tr_b16 v[64:65], v32 offset:36864
    v_mfma_f32_16x16x32_bf16 v[132:135], v[96:99], a[168:171], v[132:135]
    ds_read_b64_tr_b16 v[66:67], v32 offset:38912
    v_mfma_f32_16x16x32_bf16 v[136:139], v[96:99], a[176:179], v[136:139]
    v_add_u32 v53, 2048, v53
    buffer_load_dwordx4 a[224:227], v53, s[28:31], s40 offen offset:0
    v_mfma_f32_16x16x32_bf16 v[140:143], v[96:99], a[184:187], v[140:143]
    ds_read_b64_tr_b16 v[68:69], v33 offset:36864
    v_mfma_f32_16x16x32_bf16 v[144:147], v[100:103], a[160:163], v[144:147]
    ds_read_b64_tr_b16 v[70:71], v33 offset:38912
    v_mfma_f32_16x16x32_bf16 v[148:151], v[100:103], a[168:171], v[148:151]
    v_mfma_f32_16x16x32_bf16 v[152:155], v[100:103], a[176:179], v[152:155]
    ds_read_b64_tr_b16 v[72:73], v34 offset:36864
    v_mfma_f32_16x16x32_bf16 v[156:159], v[100:103], a[184:187], v[156:159]
    ds_read_b64_tr_b16 v[74:75], v34 offset:38912
    v_mfma_f32_16x16x32_bf16 v[160:163], v[104:107], a[160:163], v[160:163]
    buffer_load_dwordx4 a[232:235], v53, s[28:31], s41 offen offset:0
    v_mfma_f32_16x16x32_bf16 v[164:167], v[104:107], a[168:171], v[164:167]
    ds_read_b64_tr_b16 v[76:77], v35 offset:36864
    v_mfma_f32_16x16x32_bf16 v[168:171], v[104:107], a[176:179], v[168:171]
    ds_read_b64_tr_b16 v[78:79], v35 offset:38912
    v_mfma_f32_16x16x32_bf16 v[172:175], v[104:107], a[184:187], v[172:175]
    v_mfma_f32_16x16x32_bf16 v[176:179], v[108:111], a[160:163], v[176:179]
    ds_read_b64_tr_b16 v[80:81], v32 offset:45056
    v_mfma_f32_16x16x32_bf16 v[180:183], v[108:111], a[168:171], v[180:183]
    ds_read_b64_tr_b16 v[82:83], v32 offset:47104
    v_mfma_f32_16x16x32_bf16 v[184:187], v[108:111], a[176:179], v[184:187]
    buffer_load_dwordx4 a[240:243], v53, s[28:31], s42 offen offset:0
    v_mfma_f32_16x16x32_bf16 v[188:191], v[108:111], a[184:187], v[188:191]
    ds_read_b64_tr_b16 v[84:85], v33 offset:45056
    v_mfma_f32_16x16x32_bf16 v[192:195], v[112:115], a[160:163], v[192:195]
    ds_read_b64_tr_b16 v[86:87], v33 offset:47104
    v_mfma_f32_16x16x32_bf16 v[196:199], v[112:115], a[168:171], v[196:199]
    v_mfma_f32_16x16x32_bf16 v[200:203], v[112:115], a[176:179], v[200:203]
    ds_read_b64_tr_b16 v[88:89], v34 offset:45056
    v_mfma_f32_16x16x32_bf16 v[204:207], v[112:115], a[184:187], v[204:207]
    ds_read_b64_tr_b16 v[90:91], v34 offset:47104
    v_mfma_f32_16x16x32_bf16 v[208:211], v[116:119], a[160:163], v[208:211]
    buffer_load_dwordx4 a[248:251], v53, s[28:31], s43 offen offset:0
    v_mfma_f32_16x16x32_bf16 v[212:215], v[116:119], a[168:171], v[212:215]
    ds_read_b64_tr_b16 v[92:93], v35 offset:45056
    v_mfma_f32_16x16x32_bf16 v[216:219], v[116:119], a[176:179], v[216:219]
    ds_read_b64_tr_b16 v[94:95], v35 offset:47104
    v_mfma_f32_16x16x32_bf16 v[220:223], v[116:119], a[184:187], v[220:223]
    v_mfma_f32_16x16x32_bf16 v[224:227], v[120:123], a[160:163], v[224:227]
    v_mfma_f32_16x16x32_bf16 v[228:231], v[120:123], a[168:171], v[228:231]
    v_mfma_f32_16x16x32_bf16 v[232:235], v[120:123], a[176:179], v[232:235]
    v_mfma_f32_16x16x32_bf16 v[236:239], v[120:123], a[184:187], v[236:239]
    v_mfma_f32_16x16x32_bf16 v[240:243], v[124:127], a[160:163], v[240:243]
    v_mfma_f32_16x16x32_bf16 v[244:247], v[124:127], a[168:171], v[244:247]
    v_mfma_f32_16x16x32_bf16 v[248:251], v[124:127], a[176:179], v[248:251]
    v_mfma_f32_16x16x32_bf16 v[252:255], v[124:127], a[184:187], v[252:255]
    s_waitcnt lgkmcnt(0)
    v_mfma_f32_16x16x32_bf16 a[0:3], v[64:67], a[164:167], a[0:3]
    ds_read_b64_tr_b16 v[96:97], v24 offset:57344
    v_mfma_f32_16x16x32_bf16 a[4:7], v[64:67], a[172:175], a[4:7]
    ds_read_b64_tr_b16 v[98:99], v24 offset:61440
    v_mfma_f32_16x16x32_bf16 a[8:11], v[64:67], a[180:183], a[8:11]
    s_add_u32 m0, s44, 114688
    s_mov_b32 s50, 3670016
    buffer_load_dwordx4 v50, s[16:19], s50 offen offset:0 lds
    v_mfma_f32_16x16x32_bf16 a[12:15], v[64:67], a[188:191], a[12:15]
    ds_read_b64_tr_b16 v[100:101], v25 offset:57344
    v_mfma_f32_16x16x32_bf16 a[16:19], v[68:71], a[164:167], a[16:19]
    ds_read_b64_tr_b16 v[102:103], v25 offset:61440
    v_mfma_f32_16x16x32_bf16 a[20:23], v[68:71], a[172:175], a[20:23]
    v_mfma_f32_16x16x32_bf16 a[24:27], v[68:71], a[180:183], a[24:27]
    ds_read_b64_tr_b16 v[104:105], v26 offset:57344
    v_mfma_f32_16x16x32_bf16 a[28:31], v[68:71], a[188:191], a[28:31]
    ds_read_b64_tr_b16 v[106:107], v26 offset:61440
    v_mfma_f32_16x16x32_bf16 a[32:35], v[72:75], a[164:167], a[32:35]
    s_mov_b32 s51, 3701760
    buffer_load_dwordx4 v51, s[16:19], s51 offen offset:1024 lds
    v_mfma_f32_16x16x32_bf16 a[36:39], v[72:75], a[172:175], a[36:39]
    ds_read_b64_tr_b16 v[108:109], v27 offset:57344
    v_mfma_f32_16x16x32_bf16 a[40:43], v[72:75], a[180:183], a[40:43]
    ds_read_b64_tr_b16 v[110:111], v27 offset:61440
    v_mfma_f32_16x16x32_bf16 a[44:47], v[72:75], a[188:191], a[44:47]
    v_mfma_f32_16x16x32_bf16 a[48:51], v[76:79], a[164:167], a[48:51]
    ds_read_b64_tr_b16 v[112:113], v28 offset:57344
    v_mfma_f32_16x16x32_bf16 a[52:55], v[76:79], a[172:175], a[52:55]
    ds_read_b64_tr_b16 v[114:115], v28 offset:61440
    v_mfma_f32_16x16x32_bf16 a[56:59], v[76:79], a[180:183], a[56:59]
    s_mov_b32 s50, 3733504
    buffer_load_dwordx4 v50, s[16:19], s50 offen offset:2048 lds
    v_mfma_f32_16x16x32_bf16 a[60:63], v[76:79], a[188:191], a[60:63]
    ds_read_b64_tr_b16 v[116:117], v29 offset:57344
    v_mfma_f32_16x16x32_bf16 a[64:67], v[80:83], a[164:167], a[64:67]
    ds_read_b64_tr_b16 v[118:119], v29 offset:61440
    v_mfma_f32_16x16x32_bf16 a[68:71], v[80:83], a[172:175], a[68:71]
    v_mfma_f32_16x16x32_bf16 a[72:75], v[80:83], a[180:183], a[72:75]
    ds_read_b64_tr_b16 v[120:121], v30 offset:57344
    v_mfma_f32_16x16x32_bf16 a[76:79], v[80:83], a[188:191], a[76:79]
    ds_read_b64_tr_b16 v[122:123], v30 offset:61440
    v_mfma_f32_16x16x32_bf16 a[80:83], v[84:87], a[164:167], a[80:83]
    s_mov_b32 s51, 3765248
    buffer_load_dwordx4 v51, s[16:19], s51 offen offset:3072 lds
    v_mfma_f32_16x16x32_bf16 a[84:87], v[84:87], a[172:175], a[84:87]
    ds_read_b64_tr_b16 v[124:125], v31 offset:57344
    v_mfma_f32_16x16x32_bf16 a[88:91], v[84:87], a[180:183], a[88:91]
    ds_read_b64_tr_b16 v[126:127], v31 offset:61440
    v_mfma_f32_16x16x32_bf16 a[92:95], v[84:87], a[188:191], a[92:95]
    v_mfma_f32_16x16x32_bf16 a[96:99], v[88:91], a[164:167], a[96:99]
    v_mfma_f32_16x16x32_bf16 a[100:103], v[88:91], a[172:175], a[100:103]
    v_mfma_f32_16x16x32_bf16 a[104:107], v[88:91], a[180:183], a[104:107]
    v_mfma_f32_16x16x32_bf16 a[108:111], v[88:91], a[188:191], a[108:111]
    v_mfma_f32_16x16x32_bf16 a[112:115], v[92:95], a[164:167], a[112:115]
    v_mfma_f32_16x16x32_bf16 a[116:119], v[92:95], a[172:175], a[116:119]
    v_mfma_f32_16x16x32_bf16 a[120:123], v[92:95], a[180:183], a[120:123]
    v_mfma_f32_16x16x32_bf16 a[124:127], v[92:95], a[188:191], a[124:127]
    s_waitcnt vmcnt(24) lgkmcnt(0)
    s_barrier
    v_mfma_f32_16x16x32_bf16 v[128:131], v[96:99], a[164:167], v[128:131]
    ds_read_b64_tr_b16 v[64:65], v36 offset:0
    v_mfma_f32_16x16x32_bf16 v[132:135], v[96:99], a[172:175], v[132:135]
    ds_read_b64_tr_b16 v[66:67], v36 offset:2048
    v_mfma_f32_16x16x32_bf16 v[136:139], v[96:99], a[180:183], v[136:139]
    buffer_load_dwordx4 a[228:231], v53, s[28:31], s40 offen offset:1024
    v_mfma_f32_16x16x32_bf16 v[140:143], v[96:99], a[188:191], v[140:143]
    ds_read_b64_tr_b16 v[68:69], v37 offset:0
    v_mfma_f32_16x16x32_bf16 v[144:147], v[100:103], a[164:167], v[144:147]
    ds_read_b64_tr_b16 v[70:71], v37 offset:2048
    v_mfma_f32_16x16x32_bf16 v[148:151], v[100:103], a[172:175], v[148:151]
    buffer_load_dwordx4 a[236:239], v53, s[28:31], s41 offen offset:1024
    v_mfma_f32_16x16x32_bf16 v[152:155], v[100:103], a[180:183], v[152:155]
    ds_read_b64_tr_b16 v[72:73], v38 offset:0
    v_mfma_f32_16x16x32_bf16 v[156:159], v[100:103], a[188:191], v[156:159]
    ds_read_b64_tr_b16 v[74:75], v38 offset:2048
    v_mfma_f32_16x16x32_bf16 v[160:163], v[104:107], a[164:167], v[160:163]
    buffer_load_dwordx4 a[244:247], v53, s[28:31], s42 offen offset:1024
    v_mfma_f32_16x16x32_bf16 v[164:167], v[104:107], a[172:175], v[164:167]
    ds_read_b64_tr_b16 v[76:77], v39 offset:0
    v_mfma_f32_16x16x32_bf16 v[168:171], v[104:107], a[180:183], v[168:171]
    ds_read_b64_tr_b16 v[78:79], v39 offset:2048
    v_mfma_f32_16x16x32_bf16 v[172:175], v[104:107], a[188:191], v[172:175]
    buffer_load_dwordx4 a[252:255], v53, s[28:31], s43 offen offset:1024
    v_mfma_f32_16x16x32_bf16 v[176:179], v[108:111], a[164:167], v[176:179]
    ds_read_b64_tr_b16 v[80:81], v36 offset:8192
    v_mfma_f32_16x16x32_bf16 v[180:183], v[108:111], a[172:175], v[180:183]
    ds_read_b64_tr_b16 v[82:83], v36 offset:10240
    v_mfma_f32_16x16x32_bf16 v[184:187], v[108:111], a[180:183], v[184:187]
    s_add_u32 m0, s44, 32768
    s_mov_b32 s52, 32768
    buffer_load_dwordx4 v44, s[8:11], s52 offen offset:0 lds
    v_mfma_f32_16x16x32_bf16 v[188:191], v[108:111], a[188:191], v[188:191]
    ds_read_b64_tr_b16 v[84:85], v37 offset:8192
    v_mfma_f32_16x16x32_bf16 v[192:195], v[112:115], a[164:167], v[192:195]
    ds_read_b64_tr_b16 v[86:87], v37 offset:10240
    v_mfma_f32_16x16x32_bf16 v[196:199], v[112:115], a[172:175], v[196:199]
    buffer_load_dwordx4 v45, s[8:11], s52 offen offset:1024 lds
    v_mfma_f32_16x16x32_bf16 v[200:203], v[112:115], a[180:183], v[200:203]
    ds_read_b64_tr_b16 v[88:89], v38 offset:8192
    v_mfma_f32_16x16x32_bf16 v[204:207], v[112:115], a[188:191], v[204:207]
    ds_read_b64_tr_b16 v[90:91], v38 offset:10240
    v_mfma_f32_16x16x32_bf16 v[208:211], v[116:119], a[164:167], v[208:211]
    buffer_load_dwordx4 v46, s[8:11], s52 offen offset:2048 lds
    v_mfma_f32_16x16x32_bf16 v[212:215], v[116:119], a[172:175], v[212:215]
    ds_read_b64_tr_b16 v[92:93], v39 offset:8192
    v_mfma_f32_16x16x32_bf16 v[216:219], v[116:119], a[180:183], v[216:219]
    ds_read_b64_tr_b16 v[94:95], v39 offset:10240
    v_mfma_f32_16x16x32_bf16 v[220:223], v[116:119], a[188:191], v[220:223]
    buffer_load_dwordx4 v47, s[8:11], s52 offen offset:3072 lds
    v_mfma_f32_16x16x32_bf16 v[224:227], v[120:123], a[164:167], v[224:227]
    v_mfma_f32_16x16x32_bf16 v[228:231], v[120:123], a[172:175], v[228:231]
    v_mfma_f32_16x16x32_bf16 v[232:235], v[120:123], a[180:183], v[232:235]
    v_mfma_f32_16x16x32_bf16 v[236:239], v[120:123], a[188:191], v[236:239]
    v_mfma_f32_16x16x32_bf16 v[240:243], v[124:127], a[164:167], v[240:243]
    v_mfma_f32_16x16x32_bf16 v[244:247], v[124:127], a[172:175], v[244:247]
    v_mfma_f32_16x16x32_bf16 v[248:251], v[124:127], a[180:183], v[248:251]
    v_mfma_f32_16x16x32_bf16 v[252:255], v[124:127], a[188:191], v[252:255]
    s_waitcnt vmcnt(28) lgkmcnt(0)
    v_mfma_f32_16x16x32_bf16 a[0:3], v[64:67], a[192:195], a[0:3]
    ds_read_b64_tr_b16 v[96:97], v36 offset:4096
    v_mfma_f32_16x16x32_bf16 a[4:7], v[64:67], a[200:203], a[4:7]
    ds_read_b64_tr_b16 v[98:99], v36 offset:6144
    v_mfma_f32_16x16x32_bf16 a[8:11], v[64:67], a[208:211], a[8:11]
    v_mfma_f32_16x16x32_bf16 a[12:15], v[64:67], a[216:219], a[12:15]
    ds_read_b64_tr_b16 v[100:101], v37 offset:4096
    v_mfma_f32_16x16x32_bf16 a[16:19], v[68:71], a[192:195], a[16:19]
    ds_read_b64_tr_b16 v[102:103], v37 offset:6144
    v_mfma_f32_16x16x32_bf16 a[20:23], v[68:71], a[200:203], a[20:23]
    v_mfma_f32_16x16x32_bf16 a[24:27], v[68:71], a[208:211], a[24:27]
    ds_read_b64_tr_b16 v[104:105], v38 offset:4096
    v_mfma_f32_16x16x32_bf16 a[28:31], v[68:71], a[216:219], a[28:31]
    ds_read_b64_tr_b16 v[106:107], v38 offset:6144
    v_mfma_f32_16x16x32_bf16 a[32:35], v[72:75], a[192:195], a[32:35]
    v_mfma_f32_16x16x32_bf16 a[36:39], v[72:75], a[200:203], a[36:39]
    ds_read_b64_tr_b16 v[108:109], v39 offset:4096
    v_mfma_f32_16x16x32_bf16 a[40:43], v[72:75], a[208:211], a[40:43]
    ds_read_b64_tr_b16 v[110:111], v39 offset:6144
    v_mfma_f32_16x16x32_bf16 a[44:47], v[72:75], a[216:219], a[44:47]
    v_mfma_f32_16x16x32_bf16 a[48:51], v[76:79], a[192:195], a[48:51]
    ds_read_b64_tr_b16 v[112:113], v36 offset:12288
    v_mfma_f32_16x16x32_bf16 a[52:55], v[76:79], a[200:203], a[52:55]
    ds_read_b64_tr_b16 v[114:115], v36 offset:14336
    v_mfma_f32_16x16x32_bf16 a[56:59], v[76:79], a[208:211], a[56:59]
    v_mfma_f32_16x16x32_bf16 a[60:63], v[76:79], a[216:219], a[60:63]
    ds_read_b64_tr_b16 v[116:117], v37 offset:12288
    v_mfma_f32_16x16x32_bf16 a[64:67], v[80:83], a[192:195], a[64:67]
    ds_read_b64_tr_b16 v[118:119], v37 offset:14336
    v_mfma_f32_16x16x32_bf16 a[68:71], v[80:83], a[200:203], a[68:71]
    v_mfma_f32_16x16x32_bf16 a[72:75], v[80:83], a[208:211], a[72:75]
    ds_read_b64_tr_b16 v[120:121], v38 offset:12288
    v_mfma_f32_16x16x32_bf16 a[76:79], v[80:83], a[216:219], a[76:79]
    ds_read_b64_tr_b16 v[122:123], v38 offset:14336
    v_mfma_f32_16x16x32_bf16 a[80:83], v[84:87], a[192:195], a[80:83]
    v_mfma_f32_16x16x32_bf16 a[84:87], v[84:87], a[200:203], a[84:87]
    ds_read_b64_tr_b16 v[124:125], v39 offset:12288
    v_mfma_f32_16x16x32_bf16 a[88:91], v[84:87], a[208:211], a[88:91]
    ds_read_b64_tr_b16 v[126:127], v39 offset:14336
    v_mfma_f32_16x16x32_bf16 a[92:95], v[84:87], a[216:219], a[92:95]
    v_mfma_f32_16x16x32_bf16 a[96:99], v[88:91], a[192:195], a[96:99]
    v_mfma_f32_16x16x32_bf16 a[100:103], v[88:91], a[200:203], a[100:103]
    v_mfma_f32_16x16x32_bf16 a[104:107], v[88:91], a[208:211], a[104:107]
    v_mfma_f32_16x16x32_bf16 a[108:111], v[88:91], a[216:219], a[108:111]
    v_mfma_f32_16x16x32_bf16 a[112:115], v[92:95], a[192:195], a[112:115]
    v_mfma_f32_16x16x32_bf16 a[116:119], v[92:95], a[200:203], a[116:119]
    v_mfma_f32_16x16x32_bf16 a[120:123], v[92:95], a[208:211], a[120:123]
    v_mfma_f32_16x16x32_bf16 a[124:127], v[92:95], a[216:219], a[124:127]
    s_waitcnt vmcnt(8) lgkmcnt(0)
    s_barrier
    v_mfma_f32_16x16x32_bf16 a[0:3], v[96:99], a[196:199], a[0:3]
    ds_read_b64_tr_b16 v[64:65], v36 offset:32768
    v_mfma_f32_16x16x32_bf16 a[4:7], v[96:99], a[204:207], a[4:7]
    ds_read_b64_tr_b16 v[66:67], v36 offset:34816
    v_mfma_f32_16x16x32_bf16 a[8:11], v[96:99], a[212:215], a[8:11]
    v_mfma_f32_16x16x32_bf16 a[12:15], v[96:99], a[220:223], a[12:15]
    ds_read_b64_tr_b16 v[68:69], v37 offset:32768
    v_mfma_f32_16x16x32_bf16 a[16:19], v[100:103], a[196:199], a[16:19]
    ds_read_b64_tr_b16 v[70:71], v37 offset:34816
    v_mfma_f32_16x16x32_bf16 a[20:23], v[100:103], a[204:207], a[20:23]
    v_mfma_f32_16x16x32_bf16 a[24:27], v[100:103], a[212:215], a[24:27]
    ds_read_b64_tr_b16 v[72:73], v38 offset:32768
    v_mfma_f32_16x16x32_bf16 a[28:31], v[100:103], a[220:223], a[28:31]
    ds_read_b64_tr_b16 v[74:75], v38 offset:34816
    v_mfma_f32_16x16x32_bf16 a[32:35], v[104:107], a[196:199], a[32:35]
    v_mfma_f32_16x16x32_bf16 a[36:39], v[104:107], a[204:207], a[36:39]
    ds_read_b64_tr_b16 v[76:77], v39 offset:32768
    v_mfma_f32_16x16x32_bf16 a[40:43], v[104:107], a[212:215], a[40:43]
    ds_read_b64_tr_b16 v[78:79], v39 offset:34816
    v_mfma_f32_16x16x32_bf16 a[44:47], v[104:107], a[220:223], a[44:47]
    v_mfma_f32_16x16x32_bf16 a[48:51], v[108:111], a[196:199], a[48:51]
    ds_read_b64_tr_b16 v[80:81], v36 offset:40960
    v_mfma_f32_16x16x32_bf16 a[52:55], v[108:111], a[204:207], a[52:55]
    ds_read_b64_tr_b16 v[82:83], v36 offset:43008
    v_mfma_f32_16x16x32_bf16 a[56:59], v[108:111], a[212:215], a[56:59]
    v_mfma_f32_16x16x32_bf16 a[60:63], v[108:111], a[220:223], a[60:63]
    ds_read_b64_tr_b16 v[84:85], v37 offset:40960
    v_mfma_f32_16x16x32_bf16 a[64:67], v[112:115], a[196:199], a[64:67]
    ds_read_b64_tr_b16 v[86:87], v37 offset:43008
    v_mfma_f32_16x16x32_bf16 a[68:71], v[112:115], a[204:207], a[68:71]
    v_mfma_f32_16x16x32_bf16 a[72:75], v[112:115], a[212:215], a[72:75]
    ds_read_b64_tr_b16 v[88:89], v38 offset:40960
    v_mfma_f32_16x16x32_bf16 a[76:79], v[112:115], a[220:223], a[76:79]
    ds_read_b64_tr_b16 v[90:91], v38 offset:43008
    v_mfma_f32_16x16x32_bf16 a[80:83], v[116:119], a[196:199], a[80:83]
    v_mfma_f32_16x16x32_bf16 a[84:87], v[116:119], a[204:207], a[84:87]
    ds_read_b64_tr_b16 v[92:93], v39 offset:40960
    v_mfma_f32_16x16x32_bf16 a[88:91], v[116:119], a[212:215], a[88:91]
    ds_read_b64_tr_b16 v[94:95], v39 offset:43008
    v_mfma_f32_16x16x32_bf16 a[92:95], v[116:119], a[220:223], a[92:95]
    v_mfma_f32_16x16x32_bf16 a[96:99], v[120:123], a[196:199], a[96:99]
    v_mfma_f32_16x16x32_bf16 a[100:103], v[120:123], a[204:207], a[100:103]
    v_mfma_f32_16x16x32_bf16 a[104:107], v[120:123], a[212:215], a[104:107]
    v_mfma_f32_16x16x32_bf16 a[108:111], v[120:123], a[220:223], a[108:111]
    v_mfma_f32_16x16x32_bf16 a[112:115], v[124:127], a[196:199], a[112:115]
    v_mfma_f32_16x16x32_bf16 a[116:119], v[124:127], a[204:207], a[116:119]
    v_mfma_f32_16x16x32_bf16 a[120:123], v[124:127], a[212:215], a[120:123]
    v_mfma_f32_16x16x32_bf16 a[124:127], v[124:127], a[220:223], a[124:127]
    s_waitcnt vmcnt(4) lgkmcnt(0)
    v_mfma_f32_16x16x32_bf16 a[0:3], v[64:67], a[224:227], a[0:3]
    ds_read_b64_tr_b16 v[96:97], v36 offset:36864
    v_mfma_f32_16x16x32_bf16 a[4:7], v[64:67], a[232:235], a[4:7]
    ds_read_b64_tr_b16 v[98:99], v36 offset:38912
    v_mfma_f32_16x16x32_bf16 a[8:11], v[64:67], a[240:243], a[8:11]
    v_mfma_f32_16x16x32_bf16 a[12:15], v[64:67], a[248:251], a[12:15]
    ds_read_b64_tr_b16 v[100:101], v37 offset:36864
    v_mfma_f32_16x16x32_bf16 a[16:19], v[68:71], a[224:227], a[16:19]
    ds_read_b64_tr_b16 v[102:103], v37 offset:38912
    v_mfma_f32_16x16x32_bf16 a[20:23], v[68:71], a[232:235], a[20:23]
    v_mfma_f32_16x16x32_bf16 a[24:27], v[68:71], a[240:243], a[24:27]
    ds_read_b64_tr_b16 v[104:105], v38 offset:36864
    v_mfma_f32_16x16x32_bf16 a[28:31], v[68:71], a[248:251], a[28:31]
    ds_read_b64_tr_b16 v[106:107], v38 offset:38912
    v_mfma_f32_16x16x32_bf16 a[32:35], v[72:75], a[224:227], a[32:35]
    v_mfma_f32_16x16x32_bf16 a[36:39], v[72:75], a[232:235], a[36:39]
    ds_read_b64_tr_b16 v[108:109], v39 offset:36864
    v_mfma_f32_16x16x32_bf16 a[40:43], v[72:75], a[240:243], a[40:43]
    ds_read_b64_tr_b16 v[110:111], v39 offset:38912
    v_mfma_f32_16x16x32_bf16 a[44:47], v[72:75], a[248:251], a[44:47]
    v_mfma_f32_16x16x32_bf16 a[48:51], v[76:79], a[224:227], a[48:51]
    ds_read_b64_tr_b16 v[112:113], v36 offset:45056
    v_mfma_f32_16x16x32_bf16 a[52:55], v[76:79], a[232:235], a[52:55]
    ds_read_b64_tr_b16 v[114:115], v36 offset:47104
    v_mfma_f32_16x16x32_bf16 a[56:59], v[76:79], a[240:243], a[56:59]
    v_mfma_f32_16x16x32_bf16 a[60:63], v[76:79], a[248:251], a[60:63]
    ds_read_b64_tr_b16 v[116:117], v37 offset:45056
    v_mfma_f32_16x16x32_bf16 a[64:67], v[80:83], a[224:227], a[64:67]
    ds_read_b64_tr_b16 v[118:119], v37 offset:47104
    v_mfma_f32_16x16x32_bf16 a[68:71], v[80:83], a[232:235], a[68:71]
    v_mfma_f32_16x16x32_bf16 a[72:75], v[80:83], a[240:243], a[72:75]
    ds_read_b64_tr_b16 v[120:121], v38 offset:45056
    v_mfma_f32_16x16x32_bf16 a[76:79], v[80:83], a[248:251], a[76:79]
    ds_read_b64_tr_b16 v[122:123], v38 offset:47104
    v_mfma_f32_16x16x32_bf16 a[80:83], v[84:87], a[224:227], a[80:83]
    v_mfma_f32_16x16x32_bf16 a[84:87], v[84:87], a[232:235], a[84:87]
    ds_read_b64_tr_b16 v[124:125], v39 offset:45056
    v_mfma_f32_16x16x32_bf16 a[88:91], v[84:87], a[240:243], a[88:91]
    ds_read_b64_tr_b16 v[126:127], v39 offset:47104
    v_mfma_f32_16x16x32_bf16 a[92:95], v[84:87], a[248:251], a[92:95]
    v_mfma_f32_16x16x32_bf16 a[96:99], v[88:91], a[224:227], a[96:99]
    v_mfma_f32_16x16x32_bf16 a[100:103], v[88:91], a[232:235], a[100:103]
    v_mfma_f32_16x16x32_bf16 a[104:107], v[88:91], a[240:243], a[104:107]
    v_mfma_f32_16x16x32_bf16 a[108:111], v[88:91], a[248:251], a[108:111]
    v_mfma_f32_16x16x32_bf16 a[112:115], v[92:95], a[224:227], a[112:115]
    v_mfma_f32_16x16x32_bf16 a[116:119], v[92:95], a[232:235], a[116:119]
    v_mfma_f32_16x16x32_bf16 a[120:123], v[92:95], a[240:243], a[120:123]
    v_mfma_f32_16x16x32_bf16 a[124:127], v[92:95], a[248:251], a[124:127]
    s_waitcnt lgkmcnt(0)
    v_mfma_f32_16x16x32_bf16 a[0:3], v[96:99], a[228:231], a[0:3]
    ds_read_b64_tr_b16 v[64:65], v16 offset:16384
    v_mfma_f32_16x16x32_bf16 a[4:7], v[96:99], a[236:239], a[4:7]
    ds_read_b64_tr_b16 v[66:67], v16 offset:20480
    v_mfma_f32_16x16x32_bf16 a[8:11], v[96:99], a[244:247], a[8:11]
    v_mfma_f32_16x16x32_bf16 a[12:15], v[96:99], a[252:255], a[12:15]
    ds_read_b64_tr_b16 v[68:69], v17 offset:16384
    v_mfma_f32_16x16x32_bf16 a[16:19], v[100:103], a[228:231], a[16:19]
    ds_read_b64_tr_b16 v[70:71], v17 offset:20480
    v_mfma_f32_16x16x32_bf16 a[20:23], v[100:103], a[236:239], a[20:23]
    v_mfma_f32_16x16x32_bf16 a[24:27], v[100:103], a[244:247], a[24:27]
    ds_read_b64_tr_b16 v[72:73], v18 offset:16384
    v_mfma_f32_16x16x32_bf16 a[28:31], v[100:103], a[252:255], a[28:31]
    ds_read_b64_tr_b16 v[74:75], v18 offset:20480
    v_mfma_f32_16x16x32_bf16 a[32:35], v[104:107], a[228:231], a[32:35]
    v_mfma_f32_16x16x32_bf16 a[36:39], v[104:107], a[236:239], a[36:39]
    ds_read_b64_tr_b16 v[76:77], v19 offset:16384
    v_mfma_f32_16x16x32_bf16 a[40:43], v[104:107], a[244:247], a[40:43]
    ds_read_b64_tr_b16 v[78:79], v19 offset:20480
    v_mfma_f32_16x16x32_bf16 a[44:47], v[104:107], a[252:255], a[44:47]
    v_mfma_f32_16x16x32_bf16 a[48:51], v[108:111], a[228:231], a[48:51]
    ds_read_b64_tr_b16 v[80:81], v20 offset:16384
    v_mfma_f32_16x16x32_bf16 a[52:55], v[108:111], a[236:239], a[52:55]
    ds_read_b64_tr_b16 v[82:83], v20 offset:20480
    v_mfma_f32_16x16x32_bf16 a[56:59], v[108:111], a[244:247], a[56:59]
    v_mfma_f32_16x16x32_bf16 a[60:63], v[108:111], a[252:255], a[60:63]
    ds_read_b64_tr_b16 v[84:85], v21 offset:16384
    v_mfma_f32_16x16x32_bf16 a[64:67], v[112:115], a[228:231], a[64:67]
    ds_read_b64_tr_b16 v[86:87], v21 offset:20480
    v_mfma_f32_16x16x32_bf16 a[68:71], v[112:115], a[236:239], a[68:71]
    v_mfma_f32_16x16x32_bf16 a[72:75], v[112:115], a[244:247], a[72:75]
    ds_read_b64_tr_b16 v[88:89], v22 offset:16384
    v_mfma_f32_16x16x32_bf16 a[76:79], v[112:115], a[252:255], a[76:79]
    ds_read_b64_tr_b16 v[90:91], v22 offset:20480
    v_mfma_f32_16x16x32_bf16 a[80:83], v[116:119], a[228:231], a[80:83]
    v_mfma_f32_16x16x32_bf16 a[84:87], v[116:119], a[236:239], a[84:87]
    ds_read_b64_tr_b16 v[92:93], v23 offset:16384
    v_mfma_f32_16x16x32_bf16 a[88:91], v[116:119], a[244:247], a[88:91]
    ds_read_b64_tr_b16 v[94:95], v23 offset:20480
    v_mfma_f32_16x16x32_bf16 a[92:95], v[116:119], a[252:255], a[92:95]
    v_mfma_f32_16x16x32_bf16 a[96:99], v[120:123], a[228:231], a[96:99]
    v_mfma_f32_16x16x32_bf16 a[100:103], v[120:123], a[236:239], a[100:103]
    v_mfma_f32_16x16x32_bf16 a[104:107], v[120:123], a[244:247], a[104:107]
    v_mfma_f32_16x16x32_bf16 a[108:111], v[120:123], a[252:255], a[108:111]
    v_mfma_f32_16x16x32_bf16 a[112:115], v[124:127], a[228:231], a[112:115]
    v_mfma_f32_16x16x32_bf16 a[116:119], v[124:127], a[236:239], a[116:119]
    v_mfma_f32_16x16x32_bf16 a[120:123], v[124:127], a[244:247], a[120:123]
    v_mfma_f32_16x16x32_bf16 a[124:127], v[124:127], a[252:255], a[124:127]
    s_waitcnt lgkmcnt(0)
    v_mfma_f32_16x16x32_bf16 v[128:131], v[64:67], a[192:195], v[128:131]
    ds_read_b64_tr_b16 v[96:97], v16 offset:24576
    v_accvgpr_read_b32 v1, a0
    v_mfma_f32_16x16x32_bf16 v[132:135], v[64:67], a[200:203], v[132:135]
    ds_read_b64_tr_b16 v[98:99], v16 offset:28672
    v_accvgpr_read_b32 v2, a1
    v_mfma_f32_16x16x32_bf16 v[136:139], v[64:67], a[208:211], v[136:139]
    v_accvgpr_read_b32 v3, a2
    v_accvgpr_read_b32 v4, a3
    v_mfma_f32_16x16x32_bf16 v[140:143], v[64:67], a[216:219], v[140:143]
    ds_read_b64_tr_b16 v[100:101], v17 offset:24576
    v_mul_f32 v9, 0xc13504f3, v1
    v_mfma_f32_16x16x32_bf16 v[144:147], v[68:71], a[192:195], v[144:147]
    ds_read_b64_tr_b16 v[102:103], v17 offset:28672
    v_mul_f32 v10, 0xc13504f3, v2
    v_mfma_f32_16x16x32_bf16 v[148:151], v[68:71], a[200:203], v[148:151]
    v_mul_f32 v11, 0xc13504f3, v3
    v_mul_f32 v12, 0xc13504f3, v4
    v_mfma_f32_16x16x32_bf16 v[152:155], v[68:71], a[208:211], v[152:155]
    ds_read_b64_tr_b16 v[104:105], v18 offset:24576
    v_accvgpr_read_b32 v5, a64
    v_mfma_f32_16x16x32_bf16 v[156:159], v[68:71], a[216:219], v[156:159]
    ds_read_b64_tr_b16 v[106:107], v18 offset:28672
    v_accvgpr_read_b32 v6, a65
    v_mfma_f32_16x16x32_bf16 v[160:163], v[72:75], a[192:195], v[160:163]
    v_accvgpr_read_b32 v7, a66
    v_accvgpr_read_b32 v8, a67
    v_mfma_f32_16x16x32_bf16 v[164:167], v[72:75], a[200:203], v[164:167]
    ds_read_b64_tr_b16 v[108:109], v19 offset:24576
    v_mul_f32 v5, v1, v5
    v_mfma_f32_16x16x32_bf16 v[168:171], v[72:75], a[208:211], v[168:171]
    ds_read_b64_tr_b16 v[110:111], v19 offset:28672
    v_mul_f32 v6, v2, v6
    v_mfma_f32_16x16x32_bf16 v[172:175], v[72:75], a[216:219], v[172:175]
    v_exp_f32 v9, v9
    v_mfma_f32_16x16x32_bf16 v[176:179], v[76:79], a[192:195], v[176:179]
    ds_read_b64_tr_b16 v[112:113], v20 offset:24576
    v_mul_f32 v7, v3, v7
    v_mfma_f32_16x16x32_bf16 v[180:183], v[76:79], a[200:203], v[180:183]
    ds_read_b64_tr_b16 v[114:115], v20 offset:28672
    v_mul_f32 v8, v4, v8
    v_mfma_f32_16x16x32_bf16 v[184:187], v[76:79], a[208:211], v[184:187]
    v_exp_f32 v10, v10
    v_mfma_f32_16x16x32_bf16 v[188:191], v[76:79], a[216:219], v[188:191]
    ds_read_b64_tr_b16 v[116:117], v21 offset:24576
    v_add_f32 v9, 1.0, v9
    v_mfma_f32_16x16x32_bf16 v[192:195], v[80:83], a[192:195], v[192:195]
    ds_read_b64_tr_b16 v[118:119], v21 offset:28672
    v_add_f32 v10, 1.0, v10
    v_mfma_f32_16x16x32_bf16 v[196:199], v[80:83], a[200:203], v[196:199]
    v_exp_f32 v11, v11
    v_mfma_f32_16x16x32_bf16 v[200:203], v[80:83], a[208:211], v[200:203]
    ds_read_b64_tr_b16 v[120:121], v22 offset:24576
    v_add_f32 v11, 1.0, v11
    v_mfma_f32_16x16x32_bf16 v[204:207], v[80:83], a[216:219], v[204:207]
    ds_read_b64_tr_b16 v[122:123], v22 offset:28672
    v_mfma_f32_16x16x32_bf16 v[208:211], v[84:87], a[192:195], v[208:211]
    v_exp_f32 v12, v12
    v_mfma_f32_16x16x32_bf16 v[212:215], v[84:87], a[200:203], v[212:215]
    ds_read_b64_tr_b16 v[124:125], v23 offset:24576
    v_add_f32 v12, 1.0, v12
    v_mfma_f32_16x16x32_bf16 v[216:219], v[84:87], a[208:211], v[216:219]
    ds_read_b64_tr_b16 v[126:127], v23 offset:28672
    v_mfma_f32_16x16x32_bf16 v[220:223], v[84:87], a[216:219], v[220:223]
    v_rcp_f32 v9, v9
    v_mfma_f32_16x16x32_bf16 v[224:227], v[88:91], a[192:195], v[224:227]
    v_rcp_f32 v10, v10
    v_mfma_f32_16x16x32_bf16 v[228:231], v[88:91], a[200:203], v[228:231]
    v_rcp_f32 v11, v11
    v_mfma_f32_16x16x32_bf16 v[232:235], v[88:91], a[208:211], v[232:235]
    v_rcp_f32 v12, v12
    v_mfma_f32_16x16x32_bf16 v[236:239], v[88:91], a[216:219], v[236:239]
    v_mul_f32 v5, v5, v9
    v_mul_f32 v6, v6, v10
    v_mfma_f32_16x16x32_bf16 v[240:243], v[92:95], a[192:195], v[240:243]
    v_mul_f32 v7, v7, v11
    v_mul_f32 v8, v8, v12
    v_mfma_f32_16x16x32_bf16 v[244:247], v[92:95], a[200:203], v[244:247]
    v_cvt_pk_bf16_f32 v56, v5, v6
    v_cvt_pk_bf16_f32 v57, v7, v8
    v_mfma_f32_16x16x32_bf16 v[248:251], v[92:95], a[208:211], v[248:251]
    v_mfma_f32_16x16x32_bf16 v[252:255], v[92:95], a[216:219], v[252:255]
    s_waitcnt lgkmcnt(0)
    s_barrier
    v_mfma_f32_16x16x32_bf16 v[128:131], v[96:99], a[196:199], v[128:131]
    ds_read_b64_tr_b16 v[64:65], v16 offset:49152
    v_accvgpr_read_b32 v1, a16
    v_mfma_f32_16x16x32_bf16 v[132:135], v[96:99], a[204:207], v[132:135]
    ds_read_b64_tr_b16 v[66:67], v16 offset:53248
    v_accvgpr_read_b32 v2, a17
    v_mfma_f32_16x16x32_bf16 v[136:139], v[96:99], a[212:215], v[136:139]
    s_add_u32 m0, s44, 65536
    s_mov_b32 s53, 0
    buffer_load_dwordx4 v48, s[12:15], s53 offen offset:0 lds
    v_accvgpr_read_b32 v3, a18
    v_mfma_f32_16x16x32_bf16 v[140:143], v[96:99], a[220:223], v[140:143]
    ds_read_b64_tr_b16 v[68:69], v17 offset:49152
    v_accvgpr_read_b32 v4, a19
    v_mfma_f32_16x16x32_bf16 v[144:147], v[100:103], a[196:199], v[144:147]
    ds_read_b64_tr_b16 v[70:71], v17 offset:53248
    v_mul_f32 v9, 0xc13504f3, v1
    v_mfma_f32_16x16x32_bf16 v[148:151], v[100:103], a[204:207], v[148:151]
    v_mul_f32 v10, 0xc13504f3, v2
    v_mul_f32 v11, 0xc13504f3, v3
    v_mfma_f32_16x16x32_bf16 v[152:155], v[100:103], a[212:215], v[152:155]
    ds_read_b64_tr_b16 v[72:73], v18 offset:49152
    v_mul_f32 v12, 0xc13504f3, v4
    v_mfma_f32_16x16x32_bf16 v[156:159], v[100:103], a[220:223], v[156:159]
    ds_read_b64_tr_b16 v[74:75], v18 offset:53248
    v_accvgpr_read_b32 v5, a80
    v_mfma_f32_16x16x32_bf16 v[160:163], v[104:107], a[196:199], v[160:163]
    buffer_load_dwordx4 v49, s[12:15], s53 offen offset:1024 lds
    v_accvgpr_read_b32 v6, a81
    v_mfma_f32_16x16x32_bf16 v[164:167], v[104:107], a[204:207], v[164:167]
    ds_read_b64_tr_b16 v[76:77], v19 offset:49152
    v_accvgpr_read_b32 v7, a82
    v_mfma_f32_16x16x32_bf16 v[168:171], v[104:107], a[212:215], v[168:171]
    ds_read_b64_tr_b16 v[78:79], v19 offset:53248
    v_accvgpr_read_b32 v8, a83
    v_mfma_f32_16x16x32_bf16 v[172:175], v[104:107], a[220:223], v[172:175]
    v_exp_f32 v9, v9
    v_mfma_f32_16x16x32_bf16 v[176:179], v[108:111], a[196:199], v[176:179]
    ds_read_b64_tr_b16 v[80:81], v20 offset:49152
    v_mul_f32 v5, v1, v5
    v_mfma_f32_16x16x32_bf16 v[180:183], v[108:111], a[204:207], v[180:183]
    ds_read_b64_tr_b16 v[82:83], v20 offset:53248
    v_mul_f32 v6, v2, v6
    v_mfma_f32_16x16x32_bf16 v[184:187], v[108:111], a[212:215], v[184:187]
    buffer_load_dwordx4 v48, s[12:15], s53 offen offset:2048 lds
    v_mul_f32 v7, v3, v7
    v_mfma_f32_16x16x32_bf16 v[188:191], v[108:111], a[220:223], v[188:191]
    ds_read_b64_tr_b16 v[84:85], v21 offset:49152
    v_mul_f32 v8, v4, v8
    v_mfma_f32_16x16x32_bf16 v[192:195], v[112:115], a[196:199], v[192:195]
    ds_read_b64_tr_b16 v[86:87], v21 offset:53248
    v_add_f32 v9, 1.0, v9
    v_mfma_f32_16x16x32_bf16 v[196:199], v[112:115], a[204:207], v[196:199]
    v_exp_f32 v10, v10
    v_mfma_f32_16x16x32_bf16 v[200:203], v[112:115], a[212:215], v[200:203]
    ds_read_b64_tr_b16 v[88:89], v22 offset:49152
    v_add_f32 v10, 1.0, v10
    v_mfma_f32_16x16x32_bf16 v[204:207], v[112:115], a[220:223], v[204:207]
    ds_read_b64_tr_b16 v[90:91], v22 offset:53248
    v_mfma_f32_16x16x32_bf16 v[208:211], v[116:119], a[196:199], v[208:211]
    buffer_load_dwordx4 v49, s[12:15], s53 offen offset:3072 lds
    v_mfma_f32_16x16x32_bf16 v[212:215], v[116:119], a[204:207], v[212:215]
    ds_read_b64_tr_b16 v[92:93], v23 offset:49152
    v_mfma_f32_16x16x32_bf16 v[216:219], v[116:119], a[212:215], v[216:219]
    ds_read_b64_tr_b16 v[94:95], v23 offset:53248
    v_mfma_f32_16x16x32_bf16 v[220:223], v[116:119], a[220:223], v[220:223]
    v_exp_f32 v11, v11
    v_mfma_f32_16x16x32_bf16 v[224:227], v[120:123], a[196:199], v[224:227]
    v_exp_f32 v12, v12
    v_mfma_f32_16x16x32_bf16 v[228:231], v[120:123], a[204:207], v[228:231]
    v_add_f32 v11, 1.0, v11
    v_add_f32 v12, 1.0, v12
    v_mfma_f32_16x16x32_bf16 v[232:235], v[120:123], a[212:215], v[232:235]
    v_rcp_f32 v9, v9
    v_mfma_f32_16x16x32_bf16 v[236:239], v[120:123], a[220:223], v[236:239]
    v_rcp_f32 v10, v10
    v_mfma_f32_16x16x32_bf16 v[240:243], v[124:127], a[196:199], v[240:243]
    v_rcp_f32 v11, v11
    v_mfma_f32_16x16x32_bf16 v[244:247], v[124:127], a[204:207], v[244:247]
    v_rcp_f32 v12, v12
    v_mfma_f32_16x16x32_bf16 v[248:251], v[124:127], a[212:215], v[248:251]
    v_mul_f32 v5, v5, v9
    v_mul_f32 v6, v6, v10
    v_mfma_f32_16x16x32_bf16 v[252:255], v[124:127], a[220:223], v[252:255]
    s_waitcnt lgkmcnt(0)
    v_mul_f32 v7, v7, v11
    v_mul_f32 v8, v8, v12
    v_cvt_pk_bf16_f32 v58, v5, v6
    v_cvt_pk_bf16_f32 v59, v7, v8
    s_nop 0
    buffer_store_dwordx4 v[56:59], v54, s[32:35], s54 offen offset:0 sc1
    v_mfma_f32_16x16x32_bf16 v[128:131], v[64:67], a[224:227], v[128:131]
    ds_read_b64_tr_b16 v[96:97], v16 offset:57344
    v_accvgpr_read_b32 v1, a32
    v_mfma_f32_16x16x32_bf16 v[132:135], v[64:67], a[232:235], v[132:135]
    ds_read_b64_tr_b16 v[98:99], v16 offset:61440
    v_accvgpr_read_b32 v2, a33
    v_mfma_f32_16x16x32_bf16 v[136:139], v[64:67], a[240:243], v[136:139]
    s_add_u32 m0, s44, 81920
    s_mov_b32 s53, 16384
    buffer_load_dwordx4 v48, s[12:15], s53 offen offset:0 lds
    v_accvgpr_read_b32 v3, a34
    v_mfma_f32_16x16x32_bf16 v[140:143], v[64:67], a[248:251], v[140:143]
    ds_read_b64_tr_b16 v[100:101], v17 offset:57344
    v_accvgpr_read_b32 v4, a35
    v_mfma_f32_16x16x32_bf16 v[144:147], v[68:71], a[224:227], v[144:147]
    ds_read_b64_tr_b16 v[102:103], v17 offset:61440
    v_mul_f32 v9, 0xc13504f3, v1
    v_mfma_f32_16x16x32_bf16 v[148:151], v[68:71], a[232:235], v[148:151]
    v_mul_f32 v10, 0xc13504f3, v2
    v_mul_f32 v11, 0xc13504f3, v3
    v_mfma_f32_16x16x32_bf16 v[152:155], v[68:71], a[240:243], v[152:155]
    ds_read_b64_tr_b16 v[104:105], v18 offset:57344
    v_mul_f32 v12, 0xc13504f3, v4
    v_mfma_f32_16x16x32_bf16 v[156:159], v[68:71], a[248:251], v[156:159]
    ds_read_b64_tr_b16 v[106:107], v18 offset:61440
    v_accvgpr_read_b32 v5, a96
    v_mfma_f32_16x16x32_bf16 v[160:163], v[72:75], a[224:227], v[160:163]
    buffer_load_dwordx4 v49, s[12:15], s53 offen offset:1024 lds
    v_accvgpr_read_b32 v6, a97
    v_mfma_f32_16x16x32_bf16 v[164:167], v[72:75], a[232:235], v[164:167]
    ds_read_b64_tr_b16 v[108:109], v19 offset:57344
    v_accvgpr_read_b32 v7, a98
    v_mfma_f32_16x16x32_bf16 v[168:171], v[72:75], a[240:243], v[168:171]
    ds_read_b64_tr_b16 v[110:111], v19 offset:61440
    v_accvgpr_read_b32 v8, a99
    v_mfma_f32_16x16x32_bf16 v[172:175], v[72:75], a[248:251], v[172:175]
    v_exp_f32 v9, v9
    v_mfma_f32_16x16x32_bf16 v[176:179], v[76:79], a[224:227], v[176:179]
    ds_read_b64_tr_b16 v[112:113], v20 offset:57344
    v_mul_f32 v5, v1, v5
    v_mfma_f32_16x16x32_bf16 v[180:183], v[76:79], a[232:235], v[180:183]
    ds_read_b64_tr_b16 v[114:115], v20 offset:61440
    v_mul_f32 v6, v2, v6
    v_mfma_f32_16x16x32_bf16 v[184:187], v[76:79], a[240:243], v[184:187]
    buffer_load_dwordx4 v48, s[12:15], s53 offen offset:2048 lds
    v_mul_f32 v7, v3, v7
    v_mfma_f32_16x16x32_bf16 v[188:191], v[76:79], a[248:251], v[188:191]
    ds_read_b64_tr_b16 v[116:117], v21 offset:57344
    v_mul_f32 v8, v4, v8
    v_mfma_f32_16x16x32_bf16 v[192:195], v[80:83], a[224:227], v[192:195]
    ds_read_b64_tr_b16 v[118:119], v21 offset:61440
    v_add_f32 v9, 1.0, v9
    v_mfma_f32_16x16x32_bf16 v[196:199], v[80:83], a[232:235], v[196:199]
    v_exp_f32 v10, v10
    v_mfma_f32_16x16x32_bf16 v[200:203], v[80:83], a[240:243], v[200:203]
    ds_read_b64_tr_b16 v[120:121], v22 offset:57344
    v_add_f32 v10, 1.0, v10
    v_mfma_f32_16x16x32_bf16 v[204:207], v[80:83], a[248:251], v[204:207]
    ds_read_b64_tr_b16 v[122:123], v22 offset:61440
    v_mfma_f32_16x16x32_bf16 v[208:211], v[84:87], a[224:227], v[208:211]
    buffer_load_dwordx4 v49, s[12:15], s53 offen offset:3072 lds
    v_mfma_f32_16x16x32_bf16 v[212:215], v[84:87], a[232:235], v[212:215]
    ds_read_b64_tr_b16 v[124:125], v23 offset:57344
    v_mfma_f32_16x16x32_bf16 v[216:219], v[84:87], a[240:243], v[216:219]
    ds_read_b64_tr_b16 v[126:127], v23 offset:61440
    v_mfma_f32_16x16x32_bf16 v[220:223], v[84:87], a[248:251], v[220:223]
    v_exp_f32 v11, v11
    v_mfma_f32_16x16x32_bf16 v[224:227], v[88:91], a[224:227], v[224:227]
    v_exp_f32 v12, v12
    v_mfma_f32_16x16x32_bf16 v[228:231], v[88:91], a[232:235], v[228:231]
    v_add_f32 v11, 1.0, v11
    v_add_f32 v12, 1.0, v12
    v_mfma_f32_16x16x32_bf16 v[232:235], v[88:91], a[240:243], v[232:235]
    v_rcp_f32 v9, v9
    v_mfma_f32_16x16x32_bf16 v[236:239], v[88:91], a[248:251], v[236:239]
    v_rcp_f32 v10, v10
    v_mfma_f32_16x16x32_bf16 v[240:243], v[92:95], a[224:227], v[240:243]
    v_rcp_f32 v11, v11
    v_mfma_f32_16x16x32_bf16 v[244:247], v[92:95], a[232:235], v[244:247]
    v_rcp_f32 v12, v12
    v_mfma_f32_16x16x32_bf16 v[248:251], v[92:95], a[240:243], v[248:251]
    v_mul_f32 v5, v5, v9
    v_mul_f32 v6, v6, v10
    v_mfma_f32_16x16x32_bf16 v[252:255], v[92:95], a[248:251], v[252:255]
    s_waitcnt lgkmcnt(0)
    v_mul_f32 v7, v7, v11
    v_mul_f32 v8, v8, v12
    v_cvt_pk_bf16_f32 v60, v5, v6
    v_cvt_pk_bf16_f32 v61, v7, v8
    v_mfma_f32_16x16x32_bf16 v[128:131], v[96:99], a[228:231], v[128:131]
    v_accvgpr_read_b32 v1, a48
    v_accvgpr_read_b32 v2, a49
    v_mfma_f32_16x16x32_bf16 v[132:135], v[96:99], a[236:239], v[132:135]
    v_accvgpr_read_b32 v3, a50
    v_accvgpr_read_b32 v4, a51
    v_mfma_f32_16x16x32_bf16 v[136:139], v[96:99], a[244:247], v[136:139]
    v_mul_f32 v9, 0xc13504f3, v1
    v_mul_f32 v10, 0xc13504f3, v2
    v_mfma_f32_16x16x32_bf16 v[140:143], v[96:99], a[252:255], v[140:143]
    v_mul_f32 v11, 0xc13504f3, v3
    v_mul_f32 v12, 0xc13504f3, v4
    v_mfma_f32_16x16x32_bf16 v[144:147], v[100:103], a[228:231], v[144:147]
    v_accvgpr_read_b32 v5, a112
    v_accvgpr_read_b32 v6, a113
    v_mfma_f32_16x16x32_bf16 v[148:151], v[100:103], a[236:239], v[148:151]
    v_accvgpr_read_b32 v7, a114
    v_accvgpr_read_b32 v8, a115
    v_mfma_f32_16x16x32_bf16 v[152:155], v[100:103], a[244:247], v[152:155]
    v_exp_f32 v9, v9
    v_mfma_f32_16x16x32_bf16 v[156:159], v[100:103], a[252:255], v[156:159]
    v_exp_f32 v10, v10
    v_mfma_f32_16x16x32_bf16 v[160:163], v[104:107], a[228:231], v[160:163]
    v_exp_f32 v11, v11
    v_mfma_f32_16x16x32_bf16 v[164:167], v[104:107], a[236:239], v[164:167]
    v_exp_f32 v12, v12
    v_mfma_f32_16x16x32_bf16 v[168:171], v[104:107], a[244:247], v[168:171]
    v_mul_f32 v5, v1, v5
    v_mul_f32 v6, v2, v6
    v_mfma_f32_16x16x32_bf16 v[172:175], v[104:107], a[252:255], v[172:175]
    v_mul_f32 v7, v3, v7
    v_mul_f32 v8, v4, v8
    v_mfma_f32_16x16x32_bf16 v[176:179], v[108:111], a[228:231], v[176:179]
    v_add_f32 v9, 1.0, v9
    v_add_f32 v10, 1.0, v10
    v_mfma_f32_16x16x32_bf16 v[180:183], v[108:111], a[236:239], v[180:183]
    v_add_f32 v11, 1.0, v11
    v_add_f32 v12, 1.0, v12
    v_mfma_f32_16x16x32_bf16 v[184:187], v[108:111], a[244:247], v[184:187]
    v_rcp_f32 v9, v9
    v_mfma_f32_16x16x32_bf16 v[188:191], v[108:111], a[252:255], v[188:191]
    v_rcp_f32 v10, v10
    v_mfma_f32_16x16x32_bf16 v[192:195], v[112:115], a[228:231], v[192:195]
    v_rcp_f32 v11, v11
    v_mfma_f32_16x16x32_bf16 v[196:199], v[112:115], a[236:239], v[196:199]
    v_rcp_f32 v12, v12
    v_mfma_f32_16x16x32_bf16 v[200:203], v[112:115], a[244:247], v[200:203]
    v_mul_f32 v5, v5, v9
    v_mul_f32 v6, v6, v10
    v_mfma_f32_16x16x32_bf16 v[204:207], v[112:115], a[252:255], v[204:207]
    v_mul_f32 v7, v7, v11
    v_mul_f32 v8, v8, v12
    v_mfma_f32_16x16x32_bf16 v[208:211], v[116:119], a[228:231], v[208:211]
    v_cvt_pk_bf16_f32 v62, v5, v6
    v_cvt_pk_bf16_f32 v63, v7, v8
    v_mfma_f32_16x16x32_bf16 v[212:215], v[116:119], a[236:239], v[212:215]
    buffer_store_dwordx4 v[60:63], v54, s[32:35], s54 offen offset:1024 sc1
    v_mfma_f32_16x16x32_bf16 v[216:219], v[116:119], a[244:247], v[216:219]
    v_mfma_f32_16x16x32_bf16 v[220:223], v[116:119], a[252:255], v[220:223]
    v_mfma_f32_16x16x32_bf16 v[224:227], v[120:123], a[228:231], v[224:227]
    v_mfma_f32_16x16x32_bf16 v[228:231], v[120:123], a[236:239], v[228:231]
    v_mfma_f32_16x16x32_bf16 v[232:235], v[120:123], a[244:247], v[232:235]
    v_mfma_f32_16x16x32_bf16 v[236:239], v[120:123], a[252:255], v[236:239]
    v_mfma_f32_16x16x32_bf16 v[240:243], v[124:127], a[228:231], v[240:243]
    v_mfma_f32_16x16x32_bf16 v[244:247], v[124:127], a[236:239], v[244:247]
    v_mfma_f32_16x16x32_bf16 v[248:251], v[124:127], a[244:247], v[248:251]
    v_mfma_f32_16x16x32_bf16 v[252:255], v[124:127], a[252:255], v[252:255]
    s_waitcnt lgkmcnt(0)
    v_accvgpr_read_b32 v1, a4
    v_accvgpr_read_b32 v2, a5
    v_accvgpr_read_b32 v3, a6
    v_accvgpr_read_b32 v4, a7
    v_mul_f32 v9, 0xc13504f3, v1
    v_mul_f32 v10, 0xc13504f3, v2
    v_mul_f32 v11, 0xc13504f3, v3
    v_mul_f32 v12, 0xc13504f3, v4
    v_accvgpr_read_b32 v5, a68
    v_accvgpr_read_b32 v6, a69
    v_accvgpr_read_b32 v7, a70
    v_accvgpr_read_b32 v8, a71
    v_exp_f32 v9, v9
    v_exp_f32 v10, v10
    v_exp_f32 v11, v11
    v_exp_f32 v12, v12
    v_mul_f32 v5, v1, v5
    v_mul_f32 v6, v2, v6
    v_mul_f32 v7, v3, v7
    v_mul_f32 v8, v4, v8
    v_add_f32 v9, 1.0, v9
    v_add_f32 v10, 1.0, v10
    v_add_f32 v11, 1.0, v11
    v_add_f32 v12, 1.0, v12
    v_rcp_f32 v9, v9
    v_rcp_f32 v10, v10
    v_rcp_f32 v11, v11
    v_rcp_f32 v12, v12
    v_mul_f32 v5, v5, v9
    v_mul_f32 v6, v6, v10
    v_mul_f32 v7, v7, v11
    v_mul_f32 v8, v8, v12
    v_cvt_pk_bf16_f32 v56, v5, v6
    v_cvt_pk_bf16_f32 v57, v7, v8
    v_accvgpr_read_b32 v1, a20
    v_accvgpr_read_b32 v2, a21
    v_accvgpr_read_b32 v3, a22
    v_accvgpr_read_b32 v4, a23
    v_mul_f32 v9, 0xc13504f3, v1
    v_mul_f32 v10, 0xc13504f3, v2
    v_mul_f32 v11, 0xc13504f3, v3
    v_mul_f32 v12, 0xc13504f3, v4
    v_accvgpr_read_b32 v5, a84
    v_accvgpr_read_b32 v6, a85
    v_accvgpr_read_b32 v7, a86
    v_accvgpr_read_b32 v8, a87
    v_exp_f32 v9, v9
    v_exp_f32 v10, v10
    v_exp_f32 v11, v11
    v_exp_f32 v12, v12
    v_mul_f32 v5, v1, v5
    v_mul_f32 v6, v2, v6
    v_mul_f32 v7, v3, v7
    v_mul_f32 v8, v4, v8
    v_add_f32 v9, 1.0, v9
    v_add_f32 v10, 1.0, v10
    v_add_f32 v11, 1.0, v11
    v_add_f32 v12, 1.0, v12
    v_rcp_f32 v9, v9
    v_rcp_f32 v10, v10
    v_rcp_f32 v11, v11
    v_rcp_f32 v12, v12
    v_mul_f32 v5, v5, v9
    v_mul_f32 v6, v6, v10
    v_mul_f32 v7, v7, v11
    v_mul_f32 v8, v8, v12
    v_cvt_pk_bf16_f32 v58, v5, v6
    v_cvt_pk_bf16_f32 v59, v7, v8
    s_nop 0
    buffer_store_dwordx4 v[56:59], v54, s[32:35], s55 offen offset:0 sc1
    v_accvgpr_read_b32 v1, a36
    v_accvgpr_read_b32 v2, a37
    v_accvgpr_read_b32 v3, a38
    v_accvgpr_read_b32 v4, a39
    v_mul_f32 v9, 0xc13504f3, v1
    v_mul_f32 v10, 0xc13504f3, v2
    v_mul_f32 v11, 0xc13504f3, v3
    v_mul_f32 v12, 0xc13504f3, v4
    v_accvgpr_read_b32 v5, a100
    v_accvgpr_read_b32 v6, a101
    v_accvgpr_read_b32 v7, a102
    v_accvgpr_read_b32 v8, a103
    v_exp_f32 v9, v9
    v_exp_f32 v10, v10
    v_exp_f32 v11, v11
    v_exp_f32 v12, v12
    v_mul_f32 v5, v1, v5
    v_mul_f32 v6, v2, v6
    v_mul_f32 v7, v3, v7
    v_mul_f32 v8, v4, v8
    v_add_f32 v9, 1.0, v9
    v_add_f32 v10, 1.0, v10
    v_add_f32 v11, 1.0, v11
    v_add_f32 v12, 1.0, v12
    v_rcp_f32 v9, v9
    v_rcp_f32 v10, v10
    v_rcp_f32 v11, v11
    v_rcp_f32 v12, v12
    v_mul_f32 v5, v5, v9
    v_mul_f32 v6, v6, v10
    v_mul_f32 v7, v7, v11
    v_mul_f32 v8, v8, v12
    v_cvt_pk_bf16_f32 v60, v5, v6
    v_cvt_pk_bf16_f32 v61, v7, v8
    v_accvgpr_read_b32 v1, a52
    v_accvgpr_read_b32 v2, a53
    v_accvgpr_read_b32 v3, a54
    v_accvgpr_read_b32 v4, a55
    v_mul_f32 v9, 0xc13504f3, v1
    v_mul_f32 v10, 0xc13504f3, v2
    v_mul_f32 v11, 0xc13504f3, v3
    v_mul_f32 v12, 0xc13504f3, v4
    v_accvgpr_read_b32 v5, a116
    v_accvgpr_read_b32 v6, a117
    v_accvgpr_read_b32 v7, a118
    v_accvgpr_read_b32 v8, a119
    v_exp_f32 v9, v9
    v_exp_f32 v10, v10
    v_exp_f32 v11, v11
    v_exp_f32 v12, v12
    v_mul_f32 v5, v1, v5
    v_mul_f32 v6, v2, v6
    v_mul_f32 v7, v3, v7
    v_mul_f32 v8, v4, v8
    v_add_f32 v9, 1.0, v9
    v_add_f32 v10, 1.0, v10
    v_add_f32 v11, 1.0, v11
    v_add_f32 v12, 1.0, v12
    v_rcp_f32 v9, v9
    v_rcp_f32 v10, v10
    v_rcp_f32 v11, v11
    v_rcp_f32 v12, v12
    v_mul_f32 v5, v5, v9
    v_mul_f32 v6, v6, v10
    v_mul_f32 v7, v7, v11
    v_mul_f32 v8, v8, v12
    v_cvt_pk_bf16_f32 v62, v5, v6
    v_cvt_pk_bf16_f32 v63, v7, v8
    s_nop 0
    buffer_store_dwordx4 v[60:63], v54, s[32:35], s55 offen offset:1024 sc1
    v_accvgpr_read_b32 v1, a8
    v_accvgpr_read_b32 v2, a9
    v_accvgpr_read_b32 v3, a10
    v_accvgpr_read_b32 v4, a11
    v_mul_f32 v9, 0xc13504f3, v1
    v_mul_f32 v10, 0xc13504f3, v2
    v_mul_f32 v11, 0xc13504f3, v3
    v_mul_f32 v12, 0xc13504f3, v4
    v_accvgpr_read_b32 v5, a72
    v_accvgpr_read_b32 v6, a73
    v_accvgpr_read_b32 v7, a74
    v_accvgpr_read_b32 v8, a75
    v_exp_f32 v9, v9
    v_exp_f32 v10, v10
    v_exp_f32 v11, v11
    v_exp_f32 v12, v12
    v_mul_f32 v5, v1, v5
    v_mul_f32 v6, v2, v6
    v_mul_f32 v7, v3, v7
    v_mul_f32 v8, v4, v8
    v_add_f32 v9, 1.0, v9
    v_add_f32 v10, 1.0, v10
    v_add_f32 v11, 1.0, v11
    v_add_f32 v12, 1.0, v12
    v_rcp_f32 v9, v9
    v_rcp_f32 v10, v10
    v_rcp_f32 v11, v11
    v_rcp_f32 v12, v12
    v_mul_f32 v5, v5, v9
    v_mul_f32 v6, v6, v10
    v_mul_f32 v7, v7, v11
    v_mul_f32 v8, v8, v12
    v_cvt_pk_bf16_f32 v56, v5, v6
    v_cvt_pk_bf16_f32 v57, v7, v8
    v_accvgpr_read_b32 v1, a24
    v_accvgpr_read_b32 v2, a25
    v_accvgpr_read_b32 v3, a26
    v_accvgpr_read_b32 v4, a27
    v_mul_f32 v9, 0xc13504f3, v1
    v_mul_f32 v10, 0xc13504f3, v2
    v_mul_f32 v11, 0xc13504f3, v3
    v_mul_f32 v12, 0xc13504f3, v4
    v_accvgpr_read_b32 v5, a88
    v_accvgpr_read_b32 v6, a89
    v_accvgpr_read_b32 v7, a90
    v_accvgpr_read_b32 v8, a91
    v_exp_f32 v9, v9
    v_exp_f32 v10, v10
    v_exp_f32 v11, v11
    v_exp_f32 v12, v12
    v_mul_f32 v5, v1, v5
    v_mul_f32 v6, v2, v6
    v_mul_f32 v7, v3, v7
    v_mul_f32 v8, v4, v8
    v_add_f32 v9, 1.0, v9
    v_add_f32 v10, 1.0, v10
    v_add_f32 v11, 1.0, v11
    v_add_f32 v12, 1.0, v12
    v_rcp_f32 v9, v9
    v_rcp_f32 v10, v10
    v_rcp_f32 v11, v11
    v_rcp_f32 v12, v12
    v_mul_f32 v5, v5, v9
    v_mul_f32 v6, v6, v10
    v_mul_f32 v7, v7, v11
    v_mul_f32 v8, v8, v12
    v_cvt_pk_bf16_f32 v58, v5, v6
    v_cvt_pk_bf16_f32 v59, v7, v8
    s_nop 0
    buffer_store_dwordx4 v[56:59], v54, s[32:35], s56 offen offset:0 sc1
    v_accvgpr_read_b32 v1, a40
    v_accvgpr_read_b32 v2, a41
    v_accvgpr_read_b32 v3, a42
    v_accvgpr_read_b32 v4, a43
    v_mul_f32 v9, 0xc13504f3, v1
    v_mul_f32 v10, 0xc13504f3, v2
    v_mul_f32 v11, 0xc13504f3, v3
    v_mul_f32 v12, 0xc13504f3, v4
    v_accvgpr_read_b32 v5, a104
    v_accvgpr_read_b32 v6, a105
    v_accvgpr_read_b32 v7, a106
    v_accvgpr_read_b32 v8, a107
    v_exp_f32 v9, v9
    v_exp_f32 v10, v10
    v_exp_f32 v11, v11
    v_exp_f32 v12, v12
    v_mul_f32 v5, v1, v5
    v_mul_f32 v6, v2, v6
    v_mul_f32 v7, v3, v7
    v_mul_f32 v8, v4, v8
    v_add_f32 v9, 1.0, v9
    v_add_f32 v10, 1.0, v10
    v_add_f32 v11, 1.0, v11
    v_add_f32 v12, 1.0, v12
    v_rcp_f32 v9, v9
    v_rcp_f32 v10, v10
    v_rcp_f32 v11, v11
    v_rcp_f32 v12, v12
    v_mul_f32 v5, v5, v9
    v_mul_f32 v6, v6, v10
    v_mul_f32 v7, v7, v11
    v_mul_f32 v8, v8, v12
    v_cvt_pk_bf16_f32 v60, v5, v6
    v_cvt_pk_bf16_f32 v61, v7, v8
    v_accvgpr_read_b32 v1, a56
    v_accvgpr_read_b32 v2, a57
    v_accvgpr_read_b32 v3, a58
    v_accvgpr_read_b32 v4, a59
    v_mul_f32 v9, 0xc13504f3, v1
    v_mul_f32 v10, 0xc13504f3, v2
    v_mul_f32 v11, 0xc13504f3, v3
    v_mul_f32 v12, 0xc13504f3, v4
    v_accvgpr_read_b32 v5, a120
    v_accvgpr_read_b32 v6, a121
    v_accvgpr_read_b32 v7, a122
    v_accvgpr_read_b32 v8, a123
    v_exp_f32 v9, v9
    v_exp_f32 v10, v10
    v_exp_f32 v11, v11
    v_exp_f32 v12, v12
    v_mul_f32 v5, v1, v5
    v_mul_f32 v6, v2, v6
    v_mul_f32 v7, v3, v7
    v_mul_f32 v8, v4, v8
    v_add_f32 v9, 1.0, v9
    v_add_f32 v10, 1.0, v10
    v_add_f32 v11, 1.0, v11
    v_add_f32 v12, 1.0, v12
    v_rcp_f32 v9, v9
    v_rcp_f32 v10, v10
    v_rcp_f32 v11, v11
    v_rcp_f32 v12, v12
    v_mul_f32 v5, v5, v9
    v_mul_f32 v6, v6, v10
    v_mul_f32 v7, v7, v11
    v_mul_f32 v8, v8, v12
    v_cvt_pk_bf16_f32 v62, v5, v6
    v_cvt_pk_bf16_f32 v63, v7, v8
    s_nop 0
    buffer_store_dwordx4 v[60:63], v54, s[32:35], s56 offen offset:1024 sc1
    v_accvgpr_read_b32 v1, a12
    v_accvgpr_read_b32 v2, a13
    v_accvgpr_read_b32 v3, a14
    v_accvgpr_read_b32 v4, a15
    v_mul_f32 v9, 0xc13504f3, v1
    v_mul_f32 v10, 0xc13504f3, v2
    v_mul_f32 v11, 0xc13504f3, v3
    v_mul_f32 v12, 0xc13504f3, v4
    v_accvgpr_read_b32 v5, a76
    v_accvgpr_read_b32 v6, a77
    v_accvgpr_read_b32 v7, a78
    v_accvgpr_read_b32 v8, a79
    v_exp_f32 v9, v9
    v_exp_f32 v10, v10
    v_exp_f32 v11, v11
    v_exp_f32 v12, v12
    v_mul_f32 v5, v1, v5
    v_mul_f32 v6, v2, v6
    v_mul_f32 v7, v3, v7
    v_mul_f32 v8, v4, v8
    v_add_f32 v9, 1.0, v9
    v_add_f32 v10, 1.0, v10
    v_add_f32 v11, 1.0, v11
    v_add_f32 v12, 1.0, v12
    v_rcp_f32 v9, v9
    v_rcp_f32 v10, v10
    v_rcp_f32 v11, v11
    v_rcp_f32 v12, v12
    v_mul_f32 v5, v5, v9
    v_mul_f32 v6, v6, v10
    v_mul_f32 v7, v7, v11
    v_mul_f32 v8, v8, v12
    v_cvt_pk_bf16_f32 v56, v5, v6
    v_cvt_pk_bf16_f32 v57, v7, v8
    v_accvgpr_read_b32 v1, a28
    v_accvgpr_read_b32 v2, a29
    v_accvgpr_read_b32 v3, a30
    v_accvgpr_read_b32 v4, a31
    v_mul_f32 v9, 0xc13504f3, v1
    v_mul_f32 v10, 0xc13504f3, v2
    v_mul_f32 v11, 0xc13504f3, v3
    v_mul_f32 v12, 0xc13504f3, v4
    v_accvgpr_read_b32 v5, a92
    v_accvgpr_read_b32 v6, a93
    v_accvgpr_read_b32 v7, a94
    v_accvgpr_read_b32 v8, a95
    v_exp_f32 v9, v9
    v_exp_f32 v10, v10
    v_exp_f32 v11, v11
    v_exp_f32 v12, v12
    v_mul_f32 v5, v1, v5
    v_mul_f32 v6, v2, v6
    v_mul_f32 v7, v3, v7
    v_mul_f32 v8, v4, v8
    v_add_f32 v9, 1.0, v9
    v_add_f32 v10, 1.0, v10
    v_add_f32 v11, 1.0, v11
    v_add_f32 v12, 1.0, v12
    v_rcp_f32 v9, v9
    v_rcp_f32 v10, v10
    v_rcp_f32 v11, v11
    v_rcp_f32 v12, v12
    v_mul_f32 v5, v5, v9
    v_mul_f32 v6, v6, v10
    v_mul_f32 v7, v7, v11
    v_mul_f32 v8, v8, v12
    v_cvt_pk_bf16_f32 v58, v5, v6
    v_cvt_pk_bf16_f32 v59, v7, v8
    s_nop 0
    buffer_store_dwordx4 v[56:59], v54, s[32:35], s57 offen offset:0 sc1
    v_accvgpr_read_b32 v1, a44
    v_accvgpr_read_b32 v2, a45
    v_accvgpr_read_b32 v3, a46
    v_accvgpr_read_b32 v4, a47
    v_mul_f32 v9, 0xc13504f3, v1
    v_mul_f32 v10, 0xc13504f3, v2
    v_mul_f32 v11, 0xc13504f3, v3
    v_mul_f32 v12, 0xc13504f3, v4
    v_accvgpr_read_b32 v5, a108
    v_accvgpr_read_b32 v6, a109
    v_accvgpr_read_b32 v7, a110
    v_accvgpr_read_b32 v8, a111
    v_exp_f32 v9, v9
    v_exp_f32 v10, v10
    v_exp_f32 v11, v11
    v_exp_f32 v12, v12
    v_mul_f32 v5, v1, v5
    v_mul_f32 v6, v2, v6
    v_mul_f32 v7, v3, v7
    v_mul_f32 v8, v4, v8
    v_add_f32 v9, 1.0, v9
    v_add_f32 v10, 1.0, v10
    v_add_f32 v11, 1.0, v11
    v_add_f32 v12, 1.0, v12
    v_rcp_f32 v9, v9
    v_rcp_f32 v10, v10
    v_rcp_f32 v11, v11
    v_rcp_f32 v12, v12
    v_mul_f32 v5, v5, v9
    v_mul_f32 v6, v6, v10
    v_mul_f32 v7, v7, v11
    v_mul_f32 v8, v8, v12
    v_cvt_pk_bf16_f32 v60, v5, v6
    v_cvt_pk_bf16_f32 v61, v7, v8
    v_accvgpr_read_b32 v1, a60
    v_accvgpr_read_b32 v2, a61
    v_accvgpr_read_b32 v3, a62
    v_accvgpr_read_b32 v4, a63
    v_mul_f32 v9, 0xc13504f3, v1
    v_mul_f32 v10, 0xc13504f3, v2
    v_mul_f32 v11, 0xc13504f3, v3
    v_mul_f32 v12, 0xc13504f3, v4
    v_accvgpr_read_b32 v5, a124
    v_accvgpr_read_b32 v6, a125
    v_accvgpr_read_b32 v7, a126
    v_accvgpr_read_b32 v8, a127
    v_exp_f32 v9, v9
    v_exp_f32 v10, v10
    v_exp_f32 v11, v11
    v_exp_f32 v12, v12
    v_mul_f32 v5, v1, v5
    v_mul_f32 v6, v2, v6
    v_mul_f32 v7, v3, v7
    v_mul_f32 v8, v4, v8
    v_add_f32 v9, 1.0, v9
    v_add_f32 v10, 1.0, v10
    v_add_f32 v11, 1.0, v11
    v_add_f32 v12, 1.0, v12
    v_rcp_f32 v9, v9
    v_rcp_f32 v10, v10
    v_rcp_f32 v11, v11
    v_rcp_f32 v12, v12
    v_mul_f32 v5, v5, v9
    v_mul_f32 v6, v6, v10
    v_mul_f32 v7, v7, v11
    v_mul_f32 v8, v8, v12
    v_cvt_pk_bf16_f32 v62, v5, v6
    v_cvt_pk_bf16_f32 v63, v7, v8
    s_nop 0
    buffer_store_dwordx4 v[60:63], v54, s[32:35], s57 offen offset:1024 sc1
    s_nop 7
    v_cvt_pk_bf16_f32 v1, v128, v129
    v_cvt_pk_bf16_f32 v2, v130, v131
    v_cvt_pk_bf16_f32 v3, v144, v145
    v_cvt_pk_bf16_f32 v4, v146, v147
    s_nop 0
    v_permlane32_swap_b32 v1, v3
    v_permlane32_swap_b32 v2, v4
    s_nop 0
    v_permlane16_swap_b32 v1, v3
    v_permlane16_swap_b32 v2, v4
    s_nop 0
    v_accvgpr_write_b32 a128, v1
    v_accvgpr_write_b32 a129, v2
    v_accvgpr_write_b32 a130, v3
    v_accvgpr_write_b32 a131, v4
    v_cvt_pk_bf16_f32 v5, v160, v161
    v_cvt_pk_bf16_f32 v6, v162, v163
    v_cvt_pk_bf16_f32 v7, v176, v177
    v_cvt_pk_bf16_f32 v8, v178, v179
    s_nop 0
    v_permlane32_swap_b32 v5, v7
    v_permlane32_swap_b32 v6, v8
    s_nop 0
    v_permlane16_swap_b32 v5, v7
    v_permlane16_swap_b32 v6, v8
    s_nop 0
    v_accvgpr_write_b32 a132, v5
    v_accvgpr_write_b32 a133, v6
    v_accvgpr_write_b32 a134, v7
    v_accvgpr_write_b32 a135, v8
    v_cvt_pk_bf16_f32 v1, v192, v193
    v_cvt_pk_bf16_f32 v2, v194, v195
    v_cvt_pk_bf16_f32 v3, v208, v209
    v_cvt_pk_bf16_f32 v4, v210, v211
    s_nop 0
    v_permlane32_swap_b32 v1, v3
    v_permlane32_swap_b32 v2, v4
    s_nop 0
    v_permlane16_swap_b32 v1, v3
    v_permlane16_swap_b32 v2, v4
    s_nop 0
    v_accvgpr_write_b32 a136, v1
    v_accvgpr_write_b32 a137, v2
    v_accvgpr_write_b32 a138, v3
    v_accvgpr_write_b32 a139, v4
    v_cvt_pk_bf16_f32 v5, v224, v225
    v_cvt_pk_bf16_f32 v6, v226, v227
    v_cvt_pk_bf16_f32 v7, v240, v241
    v_cvt_pk_bf16_f32 v8, v242, v243
    s_nop 0
    v_permlane32_swap_b32 v5, v7
    v_permlane32_swap_b32 v6, v8
    s_nop 0
    v_permlane16_swap_b32 v5, v7
    v_permlane16_swap_b32 v6, v8
    s_nop 0
    v_accvgpr_write_b32 a140, v5
    v_accvgpr_write_b32 a141, v6
    v_accvgpr_write_b32 a142, v7
    v_accvgpr_write_b32 a143, v8
    v_cvt_pk_bf16_f32 v1, v132, v133
    v_cvt_pk_bf16_f32 v2, v134, v135
    v_cvt_pk_bf16_f32 v3, v148, v149
    v_cvt_pk_bf16_f32 v4, v150, v151
    s_nop 0
    v_permlane32_swap_b32 v1, v3
    v_permlane32_swap_b32 v2, v4
    s_nop 0
    v_permlane16_swap_b32 v1, v3
    v_permlane16_swap_b32 v2, v4
    s_nop 0
    v_accvgpr_write_b32 a144, v1
    v_accvgpr_write_b32 a145, v2
    v_accvgpr_write_b32 a146, v3
    v_accvgpr_write_b32 a147, v4
    v_cvt_pk_bf16_f32 v5, v164, v165
    v_cvt_pk_bf16_f32 v6, v166, v167
    v_cvt_pk_bf16_f32 v7, v180, v181
    v_cvt_pk_bf16_f32 v8, v182, v183
    s_nop 0
    v_permlane32_swap_b32 v5, v7
    v_permlane32_swap_b32 v6, v8
    s_nop 0
    v_permlane16_swap_b32 v5, v7
    v_permlane16_swap_b32 v6, v8
    s_nop 0
    v_accvgpr_write_b32 a148, v5
    v_accvgpr_write_b32 a149, v6
    v_accvgpr_write_b32 a150, v7
    v_accvgpr_write_b32 a151, v8
    v_cvt_pk_bf16_f32 v1, v196, v197
    v_cvt_pk_bf16_f32 v2, v198, v199
    v_cvt_pk_bf16_f32 v3, v212, v213
    v_cvt_pk_bf16_f32 v4, v214, v215
    s_nop 0
    v_permlane32_swap_b32 v1, v3
    v_permlane32_swap_b32 v2, v4
    s_nop 0
    v_permlane16_swap_b32 v1, v3
    v_permlane16_swap_b32 v2, v4
    s_nop 0
    v_accvgpr_write_b32 a152, v1
    v_accvgpr_write_b32 a153, v2
    v_accvgpr_write_b32 a154, v3
    v_accvgpr_write_b32 a155, v4
    v_cvt_pk_bf16_f32 v5, v228, v229
    v_cvt_pk_bf16_f32 v6, v230, v231
    v_cvt_pk_bf16_f32 v7, v244, v245
    v_cvt_pk_bf16_f32 v8, v246, v247
    s_nop 0
    v_permlane32_swap_b32 v5, v7
    v_permlane32_swap_b32 v6, v8
    s_nop 0
    v_permlane16_swap_b32 v5, v7
    v_permlane16_swap_b32 v6, v8
    s_nop 0
    v_accvgpr_write_b32 a156, v5
    v_accvgpr_write_b32 a157, v6
    v_accvgpr_write_b32 a158, v7
    v_accvgpr_write_b32 a159, v8
    s_waitcnt vmcnt(7) lgkmcnt(0)
    s_barrier
    ds_read_b128 a[192:195], v40 offset:0
    ds_read_b128 a[196:199], v41 offset:0
    ds_read_b128 a[200:203], v42 offset:0
    ds_read_b128 a[204:207], v43 offset:0
    ds_read_b128 a[208:211], v40 offset:4096
    ds_read_b128 a[212:215], v41 offset:4096
    ds_read_b128 a[216:219], v42 offset:4096
    ds_read_b128 a[220:223], v43 offset:4096
    ds_read_b128 a[224:227], v40 offset:8192
    ds_read_b128 a[228:231], v41 offset:8192
    ds_read_b128 a[232:235], v42 offset:8192
    ds_read_b128 a[236:239], v43 offset:8192
    ds_read_b128 a[240:243], v40 offset:12288
    ds_read_b128 a[244:247], v41 offset:12288
    ds_read_b128 a[248:251], v42 offset:12288
    ds_read_b128 a[252:255], v43 offset:12288
    v_cvt_pk_bf16_f32 v1, v136, v137
    v_cvt_pk_bf16_f32 v2, v138, v139
    v_cvt_pk_bf16_f32 v3, v152, v153
    v_cvt_pk_bf16_f32 v4, v154, v155
    s_nop 0
    v_permlane32_swap_b32 v1, v3
    v_permlane32_swap_b32 v2, v4
    s_nop 0
    v_permlane16_swap_b32 v1, v3
    v_permlane16_swap_b32 v2, v4
    s_nop 0
    v_accvgpr_write_b32 a160, v1
    v_accvgpr_write_b32 a161, v2
    v_accvgpr_write_b32 a162, v3
    v_accvgpr_write_b32 a163, v4
    v_cvt_pk_bf16_f32 v5, v168, v169
    v_cvt_pk_bf16_f32 v6, v170, v171
    v_cvt_pk_bf16_f32 v7, v184, v185
    v_cvt_pk_bf16_f32 v8, v186, v187
    s_nop 0
    v_permlane32_swap_b32 v5, v7
    v_permlane32_swap_b32 v6, v8
    s_nop 0
    v_permlane16_swap_b32 v5, v7
    v_permlane16_swap_b32 v6, v8
    s_nop 0
    v_accvgpr_write_b32 a164, v5
    v_accvgpr_write_b32 a165, v6
    v_accvgpr_write_b32 a166, v7
    v_accvgpr_write_b32 a167, v8
    v_cvt_pk_bf16_f32 v1, v200, v201
    v_cvt_pk_bf16_f32 v2, v202, v203
    v_cvt_pk_bf16_f32 v3, v216, v217
    v_cvt_pk_bf16_f32 v4, v218, v219
    s_nop 0
    v_permlane32_swap_b32 v1, v3
    v_permlane32_swap_b32 v2, v4
    s_nop 0
    v_permlane16_swap_b32 v1, v3
    v_permlane16_swap_b32 v2, v4
    s_nop 0
    v_accvgpr_write_b32 a168, v1
    v_accvgpr_write_b32 a169, v2
    v_accvgpr_write_b32 a170, v3
    v_accvgpr_write_b32 a171, v4
    v_cvt_pk_bf16_f32 v5, v232, v233
    v_cvt_pk_bf16_f32 v6, v234, v235
    v_cvt_pk_bf16_f32 v7, v248, v249
    v_cvt_pk_bf16_f32 v8, v250, v251
    s_nop 0
    v_permlane32_swap_b32 v5, v7
    v_permlane32_swap_b32 v6, v8
    s_nop 0
    v_permlane16_swap_b32 v5, v7
    v_permlane16_swap_b32 v6, v8
    s_nop 0
    v_accvgpr_write_b32 a172, v5
    v_accvgpr_write_b32 a173, v6
    v_accvgpr_write_b32 a174, v7
    v_accvgpr_write_b32 a175, v8
    v_cvt_pk_bf16_f32 v1, v140, v141
    v_cvt_pk_bf16_f32 v2, v142, v143
    v_cvt_pk_bf16_f32 v3, v156, v157
    v_cvt_pk_bf16_f32 v4, v158, v159
    s_nop 0
    v_permlane32_swap_b32 v1, v3
    v_permlane32_swap_b32 v2, v4
    s_nop 0
    v_permlane16_swap_b32 v1, v3
    v_permlane16_swap_b32 v2, v4
    s_nop 0
    v_accvgpr_write_b32 a176, v1
    v_accvgpr_write_b32 a177, v2
    v_accvgpr_write_b32 a178, v3
    v_accvgpr_write_b32 a179, v4
    v_cvt_pk_bf16_f32 v5, v172, v173
    v_cvt_pk_bf16_f32 v6, v174, v175
    v_cvt_pk_bf16_f32 v7, v188, v189
    v_cvt_pk_bf16_f32 v8, v190, v191
    s_nop 0
    v_permlane32_swap_b32 v5, v7
    v_permlane32_swap_b32 v6, v8
    s_nop 0
    v_permlane16_swap_b32 v5, v7
    v_permlane16_swap_b32 v6, v8
    s_nop 0
    v_accvgpr_write_b32 a180, v5
    v_accvgpr_write_b32 a181, v6
    v_accvgpr_write_b32 a182, v7
    v_accvgpr_write_b32 a183, v8
    v_cvt_pk_bf16_f32 v1, v204, v205
    v_cvt_pk_bf16_f32 v2, v206, v207
    v_cvt_pk_bf16_f32 v3, v220, v221
    v_cvt_pk_bf16_f32 v4, v222, v223
    s_nop 0
    v_permlane32_swap_b32 v1, v3
    v_permlane32_swap_b32 v2, v4
    s_nop 0
    v_permlane16_swap_b32 v1, v3
    v_permlane16_swap_b32 v2, v4
    s_nop 0
    v_accvgpr_write_b32 a184, v1
    v_accvgpr_write_b32 a185, v2
    v_accvgpr_write_b32 a186, v3
    v_accvgpr_write_b32 a187, v4
    v_cvt_pk_bf16_f32 v5, v236, v237
    v_cvt_pk_bf16_f32 v6, v238, v239
    v_cvt_pk_bf16_f32 v7, v252, v253
    v_cvt_pk_bf16_f32 v8, v254, v255
    s_nop 0
    v_permlane32_swap_b32 v5, v7
    v_permlane32_swap_b32 v6, v8
    s_nop 0
    v_permlane16_swap_b32 v5, v7
    v_permlane16_swap_b32 v6, v8
    s_nop 0
    v_accvgpr_write_b32 a188, v5
    v_accvgpr_write_b32 a189, v6
    v_accvgpr_write_b32 a190, v7
    v_accvgpr_write_b32 a191, v8
    v_mov_b32 v244, 0
    v_mov_b32 v245, 0
    v_mov_b32 v246, 0
    v_mov_b32 v247, 0
    v_mov_b32 v240, 0
    v_mov_b32 v241, 0
    v_mov_b32 v242, 0
    v_mov_b32 v243, 0
    v_mov_b32 v32, 0x3f803f80
    v_mov_b32 v33, 0x3f803f80
    v_mov_b32 v34, 0x3f803f80
    v_mov_b32 v35, 0x3f803f80
    v_mov_b32 v36, 0
    v_mov_b32 v37, 0
    v_mov_b32 v38, 0
    v_mov_b32 v39, 0
    v_mov_b32 v56, 0
    v_mov_b32 v57, 0
    v_mov_b32 v58, 0
    v_mov_b32 v59, 0
    s_mov_b32 s65, 507904
    s_mov_b32 s46, 49152
    s_mov_b32 s47, 32768
    s_waitcnt lgkmcnt(0)
    v_mfma_f32_16x16x32_bf16 v[128:131], a[192:195], a[128:131], 0
    v_mfma_f32_16x16x32_bf16 v[128:131], a[196:199], a[132:135], v[128:131]
    v_mfma_f32_16x16x32_bf16 v[128:131], a[200:203], a[136:139], v[128:131]
    v_mfma_f32_16x16x32_bf16 v[128:131], a[204:207], a[140:143], v[128:131]
    v_mfma_f32_16x16x32_bf16 v[132:135], a[192:195], a[144:147], 0
    v_mfma_f32_16x16x32_bf16 v[132:135], a[196:199], a[148:151], v[132:135]
    v_mfma_f32_16x16x32_bf16 v[132:135], a[200:203], a[152:155], v[132:135]
    v_mfma_f32_16x16x32_bf16 v[132:135], a[204:207], a[156:159], v[132:135]
    v_mfma_f32_16x16x32_bf16 v[136:139], a[192:195], a[160:163], 0
    v_mfma_f32_16x16x32_bf16 v[136:139], a[196:199], a[164:167], v[136:139]
    v_mfma_f32_16x16x32_bf16 v[136:139], a[200:203], a[168:171], v[136:139]
    v_mfma_f32_16x16x32_bf16 v[136:139], a[204:207], a[172:175], v[136:139]
    v_mfma_f32_16x16x32_bf16 v[140:143], a[192:195], a[176:179], 0
    v_mfma_f32_16x16x32_bf16 v[140:143], a[196:199], a[180:183], v[140:143]
    v_mfma_f32_16x16x32_bf16 v[140:143], a[200:203], a[184:187], v[140:143]
    v_mfma_f32_16x16x32_bf16 v[140:143], a[204:207], a[188:191], v[140:143]
    v_mfma_f32_16x16x32_bf16 v[144:147], a[208:211], a[128:131], 0
    v_mfma_f32_16x16x32_bf16 v[144:147], a[212:215], a[132:135], v[144:147]
    v_mfma_f32_16x16x32_bf16 v[144:147], a[216:219], a[136:139], v[144:147]
    v_mfma_f32_16x16x32_bf16 v[144:147], a[220:223], a[140:143], v[144:147]
    v_mfma_f32_16x16x32_bf16 v[148:151], a[208:211], a[144:147], 0
    v_mfma_f32_16x16x32_bf16 v[148:151], a[212:215], a[148:151], v[148:151]
    v_mfma_f32_16x16x32_bf16 v[148:151], a[216:219], a[152:155], v[148:151]
    v_mfma_f32_16x16x32_bf16 v[148:151], a[220:223], a[156:159], v[148:151]
    v_mfma_f32_16x16x32_bf16 v[152:155], a[208:211], a[160:163], 0
    v_mfma_f32_16x16x32_bf16 v[152:155], a[212:215], a[164:167], v[152:155]
    v_mfma_f32_16x16x32_bf16 v[152:155], a[216:219], a[168:171], v[152:155]
    v_mfma_f32_16x16x32_bf16 v[152:155], a[220:223], a[172:175], v[152:155]
    v_mfma_f32_16x16x32_bf16 v[156:159], a[208:211], a[176:179], 0
    v_mfma_f32_16x16x32_bf16 v[156:159], a[212:215], a[180:183], v[156:159]
    v_mfma_f32_16x16x32_bf16 v[156:159], a[216:219], a[184:187], v[156:159]
    v_mfma_f32_16x16x32_bf16 v[156:159], a[220:223], a[188:191], v[156:159]
    s_nop 7
    v_max3_f32 v224, v128, v129, v130
    v_max3_f32 v224, v224, v131, v144
    v_max3_f32 v224, v224, v145, v146
    v_max_f32 v224, v224, v147
    v_max3_f32 v228, v132, v133, v134
    v_max3_f32 v228, v228, v135, v148
    v_max3_f32 v228, v228, v149, v150
    v_max_f32 v228, v228, v151
    v_max3_f32 v232, v136, v137, v138
    v_max3_f32 v232, v232, v139, v152
    v_max3_f32 v232, v232, v153, v154
    v_max_f32 v232, v232, v155
    v_max3_f32 v236, v140, v141, v142
    v_max3_f32 v236, v236, v143, v156
    v_max3_f32 v236, v236, v157, v158
    v_max_f32 v236, v236, v159
    v_mov_b32 v225, v224
    s_nop 1
    v_permlane32_swap_b32 v225, v224
    s_nop 1
    v_max_f32 v224, v224, v225
    v_mov_b32 v225, v224
    s_nop 1
    v_permlane16_swap_b32 v225, v224
    s_nop 1
    v_max_f32 v224, v224, v225
    v_mov_b32 v229, v228
    s_nop 1
    v_permlane32_swap_b32 v229, v228
    s_nop 1
    v_max_f32 v228, v228, v229
    v_mov_b32 v229, v228
    s_nop 1
    v_permlane16_swap_b32 v229, v228
    s_nop 1
    v_max_f32 v228, v228, v229
    v_mov_b32 v233, v232
    s_nop 1
    v_permlane32_swap_b32 v233, v232
    s_nop 1
    v_max_f32 v232, v232, v233
    v_mov_b32 v233, v232
    s_nop 1
    v_permlane16_swap_b32 v233, v232
    s_nop 1
    v_max_f32 v232, v232, v233
    v_mov_b32 v237, v236
    s_nop 1
    v_permlane32_swap_b32 v237, v236
    s_nop 1
    v_max_f32 v236, v236, v237
    v_mov_b32 v237, v236
    s_nop 1
    v_permlane16_swap_b32 v237, v236
    s_nop 1
    v_max_f32 v236, v236, v237
    v_sub_f32 v224, 0, v224
    v_mov_b32 v225, v224
    v_mov_b32 v226, v224
    v_mov_b32 v227, v224
    v_sub_f32 v228, 0, v228
    v_mov_b32 v229, v228
    v_mov_b32 v230, v228
    v_mov_b32 v231, v228
    v_sub_f32 v232, 0, v232
    v_mov_b32 v233, v232
    v_mov_b32 v234, v232
    v_mov_b32 v235, v232
    v_sub_f32 v236, 0, v236
    v_mov_b32 v237, v236
    v_mov_b32 v238, v236
    v_mov_b32 v239, v236
    v_add_f32 v128, v128, v224
    v_add_f32 v129, v129, v224
    v_add_f32 v130, v130, v224
    v_add_f32 v131, v131, v224
    v_add_f32 v132, v132, v228
    v_add_f32 v133, v133, v228
    v_add_f32 v134, v134, v228
    v_add_f32 v135, v135, v228
    v_add_f32 v136, v136, v232
    v_add_f32 v137, v137, v232
    v_add_f32 v138, v138, v232
    v_add_f32 v139, v139, v232
    v_add_f32 v140, v140, v236
    v_add_f32 v141, v141, v236
    v_add_f32 v142, v142, v236
    v_add_f32 v143, v143, v236
    v_add_f32 v144, v144, v224
    v_add_f32 v145, v145, v224
    v_add_f32 v146, v146, v224
    v_add_f32 v147, v147, v224
    v_add_f32 v148, v148, v228
    v_add_f32 v149, v149, v228
    v_add_f32 v150, v150, v228
    v_add_f32 v151, v151, v228
    v_add_f32 v152, v152, v232
    v_add_f32 v153, v153, v232
    v_add_f32 v154, v154, v232
    v_add_f32 v155, v155, v232
    v_add_f32 v156, v156, v236
    v_add_f32 v157, v157, v236
    v_add_f32 v158, v158, v236
    v_add_f32 v159, v159, v236
    s_waitcnt lgkmcnt(0)
    s_barrier
    v_mfma_f32_16x16x32_bf16 v[160:163], a[224:227], a[128:131], v[224:227]
    v_exp_f32 v128, v128
    v_mfma_f32_16x16x32_bf16 v[160:163], a[228:231], a[132:135], v[160:163]
    ds_read_b128 a[192:195], v40 offset:16384
    v_mfma_f32_16x16x32_bf16 v[160:163], a[232:235], a[136:139], v[160:163]
    v_exp_f32 v129, v129
    v_mfma_f32_16x16x32_bf16 v[160:163], a[236:239], a[140:143], v[160:163]
    ds_read_b64_tr_b16 v[64:65], v16 offset:0
    v_cvt_pk_bf16_f32 v192, v128, v129
    v_mfma_f32_16x16x32_bf16 v[164:167], a[224:227], a[144:147], v[228:231]
    v_exp_f32 v130, v130
    v_mfma_f32_16x16x32_bf16 v[164:167], a[228:231], a[148:151], v[164:167]
    ds_read_b64_tr_b16 v[66:67], v16 offset:4096
    v_mfma_f32_16x16x32_bf16 v[164:167], a[232:235], a[152:155], v[164:167]
    v_exp_f32 v131, v131
    v_mfma_f32_16x16x32_bf16 v[164:167], a[236:239], a[156:159], v[164:167]
    ds_read_b128 a[196:199], v41 offset:16384
    v_cvt_pk_bf16_f32 v193, v130, v131
    v_mfma_f32_16x16x32_bf16 v[168:171], a[224:227], a[160:163], v[232:235]
    s_add_u32 m0, s44, 49152
    v_exp_f32 v132, v132
    v_mfma_f32_16x16x32_bf16 v[168:171], a[228:231], a[164:167], v[168:171]
    buffer_load_dwordx4 v44, s[8:11], s46 offen offset:0 lds
    v_mfma_f32_16x16x32_bf16 v[168:171], a[232:235], a[168:171], v[168:171]
    v_exp_f32 v133, v133
    v_mfma_f32_16x16x32_bf16 v[168:171], a[236:239], a[172:175], v[168:171]
    ds_read_b64_tr_b16 v[68:69], v17 offset:0
    v_cvt_pk_bf16_f32 v196, v132, v133
    v_mfma_f32_16x16x32_bf16 v[172:175], a[224:227], a[176:179], v[236:239]
    v_exp_f32 v134, v134
    v_mfma_f32_16x16x32_bf16 v[172:175], a[228:231], a[180:183], v[172:175]
    ds_read_b64_tr_b16 v[70:71], v17 offset:4096
    v_mfma_f32_16x16x32_bf16 v[172:175], a[232:235], a[184:187], v[172:175]
    v_exp_f32 v135, v135
    v_mfma_f32_16x16x32_bf16 v[172:175], a[236:239], a[188:191], v[172:175]
    ds_read_b128 a[200:203], v42 offset:16384
    v_cvt_pk_bf16_f32 v197, v134, v135
    v_mfma_f32_16x16x32_bf16 v[176:179], a[240:243], a[128:131], v[224:227]
    v_exp_f32 v136, v136
    v_mfma_f32_16x16x32_bf16 v[176:179], a[244:247], a[132:135], v[176:179]
    buffer_load_dwordx4 v45, s[8:11], s46 offen offset:1024 lds
    v_add_f32 v58, v58, v136
    v_mfma_f32_16x16x32_bf16 v[176:179], a[248:251], a[136:139], v[176:179]
    v_exp_f32 v137, v137
    v_mfma_f32_16x16x32_bf16 v[176:179], a[252:255], a[140:143], v[176:179]
    ds_read_b64_tr_b16 v[72:73], v18 offset:0
    v_add_f32 v58, v58, v137
    v_mfma_f32_16x16x32_bf16 v[180:183], a[240:243], a[144:147], v[228:231]
    v_exp_f32 v138, v138
    v_mfma_f32_16x16x32_bf16 v[180:183], a[244:247], a[148:151], v[180:183]
    ds_read_b64_tr_b16 v[74:75], v18 offset:4096
    v_cvt_pk_bf16_f32 v200, v136, v137
    v_mfma_f32_16x16x32_bf16 v[180:183], a[248:251], a[152:155], v[180:183]
    v_exp_f32 v139, v139
    v_mfma_f32_16x16x32_bf16 v[180:183], a[252:255], a[156:159], v[180:183]
    ds_read_b128 a[204:207], v43 offset:16384
    v_add_f32 v58, v58, v138
    v_mfma_f32_16x16x32_bf16 v[184:187], a[240:243], a[160:163], v[232:235]
    v_exp_f32 v140, v140
    v_mfma_f32_16x16x32_bf16 v[184:187], a[244:247], a[164:167], v[184:187]
    ds_read_b64_tr_b16 v[76:77], v19 offset:0
    v_add_f32 v58, v58, v139
    v_mfma_f32_16x16x32_bf16 v[184:187], a[248:251], a[168:171], v[184:187]
    v_exp_f32 v141, v141
    v_mfma_f32_16x16x32_bf16 v[184:187], a[252:255], a[172:175], v[184:187]
    buffer_load_dwordx4 v46, s[8:11], s46 offen offset:2048 lds
    v_cvt_pk_bf16_f32 v201, v138, v139
    v_mfma_f32_16x16x32_bf16 v[188:191], a[240:243], a[176:179], v[236:239]
    v_exp_f32 v142, v142
    v_mfma_f32_16x16x32_bf16 v[188:191], a[244:247], a[180:183], v[188:191]
    ds_read_b64_tr_b16 v[78:79], v19 offset:4096
    v_add_f32 v59, v59, v140
    v_mfma_f32_16x16x32_bf16 v[188:191], a[248:251], a[184:187], v[188:191]
    v_exp_f32 v143, v143
    v_mfma_f32_16x16x32_bf16 v[188:191], a[252:255], a[188:191], v[188:191]
    ds_read_b128 a[208:211], v40 offset:20480
    v_add_f32 v59, v59, v141
    v_mfma_f32_16x16x32_bf16 a[0:3], v[36:39], v[36:39], 0
    ds_read_b64_tr_b16 v[80:81], v20 offset:0
    v_cvt_pk_bf16_f32 v204, v140, v141
    v_mfma_f32_16x16x32_bf16 a[4:7], v[36:39], v[36:39], 0
    v_exp_f32 v144, v144
    v_mfma_f32_16x16x32_bf16 a[8:11], v[36:39], v[36:39], 0
    buffer_load_dwordx4 v47, s[8:11], s46 offen offset:3072 lds
    v_add_f32 v59, v59, v142
    v_mfma_f32_16x16x32_bf16 a[12:15], v[36:39], v[36:39], 0
    v_exp_f32 v145, v145
    v_mfma_f32_16x16x32_bf16 a[16:19], v[36:39], v[36:39], 0
    ds_read_b64_tr_b16 v[82:83], v20 offset:4096
    v_add_f32 v59, v59, v143
    v_mfma_f32_16x16x32_bf16 a[20:23], v[36:39], v[36:39], 0
    v_exp_f32 v146, v146
    v_mfma_f32_16x16x32_bf16 a[24:27], v[36:39], v[36:39], 0
    ds_read_b128 a[212:215], v41 offset:20480
    v_cvt_pk_bf16_f32 v205, v142, v143
    v_mfma_f32_16x16x32_bf16 a[28:31], v[36:39], v[36:39], 0
    v_exp_f32 v147, v147
    v_mfma_f32_16x16x32_bf16 v[240:243], v[36:39], v[36:39], 0
    ds_read_b64_tr_b16 v[84:85], v21 offset:0
    v_cvt_pk_bf16_f32 v194, v144, v145
    v_mfma_f32_16x16x32_bf16 a[32:35], v[36:39], v[36:39], 0
    v_exp_f32 v148, v148
    v_mfma_f32_16x16x32_bf16 a[36:39], v[36:39], v[36:39], 0
    ds_read_b64_tr_b16 v[86:87], v21 offset:4096
    v_cvt_pk_bf16_f32 v195, v146, v147
    v_mfma_f32_16x16x32_bf16 a[40:43], v[36:39], v[36:39], 0
    s_add_u32 s46, s46, 16384
    s_min_u32 s46, s46, s65
    s_add_u32 m0, s44, 0
    v_exp_f32 v149, v149
    v_mfma_f32_16x16x32_bf16 a[44:47], v[36:39], v[36:39], 0
    buffer_load_dwordx4 v44, s[8:11], s46 offen offset:0 lds
    v_cvt_pk_bf16_f32 v198, v148, v149
    v_mfma_f32_16x16x32_bf16 a[48:51], v[36:39], v[36:39], 0
    v_exp_f32 v150, v150
    v_mfma_f32_16x16x32_bf16 a[52:55], v[36:39], v[36:39], 0
    ds_read_b128 a[216:219], v42 offset:20480
    v_mfma_f32_16x16x32_bf16 a[56:59], v[36:39], v[36:39], 0
    v_exp_f32 v151, v151
    v_mfma_f32_16x16x32_bf16 a[60:63], v[36:39], v[36:39], 0
    ds_read_b64_tr_b16 v[88:89], v22 offset:0
    v_cvt_pk_bf16_f32 v199, v150, v151
    v_mfma_f32_16x16x32_bf16 v[244:247], v[36:39], v[36:39], 0
    v_exp_f32 v152, v152
    v_mfma_f32_16x16x32_bf16 a[64:67], v[36:39], v[36:39], 0
    ds_read_b64_tr_b16 v[90:91], v22 offset:4096
    v_add_f32 v58, v58, v152
    v_mfma_f32_16x16x32_bf16 a[68:71], v[36:39], v[36:39], 0
    v_exp_f32 v153, v153
    v_mfma_f32_16x16x32_bf16 a[72:75], v[36:39], v[36:39], 0
    buffer_load_dwordx4 v45, s[8:11], s46 offen offset:1024 lds
    v_add_f32 v58, v58, v153
    v_mfma_f32_16x16x32_bf16 a[76:79], v[36:39], v[36:39], 0
    v_exp_f32 v154, v154
    v_mfma_f32_16x16x32_bf16 a[80:83], v[36:39], v[36:39], 0
    ds_read_b128 a[220:223], v43 offset:20480
    v_cvt_pk_bf16_f32 v202, v152, v153
    v_mfma_f32_16x16x32_bf16 a[84:87], v[36:39], v[36:39], 0
    v_exp_f32 v155, v155
    v_mfma_f32_16x16x32_bf16 a[88:91], v[36:39], v[36:39], 0
    ds_read_b64_tr_b16 v[92:93], v23 offset:0
    v_add_f32 v58, v58, v154
    v_mfma_f32_16x16x32_bf16 a[92:95], v[36:39], v[36:39], 0
    v_exp_f32 v156, v156
    v_mfma_f32_16x16x32_bf16 a[96:99], v[36:39], v[36:39], 0
    ds_read_b64_tr_b16 v[94:95], v23 offset:4096
    v_add_f32 v58, v58, v155
    v_mfma_f32_16x16x32_bf16 a[100:103], v[36:39], v[36:39], 0
    v_exp_f32 v157, v157
    v_mfma_f32_16x16x32_bf16 a[104:107], v[36:39], v[36:39], 0
    buffer_load_dwordx4 v46, s[8:11], s46 offen offset:2048 lds
    v_cvt_pk_bf16_f32 v203, v154, v155
    v_mfma_f32_16x16x32_bf16 a[108:111], v[36:39], v[36:39], 0
    v_exp_f32 v158, v158
    v_mfma_f32_16x16x32_bf16 a[112:115], v[36:39], v[36:39], 0
    buffer_load_dwordx4 v47, s[8:11], s46 offen offset:3072 lds
    v_add_f32 v59, v59, v156
    v_mfma_f32_16x16x32_bf16 a[116:119], v[36:39], v[36:39], 0
    s_waitcnt lgkmcnt(0)
    v_exp_f32 v159, v159
    v_mfma_f32_16x16x32_bf16 a[120:123], v[36:39], v[36:39], 0
    v_add_f32 v59, v59, v157
    v_cvt_pk_bf16_f32 v206, v156, v157
    v_add_f32 v59, v59, v158
    v_mfma_f32_16x16x32_bf16 a[124:127], v[36:39], v[36:39], 0
    v_add_f32 v59, v59, v159
    v_cvt_pk_bf16_f32 v207, v158, v159
    s_add_u32 s46, s46, 16384
    s_min_u32 s46, s46, s65
    s_mov_b32 s48, 8
    s_branch L_k1_slot1
.p2align 6
L_k1_loop:
    v_mfma_f32_16x16x32_bf16 v[160:163], a[224:227], a[128:131], v[224:227]
    v_exp_f32 v128, v128
    v_mfma_f32_16x16x32_bf16 v[160:163], a[228:231], a[132:135], v[160:163]
    ds_read_b128 a[192:195], v40 offset:16384
    v_mfma_f32_16x16x32_bf16 v[160:163], a[232:235], a[136:139], v[160:163]
    v_exp_f32 v129, v129
    v_mfma_f32_16x16x32_bf16 v[160:163], a[236:239], a[140:143], v[160:163]
    ds_read_b64_tr_b16 v[64:65], v16 offset:0
    v_cvt_pk_bf16_f32 v192, v128, v129
    v_mfma_f32_16x16x32_bf16 v[164:167], a[224:227], a[144:147], v[228:231]
    v_exp_f32 v130, v130
    v_mfma_f32_16x16x32_bf16 v[164:167], a[228:231], a[148:151], v[164:167]
    ds_read_b64_tr_b16 v[66:67], v16 offset:4096
    v_mfma_f32_16x16x32_bf16 v[164:167], a[232:235], a[152:155], v[164:167]
    v_exp_f32 v131, v131
    v_mfma_f32_16x16x32_bf16 v[164:167], a[236:239], a[156:159], v[164:167]
    ds_read_b128 a[196:199], v41 offset:16384
    v_cvt_pk_bf16_f32 v193, v130, v131
    v_mfma_f32_16x16x32_bf16 v[168:171], a[224:227], a[160:163], v[232:235]
    s_add_u32 m0, s44, 49152
    v_exp_f32 v132, v132
    v_mfma_f32_16x16x32_bf16 v[168:171], a[228:231], a[164:167], v[168:171]
    buffer_load_dwordx4 v44, s[8:11], s46 offen offset:0 lds
    v_mfma_f32_16x16x32_bf16 v[168:171], a[232:235], a[168:171], v[168:171]
    v_exp_f32 v133, v133
    v_mfma_f32_16x16x32_bf16 v[168:171], a[236:239], a[172:175], v[168:171]
    ds_read_b64_tr_b16 v[68:69], v17 offset:0
    v_cvt_pk_bf16_f32 v196, v132, v133
    v_mfma_f32_16x16x32_bf16 v[172:175], a[224:227], a[176:179], v[236:239]
    v_exp_f32 v134, v134
    v_mfma_f32_16x16x32_bf16 v[172:175], a[228:231], a[180:183], v[172:175]
    ds_read_b64_tr_b16 v[70:71], v17 offset:4096
    v_mfma_f32_16x16x32_bf16 v[172:175], a[232:235], a[184:187], v[172:175]
    v_exp_f32 v135, v135
    v_mfma_f32_16x16x32_bf16 v[172:175], a[236:239], a[188:191], v[172:175]
    ds_read_b128 a[200:203], v42 offset:16384
    v_cvt_pk_bf16_f32 v197, v134, v135
    v_mfma_f32_16x16x32_bf16 v[176:179], a[240:243], a[128:131], v[224:227]
    v_exp_f32 v136, v136
    v_mfma_f32_16x16x32_bf16 v[176:179], a[244:247], a[132:135], v[176:179]
    buffer_load_dwordx4 v45, s[8:11], s46 offen offset:1024 lds
    v_add_f32 v58, v58, v136
    v_mfma_f32_16x16x32_bf16 v[176:179], a[248:251], a[136:139], v[176:179]
    v_exp_f32 v137, v137
    v_mfma_f32_16x16x32_bf16 v[176:179], a[252:255], a[140:143], v[176:179]
    ds_read_b64_tr_b16 v[72:73], v18 offset:0
    v_add_f32 v58, v58, v137
    v_mfma_f32_16x16x32_bf16 v[180:183], a[240:243], a[144:147], v[228:231]
    v_exp_f32 v138, v138
    v_mfma_f32_16x16x32_bf16 v[180:183], a[244:247], a[148:151], v[180:183]
    ds_read_b64_tr_b16 v[74:75], v18 offset:4096
    v_cvt_pk_bf16_f32 v200, v136, v137
    v_mfma_f32_16x16x32_bf16 v[180:183], a[248:251], a[152:155], v[180:183]
    v_exp_f32 v139, v139
    v_mfma_f32_16x16x32_bf16 v[180:183], a[252:255], a[156:159], v[180:183]
    ds_read_b128 a[204:207], v43 offset:16384
    v_add_f32 v58, v58, v138
    v_mfma_f32_16x16x32_bf16 v[184:187], a[240:243], a[160:163], v[232:235]
    v_exp_f32 v140, v140
    v_mfma_f32_16x16x32_bf16 v[184:187], a[244:247], a[164:167], v[184:187]
    ds_read_b64_tr_b16 v[76:77], v19 offset:0
    v_add_f32 v58, v58, v139
    v_mfma_f32_16x16x32_bf16 v[184:187], a[248:251], a[168:171], v[184:187]
    v_exp_f32 v141, v141
    v_mfma_f32_16x16x32_bf16 v[184:187], a[252:255], a[172:175], v[184:187]
    buffer_load_dwordx4 v46, s[8:11], s46 offen offset:2048 lds
    v_cvt_pk_bf16_f32 v201, v138, v139
    v_mfma_f32_16x16x32_bf16 v[188:191], a[240:243], a[176:179], v[236:239]
    v_exp_f32 v142, v142
    v_mfma_f32_16x16x32_bf16 v[188:191], a[244:247], a[180:183], v[188:191]
    ds_read_b64_tr_b16 v[78:79], v19 offset:4096
    v_add_f32 v59, v59, v140
    v_mfma_f32_16x16x32_bf16 v[188:191], a[248:251], a[184:187], v[188:191]
    v_exp_f32 v143, v143
    v_mfma_f32_16x16x32_bf16 v[188:191], a[252:255], a[188:191], v[188:191]
    ds_read_b128 a[208:211], v40 offset:20480
    v_add_f32 v59, v59, v141
    v_mfma_f32_16x16x32_bf16 a[0:3], v[96:99], v[208:211], a[0:3]
    ds_read_b64_tr_b16 v[80:81], v20 offset:0
    v_cvt_pk_bf16_f32 v204, v140, v141
    v_mfma_f32_16x16x32_bf16 a[4:7], v[96:99], v[212:215], a[4:7]
    v_exp_f32 v144, v144
    v_mfma_f32_16x16x32_bf16 a[8:11], v[96:99], v[216:219], a[8:11]
    buffer_load_dwordx4 v47, s[8:11], s46 offen offset:3072 lds
    v_add_f32 v59, v59, v142
    v_mfma_f32_16x16x32_bf16 a[12:15], v[96:99], v[220:223], a[12:15]
    v_exp_f32 v145, v145
    v_mfma_f32_16x16x32_bf16 a[16:19], v[100:103], v[208:211], a[16:19]
    ds_read_b64_tr_b16 v[82:83], v20 offset:4096
    v_add_f32 v59, v59, v143
    v_mfma_f32_16x16x32_bf16 a[20:23], v[100:103], v[212:215], a[20:23]
    v_exp_f32 v146, v146
    v_mfma_f32_16x16x32_bf16 a[24:27], v[100:103], v[216:219], a[24:27]
    ds_read_b128 a[212:215], v41 offset:20480
    v_cvt_pk_bf16_f32 v205, v142, v143
    v_mfma_f32_16x16x32_bf16 a[28:31], v[100:103], v[220:223], a[28:31]
    v_exp_f32 v147, v147
    v_mfma_f32_16x16x32_bf16 v[240:243], v[32:35], v[208:211], v[240:243]
    ds_read_b64_tr_b16 v[84:85], v21 offset:0
    v_cvt_pk_bf16_f32 v194, v144, v145
    v_mfma_f32_16x16x32_bf16 a[32:35], v[104:107], v[208:211], a[32:35]
    v_exp_f32 v148, v148
    v_mfma_f32_16x16x32_bf16 a[36:39], v[104:107], v[212:215], a[36:39]
    ds_read_b64_tr_b16 v[86:87], v21 offset:4096
    v_cvt_pk_bf16_f32 v195, v146, v147
    v_mfma_f32_16x16x32_bf16 a[40:43], v[104:107], v[216:219], a[40:43]
    s_add_u32 s46, s46, 16384
    s_min_u32 s46, s46, s65
    s_add_u32 m0, s44, 0
    v_exp_f32 v149, v149
    v_mfma_f32_16x16x32_bf16 a[44:47], v[104:107], v[220:223], a[44:47]
    buffer_load_dwordx4 v44, s[8:11], s46 offen offset:0 lds
    v_cvt_pk_bf16_f32 v198, v148, v149
    v_mfma_f32_16x16x32_bf16 a[48:51], v[108:111], v[208:211], a[48:51]
    v_exp_f32 v150, v150
    v_mfma_f32_16x16x32_bf16 a[52:55], v[108:111], v[212:215], a[52:55]
    ds_read_b128 a[216:219], v42 offset:20480
    v_mfma_f32_16x16x32_bf16 a[56:59], v[108:111], v[216:219], a[56:59]
    v_exp_f32 v151, v151
    v_mfma_f32_16x16x32_bf16 a[60:63], v[108:111], v[220:223], a[60:63]
    ds_read_b64_tr_b16 v[88:89], v22 offset:0
    v_cvt_pk_bf16_f32 v199, v150, v151
    v_mfma_f32_16x16x32_bf16 v[244:247], v[32:35], v[212:215], v[244:247]
    v_exp_f32 v152, v152
    v_mfma_f32_16x16x32_bf16 a[64:67], v[112:115], v[208:211], a[64:67]
    ds_read_b64_tr_b16 v[90:91], v22 offset:4096
    v_add_f32 v58, v58, v152
    v_mfma_f32_16x16x32_bf16 a[68:71], v[112:115], v[212:215], a[68:71]
    v_exp_f32 v153, v153
    v_mfma_f32_16x16x32_bf16 a[72:75], v[112:115], v[216:219], a[72:75]
    buffer_load_dwordx4 v45, s[8:11], s46 offen offset:1024 lds
    v_add_f32 v58, v58, v153
    v_mfma_f32_16x16x32_bf16 a[76:79], v[112:115], v[220:223], a[76:79]
    v_exp_f32 v154, v154
    v_mfma_f32_16x16x32_bf16 a[80:83], v[116:119], v[208:211], a[80:83]
    ds_read_b128 a[220:223], v43 offset:20480
    v_cvt_pk_bf16_f32 v202, v152, v153
    v_mfma_f32_16x16x32_bf16 a[84:87], v[116:119], v[212:215], a[84:87]
    v_exp_f32 v155, v155
    v_mfma_f32_16x16x32_bf16 a[88:91], v[116:119], v[216:219], a[88:91]
    ds_read_b64_tr_b16 v[92:93], v23 offset:0
    v_add_f32 v58, v58, v154
    v_mfma_f32_16x16x32_bf16 a[92:95], v[116:119], v[220:223], a[92:95]
    v_exp_f32 v156, v156
    v_mfma_f32_16x16x32_bf16 a[96:99], v[120:123], v[208:211], a[96:99]
    ds_read_b64_tr_b16 v[94:95], v23 offset:4096
    v_add_f32 v58, v58, v155
    v_mfma_f32_16x16x32_bf16 a[100:103], v[120:123], v[212:215], a[100:103]
    v_exp_f32 v157, v157
    v_mfma_f32_16x16x32_bf16 a[104:107], v[120:123], v[216:219], a[104:107]
    buffer_load_dwordx4 v46, s[8:11], s46 offen offset:2048 lds
    v_cvt_pk_bf16_f32 v203, v154, v155
    v_mfma_f32_16x16x32_bf16 a[108:111], v[120:123], v[220:223], a[108:111]
    v_exp_f32 v158, v158
    v_mfma_f32_16x16x32_bf16 a[112:115], v[124:127], v[208:211], a[112:115]
    buffer_load_dwordx4 v47, s[8:11], s46 offen offset:3072 lds
    v_add_f32 v59, v59, v156
    v_mfma_f32_16x16x32_bf16 a[116:119], v[124:127], v[212:215], a[116:119]
    s_waitcnt lgkmcnt(0)
    v_exp_f32 v159, v159
    v_mfma_f32_16x16x32_bf16 a[120:123], v[124:127], v[216:219], a[120:123]
    v_add_f32 v59, v59, v157
    v_cvt_pk_bf16_f32 v206, v156, v157
    v_add_f32 v59, v59, v158
    v_mfma_f32_16x16x32_bf16 a[124:127], v[124:127], v[220:223], a[124:127]
    v_add_f32 v59, v59, v159
    v_cvt_pk_bf16_f32 v207, v158, v159
    s_add_u32 s46, s46, 16384
    s_min_u32 s46, s46, s65
L_k1_slot1:
    v_mfma_f32_16x16x32_bf16 v[128:131], a[192:195], a[128:131], v[224:227]
    v_exp_f32 v160, v160
    v_mfma_f32_16x16x32_bf16 v[128:131], a[196:199], a[132:135], v[128:131]
    ds_read_b128 a[224:227], v40 offset:24576
    v_mfma_f32_16x16x32_bf16 v[128:131], a[200:203], a[136:139], v[128:131]
    v_exp_f32 v161, v161
    v_mfma_f32_16x16x32_bf16 v[128:131], a[204:207], a[140:143], v[128:131]
    ds_read_b64_tr_b16 v[96:97], v16 offset:8192
    v_cvt_pk_bf16_f32 v208, v160, v161
    v_mfma_f32_16x16x32_bf16 v[132:135], a[192:195], a[144:147], v[228:231]
    v_exp_f32 v162, v162
    v_mfma_f32_16x16x32_bf16 v[132:135], a[196:199], a[148:151], v[132:135]
    ds_read_b64_tr_b16 v[98:99], v16 offset:12288
    v_mfma_f32_16x16x32_bf16 v[132:135], a[200:203], a[152:155], v[132:135]
    v_exp_f32 v163, v163
    v_mfma_f32_16x16x32_bf16 v[132:135], a[204:207], a[156:159], v[132:135]
    ds_read_b128 a[228:231], v41 offset:24576
    v_cvt_pk_bf16_f32 v209, v162, v163
    v_mfma_f32_16x16x32_bf16 v[136:139], a[192:195], a[160:163], v[232:235]
    s_add_u32 m0, s44, 98304
    v_exp_f32 v164, v164
    v_mfma_f32_16x16x32_bf16 v[136:139], a[196:199], a[164:167], v[136:139]
    buffer_load_dwordx4 v48, s[12:15], s47 offen offset:0 lds
    v_mfma_f32_16x16x32_bf16 v[136:139], a[200:203], a[168:171], v[136:139]
    v_exp_f32 v165, v165
    v_mfma_f32_16x16x32_bf16 v[136:139], a[204:207], a[172:175], v[136:139]
    ds_read_b64_tr_b16 v[100:101], v17 offset:8192
    v_cvt_pk_bf16_f32 v212, v164, v165
    v_mfma_f32_16x16x32_bf16 v[140:143], a[192:195], a[176:179], v[236:239]
    v_exp_f32 v166, v166
    v_mfma_f32_16x16x32_bf16 v[140:143], a[196:199], a[180:183], v[140:143]
    ds_read_b64_tr_b16 v[102:103], v17 offset:12288
    v_mfma_f32_16x16x32_bf16 v[140:143], a[200:203], a[184:187], v[140:143]
    v_exp_f32 v167, v167
    v_mfma_f32_16x16x32_bf16 v[140:143], a[204:207], a[188:191], v[140:143]
    ds_read_b128 a[232:235], v42 offset:24576
    v_cvt_pk_bf16_f32 v213, v166, v167
    v_mfma_f32_16x16x32_bf16 v[144:147], a[208:211], a[128:131], v[224:227]
    v_exp_f32 v168, v168
    v_mfma_f32_16x16x32_bf16 v[144:147], a[212:215], a[132:135], v[144:147]
    buffer_load_dwordx4 v49, s[12:15], s47 offen offset:1024 lds
    v_add_f32 v58, v58, v168
    v_mfma_f32_16x16x32_bf16 v[144:147], a[216:219], a[136:139], v[144:147]
    v_exp_f32 v169, v169
    v_mfma_f32_16x16x32_bf16 v[144:147], a[220:223], a[140:143], v[144:147]
    ds_read_b64_tr_b16 v[104:105], v18 offset:8192
    v_add_f32 v58, v58, v169
    v_mfma_f32_16x16x32_bf16 v[148:151], a[208:211], a[144:147], v[228:231]
    v_exp_f32 v170, v170
    v_mfma_f32_16x16x32_bf16 v[148:151], a[212:215], a[148:151], v[148:151]
    ds_read_b64_tr_b16 v[106:107], v18 offset:12288
    v_cvt_pk_bf16_f32 v216, v168, v169
    v_mfma_f32_16x16x32_bf16 v[148:151], a[216:219], a[152:155], v[148:151]
    v_exp_f32 v171, v171
    v_mfma_f32_16x16x32_bf16 v[148:151], a[220:223], a[156:159], v[148:151]
    ds_read_b128 a[236:239], v43 offset:24576
    v_add_f32 v58, v58, v170
    v_mfma_f32_16x16x32_bf16 v[152:155], a[208:211], a[160:163], v[232:235]
    v_exp_f32 v172, v172
    v_mfma_f32_16x16x32_bf16 v[152:155], a[212:215], a[164:167], v[152:155]
    ds_read_b64_tr_b16 v[108:109], v19 offset:8192
    v_add_f32 v58, v58, v171
    v_mfma_f32_16x16x32_bf16 v[152:155], a[216:219], a[168:171], v[152:155]
    v_exp_f32 v173, v173
    v_mfma_f32_16x16x32_bf16 v[152:155], a[220:223], a[172:175], v[152:155]
    buffer_load_dwordx4 v48, s[12:15], s47 offen offset:2048 lds
    v_cvt_pk_bf16_f32 v217, v170, v171
    v_mfma_f32_16x16x32_bf16 v[156:159], a[208:211], a[176:179], v[236:239]
    v_exp_f32 v174, v174
    v_mfma_f32_16x16x32_bf16 v[156:159], a[212:215], a[180:183], v[156:159]
    ds_read_b64_tr_b16 v[110:111], v19 offset:12288
    v_add_f32 v59, v59, v172
    v_mfma_f32_16x16x32_bf16 v[156:159], a[216:219], a[184:187], v[156:159]
    v_exp_f32 v175, v175
    v_mfma_f32_16x16x32_bf16 v[156:159], a[220:223], a[188:191], v[156:159]
    ds_read_b128 a[240:243], v40 offset:28672
    v_add_f32 v59, v59, v173
    v_mfma_f32_16x16x32_bf16 a[0:3], v[64:67], v[192:195], a[0:3]
    ds_read_b64_tr_b16 v[112:113], v20 offset:8192
    v_cvt_pk_bf16_f32 v220, v172, v173
    v_mfma_f32_16x16x32_bf16 a[4:7], v[64:67], v[196:199], a[4:7]
    v_exp_f32 v176, v176
    v_mfma_f32_16x16x32_bf16 a[8:11], v[64:67], v[200:203], a[8:11]
    buffer_load_dwordx4 v49, s[12:15], s47 offen offset:3072 lds
    v_add_f32 v59, v59, v174
    v_mfma_f32_16x16x32_bf16 a[12:15], v[64:67], v[204:207], a[12:15]
    v_exp_f32 v177, v177
    v_mfma_f32_16x16x32_bf16 a[16:19], v[68:71], v[192:195], a[16:19]
    ds_read_b64_tr_b16 v[114:115], v20 offset:12288
    v_add_f32 v59, v59, v175
    v_mfma_f32_16x16x32_bf16 a[20:23], v[68:71], v[196:199], a[20:23]
    v_exp_f32 v178, v178
    v_mfma_f32_16x16x32_bf16 a[24:27], v[68:71], v[200:203], a[24:27]
    ds_read_b128 a[244:247], v41 offset:28672
    v_cvt_pk_bf16_f32 v221, v174, v175
    v_mfma_f32_16x16x32_bf16 a[28:31], v[68:71], v[204:207], a[28:31]
    v_exp_f32 v179, v179
    v_mfma_f32_16x16x32_bf16 v[240:243], v[32:35], v[192:195], v[240:243]
    ds_read_b64_tr_b16 v[116:117], v21 offset:8192
    v_cvt_pk_bf16_f32 v210, v176, v177
    v_mfma_f32_16x16x32_bf16 a[32:35], v[72:75], v[192:195], a[32:35]
    v_exp_f32 v180, v180
    v_mfma_f32_16x16x32_bf16 a[36:39], v[72:75], v[196:199], a[36:39]
    ds_read_b64_tr_b16 v[118:119], v21 offset:12288
    v_cvt_pk_bf16_f32 v211, v178, v179
    v_mfma_f32_16x16x32_bf16 a[40:43], v[72:75], v[200:203], a[40:43]
    s_add_u32 s47, s47, 16384
    s_min_u32 s47, s47, s65
    s_add_u32 m0, s44, 114688
    v_exp_f32 v181, v181
    v_mfma_f32_16x16x32_bf16 a[44:47], v[72:75], v[204:207], a[44:47]
    buffer_load_dwordx4 v48, s[12:15], s47 offen offset:0 lds
    v_cvt_pk_bf16_f32 v214, v180, v181
    v_mfma_f32_16x16x32_bf16 a[48:51], v[76:79], v[192:195], a[48:51]
    v_exp_f32 v182, v182
    v_mfma_f32_16x16x32_bf16 a[52:55], v[76:79], v[196:199], a[52:55]
    ds_read_b128 a[248:251], v42 offset:28672
    v_mfma_f32_16x16x32_bf16 a[56:59], v[76:79], v[200:203], a[56:59]
    v_exp_f32 v183, v183
    v_mfma_f32_16x16x32_bf16 a[60:63], v[76:79], v[204:207], a[60:63]
    ds_read_b64_tr_b16 v[120:121], v22 offset:8192
    v_cvt_pk_bf16_f32 v215, v182, v183
    v_mfma_f32_16x16x32_bf16 v[244:247], v[32:35], v[196:199], v[244:247]
    v_exp_f32 v184, v184
    v_mfma_f32_16x16x32_bf16 a[64:67], v[80:83], v[192:195], a[64:67]
    ds_read_b64_tr_b16 v[122:123], v22 offset:12288
    v_add_f32 v58, v58, v184
    v_mfma_f32_16x16x32_bf16 a[68:71], v[80:83], v[196:199], a[68:71]
    v_exp_f32 v185, v185
    v_mfma_f32_16x16x32_bf16 a[72:75], v[80:83], v[200:203], a[72:75]
    buffer_load_dwordx4 v49, s[12:15], s47 offen offset:1024 lds
    v_add_f32 v58, v58, v185
    v_mfma_f32_16x16x32_bf16 a[76:79], v[80:83], v[204:207], a[76:79]
    v_exp_f32 v186, v186
    v_mfma_f32_16x16x32_bf16 a[80:83], v[84:87], v[192:195], a[80:83]
    ds_read_b128 a[252:255], v43 offset:28672
    v_cvt_pk_bf16_f32 v218, v184, v185
    v_mfma_f32_16x16x32_bf16 a[84:87], v[84:87], v[196:199], a[84:87]
    v_exp_f32 v187, v187
    v_mfma_f32_16x16x32_bf16 a[88:91], v[84:87], v[200:203], a[88:91]
    ds_read_b64_tr_b16 v[124:125], v23 offset:8192
    v_add_f32 v58, v58, v186
    v_mfma_f32_16x16x32_bf16 a[92:95], v[84:87], v[204:207], a[92:95]
    v_exp_f32 v188, v188
    v_mfma_f32_16x16x32_bf16 a[96:99], v[88:91], v[192:195], a[96:99]
    ds_read_b64_tr_b16 v[126:127], v23 offset:12288
    v_add_f32 v58, v58, v187
    v_mfma_f32_16x16x32_bf16 a[100:103], v[88:91], v[196:199], a[100:103]
    v_exp_f32 v189, v189
    v_mfma_f32_16x16x32_bf16 a[104:107], v[88:91], v[200:203], a[104:107]
    buffer_load_dwordx4 v48, s[12:15], s47 offen offset:2048 lds
    v_cvt_pk_bf16_f32 v219, v186, v187
    v_mfma_f32_16x16x32_bf16 a[108:111], v[88:91], v[204:207], a[108:111]
    v_exp_f32 v190, v190
    v_mfma_f32_16x16x32_bf16 a[112:115], v[92:95], v[192:195], a[112:115]
    buffer_load_dwordx4 v49, s[12:15], s47 offen offset:3072 lds
    v_add_f32 v59, v59, v188
    v_mfma_f32_16x16x32_bf16 a[116:119], v[92:95], v[196:199], a[116:119]
    s_waitcnt lgkmcnt(0)
    v_exp_f32 v191, v191
    v_mfma_f32_16x16x32_bf16 a[120:123], v[92:95], v[200:203], a[120:123]
    v_add_f32 v59, v59, v189
    v_cvt_pk_bf16_f32 v222, v188, v189
    v_add_f32 v59, v59, v190
    v_mfma_f32_16x16x32_bf16 a[124:127], v[92:95], v[204:207], a[124:127]
    v_add_f32 v59, v59, v191
    v_cvt_pk_bf16_f32 v223, v190, v191
    s_add_u32 s47, s47, 16384
    s_min_u32 s47, s47, s65
    v_mfma_f32_16x16x32_bf16 v[160:163], a[224:227], a[128:131], v[224:227]
    v_exp_f32 v128, v128
    v_mfma_f32_16x16x32_bf16 v[160:163], a[228:231], a[132:135], v[160:163]
    ds_read_b128 a[192:195], v40 offset:32768
    v_mfma_f32_16x16x32_bf16 v[160:163], a[232:235], a[136:139], v[160:163]
    v_exp_f32 v129, v129
    v_mfma_f32_16x16x32_bf16 v[160:163], a[236:239], a[140:143], v[160:163]
    ds_read_b64_tr_b16 v[64:65], v16 offset:16384
    v_cvt_pk_bf16_f32 v192, v128, v129
    v_mfma_f32_16x16x32_bf16 v[164:167], a[224:227], a[144:147], v[228:231]
    v_exp_f32 v130, v130
    v_mfma_f32_16x16x32_bf16 v[164:167], a[228:231], a[148:151], v[164:167]
    ds_read_b64_tr_b16 v[66:67], v16 offset:20480
    v_mfma_f32_16x16x32_bf16 v[164:167], a[232:235], a[152:155], v[164:167]
    v_exp_f32 v131, v131
    v_mfma_f32_16x16x32_bf16 v[164:167], a[236:239], a[156:159], v[164:167]
    ds_read_b128 a[196:199], v41 offset:32768
    v_cvt_pk_bf16_f32 v193, v130, v131
    v_mfma_f32_16x16x32_bf16 v[168:171], a[224:227], a[160:163], v[232:235]
    v_exp_f32 v132, v132
    v_mfma_f32_16x16x32_bf16 v[168:171], a[228:231], a[164:167], v[168:171]
    v_mfma_f32_16x16x32_bf16 v[168:171], a[232:235], a[168:171], v[168:171]
    v_exp_f32 v133, v133
    v_mfma_f32_16x16x32_bf16 v[168:171], a[236:239], a[172:175], v[168:171]
    ds_read_b64_tr_b16 v[68:69], v17 offset:16384
    v_cvt_pk_bf16_f32 v196, v132, v133
    v_mfma_f32_16x16x32_bf16 v[172:175], a[224:227], a[176:179], v[236:239]
    v_exp_f32 v134, v134
    v_mfma_f32_16x16x32_bf16 v[172:175], a[228:231], a[180:183], v[172:175]
    ds_read_b64_tr_b16 v[70:71], v17 offset:20480
    v_mfma_f32_16x16x32_bf16 v[172:175], a[232:235], a[184:187], v[172:175]
    v_exp_f32 v135, v135
    v_mfma_f32_16x16x32_bf16 v[172:175], a[236:239], a[188:191], v[172:175]
    ds_read_b128 a[200:203], v42 offset:32768
    v_cvt_pk_bf16_f32 v197, v134, v135
    v_mfma_f32_16x16x32_bf16 v[176:179], a[240:243], a[128:131], v[224:227]
    v_exp_f32 v136, v136
    v_mfma_f32_16x16x32_bf16 v[176:179], a[244:247], a[132:135], v[176:179]
    v_add_f32 v58, v58, v136
    v_mfma_f32_16x16x32_bf16 v[176:179], a[248:251], a[136:139], v[176:179]
    v_exp_f32 v137, v137
    v_mfma_f32_16x16x32_bf16 v[176:179], a[252:255], a[140:143], v[176:179]
    ds_read_b64_tr_b16 v[72:73], v18 offset:16384
    v_add_f32 v58, v58, v137
    v_mfma_f32_16x16x32_bf16 v[180:183], a[240:243], a[144:147], v[228:231]
    v_exp_f32 v138, v138
    v_mfma_f32_16x16x32_bf16 v[180:183], a[244:247], a[148:151], v[180:183]
    ds_read_b64_tr_b16 v[74:75], v18 offset:20480
    v_cvt_pk_bf16_f32 v200, v136, v137
    v_mfma_f32_16x16x32_bf16 v[180:183], a[248:251], a[152:155], v[180:183]
    v_exp_f32 v139, v139
    v_mfma_f32_16x16x32_bf16 v[180:183], a[252:255], a[156:159], v[180:183]
    ds_read_b128 a[204:207], v43 offset:32768
    v_add_f32 v58, v58, v138
    v_mfma_f32_16x16x32_bf16 v[184:187], a[240:243], a[160:163], v[232:235]
    v_exp_f32 v140, v140
    v_mfma_f32_16x16x32_bf16 v[184:187], a[244:247], a[164:167], v[184:187]
    ds_read_b64_tr_b16 v[76:77], v19 offset:16384
    v_add_f32 v58, v58, v139
    v_mfma_f32_16x16x32_bf16 v[184:187], a[248:251], a[168:171], v[184:187]
    v_exp_f32 v141, v141
    v_mfma_f32_16x16x32_bf16 v[184:187], a[252:255], a[172:175], v[184:187]
    v_cvt_pk_bf16_f32 v201, v138, v139
    v_add_f32 v59, v59, v140
    v_mfma_f32_16x16x32_bf16 v[188:191], a[240:243], a[176:179], v[236:239]
    v_exp_f32 v142, v142
    v_mfma_f32_16x16x32_bf16 v[188:191], a[244:247], a[180:183], v[188:191]
    ds_read_b64_tr_b16 v[78:79], v19 offset:20480
    v_add_f32 v59, v59, v141
    v_mfma_f32_16x16x32_bf16 v[188:191], a[248:251], a[184:187], v[188:191]
    v_exp_f32 v143, v143
    v_mfma_f32_16x16x32_bf16 v[188:191], a[252:255], a[188:191], v[188:191]
    ds_read_b128 a[208:211], v40 offset:36864
    v_cvt_pk_bf16_f32 v204, v140, v141
    v_mfma_f32_16x16x32_bf16 a[0:3], v[96:99], v[208:211], a[0:3]
    ds_read_b64_tr_b16 v[80:81], v20 offset:16384
    v_add_f32 v59, v59, v142
    v_mfma_f32_16x16x32_bf16 a[4:7], v[96:99], v[212:215], a[4:7]
    v_exp_f32 v144, v144
    v_mfma_f32_16x16x32_bf16 a[8:11], v[96:99], v[216:219], a[8:11]
    v_add_f32 v59, v59, v143
    v_cvt_pk_bf16_f32 v205, v142, v143
    v_mfma_f32_16x16x32_bf16 a[12:15], v[96:99], v[220:223], a[12:15]
    v_exp_f32 v145, v145
    v_mfma_f32_16x16x32_bf16 a[16:19], v[100:103], v[208:211], a[16:19]
    ds_read_b64_tr_b16 v[82:83], v20 offset:20480
    v_cvt_pk_bf16_f32 v194, v144, v145
    v_mfma_f32_16x16x32_bf16 a[20:23], v[100:103], v[212:215], a[20:23]
    v_exp_f32 v146, v146
    v_mfma_f32_16x16x32_bf16 a[24:27], v[100:103], v[216:219], a[24:27]
    ds_read_b128 a[212:215], v41 offset:36864
    v_mfma_f32_16x16x32_bf16 a[28:31], v[100:103], v[220:223], a[28:31]
    v_exp_f32 v147, v147
    v_mfma_f32_16x16x32_bf16 v[240:243], v[32:35], v[208:211], v[240:243]
    ds_read_b64_tr_b16 v[84:85], v21 offset:16384
    v_cvt_pk_bf16_f32 v195, v146, v147
    v_mfma_f32_16x16x32_bf16 a[32:35], v[104:107], v[208:211], a[32:35]
    v_exp_f32 v148, v148
    v_mfma_f32_16x16x32_bf16 a[36:39], v[104:107], v[212:215], a[36:39]
    ds_read_b64_tr_b16 v[86:87], v21 offset:20480
    v_mfma_f32_16x16x32_bf16 a[40:43], v[104:107], v[216:219], a[40:43]
    v_exp_f32 v149, v149
    v_mfma_f32_16x16x32_bf16 a[44:47], v[104:107], v[220:223], a[44:47]
    v_cvt_pk_bf16_f32 v198, v148, v149
    v_mfma_f32_16x16x32_bf16 a[48:51], v[108:111], v[208:211], a[48:51]
    v_exp_f32 v150, v150
    v_mfma_f32_16x16x32_bf16 a[52:55], v[108:111], v[212:215], a[52:55]
    ds_read_b128 a[216:219], v42 offset:36864
    v_mfma_f32_16x16x32_bf16 a[56:59], v[108:111], v[216:219], a[56:59]
    v_exp_f32 v151, v151
    v_mfma_f32_16x16x32_bf16 a[60:63], v[108:111], v[220:223], a[60:63]
    ds_read_b64_tr_b16 v[88:89], v22 offset:16384
    v_cvt_pk_bf16_f32 v199, v150, v151
    v_mfma_f32_16x16x32_bf16 v[244:247], v[32:35], v[212:215], v[244:247]
    v_exp_f32 v152, v152
    v_mfma_f32_16x16x32_bf16 a[64:67], v[112:115], v[208:211], a[64:67]
    ds_read_b64_tr_b16 v[90:91], v22 offset:20480
    v_add_f32 v58, v58, v152
    v_mfma_f32_16x16x32_bf16 a[68:71], v[112:115], v[212:215], a[68:71]
    v_exp_f32 v153, v153
    v_mfma_f32_16x16x32_bf16 a[72:75], v[112:115], v[216:219], a[72:75]
    v_add_f32 v58, v58, v153
    v_cvt_pk_bf16_f32 v202, v152, v153
    v_mfma_f32_16x16x32_bf16 a[76:79], v[112:115], v[220:223], a[76:79]
    v_exp_f32 v154, v154
    v_mfma_f32_16x16x32_bf16 a[80:83], v[116:119], v[208:211], a[80:83]
    ds_read_b128 a[220:223], v43 offset:36864
    v_add_f32 v58, v58, v154
    v_mfma_f32_16x16x32_bf16 a[84:87], v[116:119], v[212:215], a[84:87]
    v_exp_f32 v155, v155
    v_mfma_f32_16x16x32_bf16 a[88:91], v[116:119], v[216:219], a[88:91]
    ds_read_b64_tr_b16 v[92:93], v23 offset:16384
    v_add_f32 v58, v58, v155
    v_mfma_f32_16x16x32_bf16 a[92:95], v[116:119], v[220:223], a[92:95]
    v_exp_f32 v156, v156
    v_mfma_f32_16x16x32_bf16 a[96:99], v[120:123], v[208:211], a[96:99]
    ds_read_b64_tr_b16 v[94:95], v23 offset:20480
    v_cvt_pk_bf16_f32 v203, v154, v155
    v_mfma_f32_16x16x32_bf16 a[100:103], v[120:123], v[212:215], a[100:103]
    v_exp_f32 v157, v157
    v_mfma_f32_16x16x32_bf16 a[104:107], v[120:123], v[216:219], a[104:107]
    v_add_f32 v59, v59, v156
    v_add_f32 v59, v59, v157
    v_mfma_f32_16x16x32_bf16 a[108:111], v[120:123], v[220:223], a[108:111]
    v_exp_f32 v158, v158
    v_mfma_f32_16x16x32_bf16 a[112:115], v[124:127], v[208:211], a[112:115]
    v_cvt_pk_bf16_f32 v206, v156, v157
    v_add_f32 v59, v59, v158
    v_mfma_f32_16x16x32_bf16 a[116:119], v[124:127], v[212:215], a[116:119]
    s_waitcnt lgkmcnt(0)
    v_exp_f32 v159, v159
    v_mfma_f32_16x16x32_bf16 a[120:123], v[124:127], v[216:219], a[120:123]
    v_add_f32 v59, v59, v159
    v_cvt_pk_bf16_f32 v207, v158, v159
    v_mfma_f32_16x16x32_bf16 a[124:127], v[124:127], v[220:223], a[124:127]
    v_mfma_f32_16x16x32_bf16 v[128:131], a[192:195], a[128:131], v[224:227]
    v_exp_f32 v160, v160
    v_mfma_f32_16x16x32_bf16 v[128:131], a[196:199], a[132:135], v[128:131]
    ds_read_b128 a[224:227], v40 offset:40960
    v_mfma_f32_16x16x32_bf16 v[128:131], a[200:203], a[136:139], v[128:131]
    v_exp_f32 v161, v161
    v_mfma_f32_16x16x32_bf16 v[128:131], a[204:207], a[140:143], v[128:131]
    ds_read_b64_tr_b16 v[96:97], v16 offset:24576
    v_cvt_pk_bf16_f32 v208, v160, v161
    v_mfma_f32_16x16x32_bf16 v[132:135], a[192:195], a[144:147], v[228:231]
    v_exp_f32 v162, v162
    v_mfma_f32_16x16x32_bf16 v[132:135], a[196:199], a[148:151], v[132:135]
    ds_read_b64_tr_b16 v[98:99], v16 offset:28672
    v_mfma_f32_16x16x32_bf16 v[132:135], a[200:203], a[152:155], v[132:135]
    v_exp_f32 v163, v163
    v_mfma_f32_16x16x32_bf16 v[132:135], a[204:207], a[156:159], v[132:135]
    ds_read_b128 a[228:231], v41 offset:40960
    v_cvt_pk_bf16_f32 v209, v162, v163
    v_mfma_f32_16x16x32_bf16 v[136:139], a[192:195], a[160:163], v[232:235]
    v_exp_f32 v164, v164
    v_mfma_f32_16x16x32_bf16 v[136:139], a[196:199], a[164:167], v[136:139]
    v_mfma_f32_16x16x32_bf16 v[136:139], a[200:203], a[168:171], v[136:139]
    v_exp_f32 v165, v165
    v_mfma_f32_16x16x32_bf16 v[136:139], a[204:207], a[172:175], v[136:139]
    ds_read_b64_tr_b16 v[100:101], v17 offset:24576
    v_cvt_pk_bf16_f32 v212, v164, v165
    v_mfma_f32_16x16x32_bf16 v[140:143], a[192:195], a[176:179], v[236:239]
    v_exp_f32 v166, v166
    v_mfma_f32_16x16x32_bf16 v[140:143], a[196:199], a[180:183], v[140:143]
    ds_read_b64_tr_b16 v[102:103], v17 offset:28672
    v_mfma_f32_16x16x32_bf16 v[140:143], a[200:203], a[184:187], v[140:143]
    v_exp_f32 v167, v167
    v_mfma_f32_16x16x32_bf16 v[140:143], a[204:207], a[188:191], v[140:143]
    ds_read_b128 a[232:235], v42 offset:40960
    v_cvt_pk_bf16_f32 v213, v166, v167
    v_mfma_f32_16x16x32_bf16 v[144:147], a[208:211], a[128:131], v[224:227]
    v_exp_f32 v168, v168
    v_mfma_f32_16x16x32_bf16 v[144:147], a[212:215], a[132:135], v[144:147]
    v_add_f32 v58, v58, v168
    v_mfma_f32_16x16x32_bf16 v[144:147], a[216:219], a[136:139], v[144:147]
    v_exp_f32 v169, v169
    v_mfma_f32_16x16x32_bf16 v[144:147], a[220:223], a[140:143], v[144:147]
    ds_read_b64_tr_b16 v[104:105], v18 offset:24576
    v_add_f32 v58, v58, v169
    v_mfma_f32_16x16x32_bf16 v[148:151], a[208:211], a[144:147], v[228:231]
    v_exp_f32 v170, v170
    v_mfma_f32_16x16x32_bf16 v[148:151], a[212:215], a[148:151], v[148:151]
    ds_read_b64_tr_b16 v[106:107], v18 offset:28672
    v_cvt_pk_bf16_f32 v216, v168, v169
    v_mfma_f32_16x16x32_bf16 v[148:151], a[216:219], a[152:155], v[148:151]
    v_exp_f32 v171, v171
    v_mfma_f32_16x16x32_bf16 v[148:151], a[220:223], a[156:159], v[148:151]
    ds_read_b128 a[236:239], v43 offset:40960
    v_add_f32 v58, v58, v170
    v_mfma_f32_16x16x32_bf16 v[152:155], a[208:211], a[160:163], v[232:235]
    v_exp_f32 v172, v172
    v_mfma_f32_16x16x32_bf16 v[152:155], a[212:215], a[164:167], v[152:155]
    ds_read_b64_tr_b16 v[108:109], v19 offset:24576
    v_add_f32 v58, v58, v171
    v_mfma_f32_16x16x32_bf16 v[152:155], a[216:219], a[168:171], v[152:155]
    v_exp_f32 v173, v173
    v_mfma_f32_16x16x32_bf16 v[152:155], a[220:223], a[172:175], v[152:155]
    v_cvt_pk_bf16_f32 v217, v170, v171
    v_add_f32 v59, v59, v172
    v_mfma_f32_16x16x32_bf16 v[156:159], a[208:211], a[176:179], v[236:239]
    v_exp_f32 v174, v174
    v_mfma_f32_16x16x32_bf16 v[156:159], a[212:215], a[180:183], v[156:159]
    ds_read_b64_tr_b16 v[110:111], v19 offset:28672
    v_add_f32 v59, v59, v173
    v_mfma_f32_16x16x32_bf16 v[156:159], a[216:219], a[184:187], v[156:159]
    v_exp_f32 v175, v175
    v_mfma_f32_16x16x32_bf16 v[156:159], a[220:223], a[188:191], v[156:159]
    ds_read_b128 a[240:243], v40 offset:45056
    v_cvt_pk_bf16_f32 v220, v172, v173
    v_mfma_f32_16x16x32_bf16 a[0:3], v[64:67], v[192:195], a[0:3]
    ds_read_b64_tr_b16 v[112:113], v20 offset:24576
    v_add_f32 v59, v59, v174
    v_mfma_f32_16x16x32_bf16 a[4:7], v[64:67], v[196:199], a[4:7]
    v_exp_f32 v176, v176
    v_mfma_f32_16x16x32_bf16 a[8:11], v[64:67], v[200:203], a[8:11]
    v_add_f32 v59, v59, v175
    v_cvt_pk_bf16_f32 v221, v174, v175
    v_mfma_f32_16x16x32_bf16 a[12:15], v[64:67], v[204:207], a[12:15]
    v_exp_f32 v177, v177
    v_mfma_f32_16x16x32_bf16 a[16:19], v[68:71], v[192:195], a[16:19]
    ds_read_b64_tr_b16 v[114:115], v20 offset:28672
    v_cvt_pk_bf16_f32 v210, v176, v177
    v_mfma_f32_16x16x32_bf16 a[20:23], v[68:71], v[196:199], a[20:23]
    v_exp_f32 v178, v178
    v_mfma_f32_16x16x32_bf16 a[24:27], v[68:71], v[200:203], a[24:27]
    ds_read_b128 a[244:247], v41 offset:45056
    v_mfma_f32_16x16x32_bf16 a[28:31], v[68:71], v[204:207], a[28:31]
    v_exp_f32 v179, v179
    v_mfma_f32_16x16x32_bf16 v[240:243], v[32:35], v[192:195], v[240:243]
    ds_read_b64_tr_b16 v[116:117], v21 offset:24576
    v_cvt_pk_bf16_f32 v211, v178, v179
    v_mfma_f32_16x16x32_bf16 a[32:35], v[72:75], v[192:195], a[32:35]
    v_exp_f32 v180, v180
    v_mfma_f32_16x16x32_bf16 a[36:39], v[72:75], v[196:199], a[36:39]
    ds_read_b64_tr_b16 v[118:119], v21 offset:28672
    v_mfma_f32_16x16x32_bf16 a[40:43], v[72:75], v[200:203], a[40:43]
    v_exp_f32 v181, v181
    v_mfma_f32_16x16x32_bf16 a[44:47], v[72:75], v[204:207], a[44:47]
    v_cvt_pk_bf16_f32 v214, v180, v181
    v_mfma_f32_16x16x32_bf16 a[48:51], v[76:79], v[192:195], a[48:51]
    v_exp_f32 v182, v182
    v_mfma_f32_16x16x32_bf16 a[52:55], v[76:79], v[196:199], a[52:55]
    ds_read_b128 a[248:251], v42 offset:45056
    v_mfma_f32_16x16x32_bf16 a[56:59], v[76:79], v[200:203], a[56:59]
    v_exp_f32 v183, v183
    v_mfma_f32_16x16x32_bf16 a[60:63], v[76:79], v[204:207], a[60:63]
    ds_read_b64_tr_b16 v[120:121], v22 offset:24576
    v_cvt_pk_bf16_f32 v215, v182, v183
    v_mfma_f32_16x16x32_bf16 v[244:247], v[32:35], v[196:199], v[244:247]
    v_exp_f32 v184, v184
    v_mfma_f32_16x16x32_bf16 a[64:67], v[80:83], v[192:195], a[64:67]
    ds_read_b64_tr_b16 v[122:123], v22 offset:28672
    v_add_f32 v58, v58, v184
    v_mfma_f32_16x16x32_bf16 a[68:71], v[80:83], v[196:199], a[68:71]
    v_exp_f32 v185, v185
    v_mfma_f32_16x16x32_bf16 a[72:75], v[80:83], v[200:203], a[72:75]
    v_add_f32 v58, v58, v185
    v_cvt_pk_bf16_f32 v218, v184, v185
    v_mfma_f32_16x16x32_bf16 a[76:79], v[80:83], v[204:207], a[76:79]
    v_exp_f32 v186, v186
    v_mfma_f32_16x16x32_bf16 a[80:83], v[84:87], v[192:195], a[80:83]
    ds_read_b128 a[252:255], v43 offset:45056
    v_add_f32 v58, v58, v186
    v_mfma_f32_16x16x32_bf16 a[84:87], v[84:87], v[196:199], a[84:87]
    v_exp_f32 v187, v187
    v_mfma_f32_16x16x32_bf16 a[88:91], v[84:87], v[200:203], a[88:91]
    ds_read_b64_tr_b16 v[124:125], v23 offset:24576
    v_add_f32 v58, v58, v187
    v_mfma_f32_16x16x32_bf16 a[92:95], v[84:87], v[204:207], a[92:95]
    v_exp_f32 v188, v188
    v_mfma_f32_16x16x32_bf16 a[96:99], v[88:91], v[192:195], a[96:99]
    ds_read_b64_tr_b16 v[126:127], v23 offset:28672
    v_cvt_pk_bf16_f32 v219, v186, v187
    v_mfma_f32_16x16x32_bf16 a[100:103], v[88:91], v[196:199], a[100:103]
    v_exp_f32 v189, v189
    v_mfma_f32_16x16x32_bf16 a[104:107], v[88:91], v[200:203], a[104:107]
    v_add_f32 v59, v59, v188
    v_add_f32 v59, v59, v189
    v_mfma_f32_16x16x32_bf16 a[108:111], v[88:91], v[204:207], a[108:111]
    v_exp_f32 v190, v190
    v_mfma_f32_16x16x32_bf16 a[112:115], v[92:95], v[192:195], a[112:115]
    v_cvt_pk_bf16_f32 v222, v188, v189
    v_add_f32 v59, v59, v190
    v_mfma_f32_16x16x32_bf16 a[116:119], v[92:95], v[196:199], a[116:119]
    v_exp_f32 v191, v191
    v_mfma_f32_16x16x32_bf16 a[120:123], v[92:95], v[200:203], a[120:123]
    v_add_f32 v59, v59, v191
    v_cvt_pk_bf16_f32 v223, v190, v191
    v_mfma_f32_16x16x32_bf16 a[124:127], v[92:95], v[204:207], a[124:127]
    s_waitcnt vmcnt(0) lgkmcnt(0)
    s_barrier
    s_cmp_lg_u32 s48, 1
    s_cbranch_scc1 L_k1_nored
    s_and_b32 s50, s2, 7
    s_lshr_b32 s50, s50, 1
    s_lshr_b32 s51, s2, 3
    s_mul_i32 s50, s50, 1472
    s_mul_i32 s51, s51, 46
    s_add_u32 s50, s50, s51
    s_add_u32 s51, s50, 0
    s_sub_u32 s52, s51, 4096
    s_cmp_lt_u32 s51, 4096
    s_cselect_b32 s8, s94, s96
    s_cselect_b32 s9, s95, s97
    s_mov_b32 s53, 1835008
    s_cselect_b32 s10, 0x400000, s53
    s_cselect_b32 s51, s51, s52
    s_lshl_b32 s46, s51, 10
    s_add_u32 s51, s50, 32
    s_sub_u32 s52, s51, 4096
    s_cmp_lt_u32 s51, 4096
    s_cselect_b32 s12, s94, s96
    s_cselect_b32 s13, s95, s97
    s_mov_b32 s53, 1835008
    s_cselect_b32 s14, 0x400000, s53
    s_cselect_b32 s51, s51, s52
    s_lshl_b32 s47, s51, 10
    s_mov_b32 s65, 0x7fffffff
    v_mov_b32 v14, 0
    buffer_load_dword v15, v14, s[36:39], s58 offen sc1
    s_getpc_b64 s[24:25]
L_k1_pc:
    s_add_u32 s26, s24, L_k1_loopdone-L_k1_pc
    s_addc_u32 s27, s25, 0
    s_add_u32 s24, s24, out_kernel-L_k1_pc
    s_addc_u32 s25, s25, 0
    s_lshr_b32 s51, s2, 3
    s_lshl_b32 s51, s51, 2
    s_add_u32 s51, s51, s3
    s_lshl_b32 s51, s51, 10
    v_add_u32 v12, s51, v54
    s_mov_b32 s52, L_k2_codeend-out_kernel-16
    v_min_u32 v12, s52, v12
    global_load_dwordx4 v[8:11], v12, s[24:25]
    s_lshl_b32 s51, s3, 10
    v_add_u32 v13, s51, v54
    s_mov_b32 s52, L_k1_codeend-L_k1_loopdone-16
    v_min_u32 v13, s52, v13
    global_load_dwordx4 v[8:11], v13, s[26:27]
L_k1_nored:
    v_mfma_f32_16x16x32_bf16 v[160:163], a[224:227], a[128:131], v[224:227]
    v_exp_f32 v128, v128
    v_mfma_f32_16x16x32_bf16 v[160:163], a[228:231], a[132:135], v[160:163]
    ds_read_b128 a[192:195], v40 offset:49152
    v_mfma_f32_16x16x32_bf16 v[160:163], a[232:235], a[136:139], v[160:163]
    v_exp_f32 v129, v129
    v_mfma_f32_16x16x32_bf16 v[160:163], a[236:239], a[140:143], v[160:163]
    ds_read_b64_tr_b16 v[64:65], v16 offset:32768
    v_cvt_pk_bf16_f32 v192, v128, v129
    v_mfma_f32_16x16x32_bf16 v[164:167], a[224:227], a[144:147], v[228:231]
    v_exp_f32 v130, v130
    v_mfma_f32_16x16x32_bf16 v[164:167], a[228:231], a[148:151], v[164:167]
    ds_read_b64_tr_b16 v[66:67], v16 offset:36864
    v_mfma_f32_16x16x32_bf16 v[164:167], a[232:235], a[152:155], v[164:167]
    v_exp_f32 v131, v131
    v_mfma_f32_16x16x32_bf16 v[164:167], a[236:239], a[156:159], v[164:167]
    ds_read_b128 a[196:199], v41 offset:49152
    v_cvt_pk_bf16_f32 v193, v130, v131
    v_mfma_f32_16x16x32_bf16 v[168:171], a[224:227], a[160:163], v[232:235]
    s_add_u32 m0, s44, 16384
    v_exp_f32 v132, v132
    v_mfma_f32_16x16x32_bf16 v[168:171], a[228:231], a[164:167], v[168:171]
    buffer_load_dwordx4 v44, s[8:11], s46 offen offset:0 lds
    v_mfma_f32_16x16x32_bf16 v[168:171], a[232:235], a[168:171], v[168:171]
    v_exp_f32 v133, v133
    v_mfma_f32_16x16x32_bf16 v[168:171], a[236:239], a[172:175], v[168:171]
    ds_read_b64_tr_b16 v[68:69], v17 offset:32768
    v_cvt_pk_bf16_f32 v196, v132, v133
    v_mfma_f32_16x16x32_bf16 v[172:175], a[224:227], a[176:179], v[236:239]
    v_exp_f32 v134, v134
    v_mfma_f32_16x16x32_bf16 v[172:175], a[228:231], a[180:183], v[172:175]
    ds_read_b64_tr_b16 v[70:71], v17 offset:36864
    v_mfma_f32_16x16x32_bf16 v[172:175], a[232:235], a[184:187], v[172:175]
    v_exp_f32 v135, v135
    v_mfma_f32_16x16x32_bf16 v[172:175], a[236:239], a[188:191], v[172:175]
    ds_read_b128 a[200:203], v42 offset:49152
    v_cvt_pk_bf16_f32 v197, v134, v135
    v_mfma_f32_16x16x32_bf16 v[176:179], a[240:243], a[128:131], v[224:227]
    v_exp_f32 v136, v136
    v_mfma_f32_16x16x32_bf16 v[176:179], a[244:247], a[132:135], v[176:179]
    buffer_load_dwordx4 v45, s[8:11], s46 offen offset:1024 lds
    v_add_f32 v58, v58, v136
    v_mfma_f32_16x16x32_bf16 v[176:179], a[248:251], a[136:139], v[176:179]
    v_exp_f32 v137, v137
    v_mfma_f32_16x16x32_bf16 v[176:179], a[252:255], a[140:143], v[176:179]
    ds_read_b64_tr_b16 v[72:73], v18 offset:32768
    v_add_f32 v58, v58, v137
    v_mfma_f32_16x16x32_bf16 v[180:183], a[240:243], a[144:147], v[228:231]
    v_exp_f32 v138, v138
    v_mfma_f32_16x16x32_bf16 v[180:183], a[244:247], a[148:151], v[180:183]
    ds_read_b64_tr_b16 v[74:75], v18 offset:36864
    v_cvt_pk_bf16_f32 v200, v136, v137
    v_mfma_f32_16x16x32_bf16 v[180:183], a[248:251], a[152:155], v[180:183]
    v_exp_f32 v139, v139
    v_mfma_f32_16x16x32_bf16 v[180:183], a[252:255], a[156:159], v[180:183]
    ds_read_b128 a[204:207], v43 offset:49152
    v_add_f32 v58, v58, v138
    v_mfma_f32_16x16x32_bf16 v[184:187], a[240:243], a[160:163], v[232:235]
    v_exp_f32 v140, v140
    v_mfma_f32_16x16x32_bf16 v[184:187], a[244:247], a[164:167], v[184:187]
    ds_read_b64_tr_b16 v[76:77], v19 offset:32768
    v_add_f32 v58, v58, v139
    v_mfma_f32_16x16x32_bf16 v[184:187], a[248:251], a[168:171], v[184:187]
    v_exp_f32 v141, v141
    v_mfma_f32_16x16x32_bf16 v[184:187], a[252:255], a[172:175], v[184:187]
    buffer_load_dwordx4 v46, s[8:11], s46 offen offset:2048 lds
    v_cvt_pk_bf16_f32 v201, v138, v139
    v_mfma_f32_16x16x32_bf16 v[188:191], a[240:243], a[176:179], v[236:239]
    v_exp_f32 v142, v142
    v_mfma_f32_16x16x32_bf16 v[188:191], a[244:247], a[180:183], v[188:191]
    ds_read_b64_tr_b16 v[78:79], v19 offset:36864
    v_add_f32 v59, v59, v140
    v_mfma_f32_16x16x32_bf16 v[188:191], a[248:251], a[184:187], v[188:191]
    v_exp_f32 v143, v143
    v_mfma_f32_16x16x32_bf16 v[188:191], a[252:255], a[188:191], v[188:191]
    ds_read_b128 a[208:211], v40 offset:53248
    v_add_f32 v59, v59, v141
    v_mfma_f32_16x16x32_bf16 a[0:3], v[96:99], v[208:211], a[0:3]
    ds_read_b64_tr_b16 v[80:81], v20 offset:32768
    v_cvt_pk_bf16_f32 v204, v140, v141
    v_mfma_f32_16x16x32_bf16 a[4:7], v[96:99], v[212:215], a[4:7]
    v_exp_f32 v144, v144
    v_mfma_f32_16x16x32_bf16 a[8:11], v[96:99], v[216:219], a[8:11]
    buffer_load_dwordx4 v47, s[8:11], s46 offen offset:3072 lds
    v_add_f32 v59, v59, v142
    v_mfma_f32_16x16x32_bf16 a[12:15], v[96:99], v[220:223], a[12:15]
    v_exp_f32 v145, v145
    v_mfma_f32_16x16x32_bf16 a[16:19], v[100:103], v[208:211], a[16:19]
    ds_read_b64_tr_b16 v[82:83], v20 offset:36864
    v_add_f32 v59, v59, v143
    v_mfma_f32_16x16x32_bf16 a[20:23], v[100:103], v[212:215], a[20:23]
    v_exp_f32 v146, v146
    v_mfma_f32_16x16x32_bf16 a[24:27], v[100:103], v[216:219], a[24:27]
    ds_read_b128 a[212:215], v41 offset:53248
    v_cvt_pk_bf16_f32 v205, v142, v143
    v_mfma_f32_16x16x32_bf16 a[28:31], v[100:103], v[220:223], a[28:31]
    v_exp_f32 v147, v147
    v_mfma_f32_16x16x32_bf16 v[240:243], v[32:35], v[208:211], v[240:243]
    ds_read_b64_tr_b16 v[84:85], v21 offset:32768
    v_cvt_pk_bf16_f32 v194, v144, v145
    v_mfma_f32_16x16x32_bf16 a[32:35], v[104:107], v[208:211], a[32:35]
    v_exp_f32 v148, v148
    v_mfma_f32_16x16x32_bf16 a[36:39], v[104:107], v[212:215], a[36:39]
    ds_read_b64_tr_b16 v[86:87], v21 offset:36864
    v_cvt_pk_bf16_f32 v195, v146, v147
    v_mfma_f32_16x16x32_bf16 a[40:43], v[104:107], v[216:219], a[40:43]
    s_add_u32 s46, s46, 16384
    s_min_u32 s46, s46, s65
    s_add_u32 m0, s44, 32768
    v_exp_f32 v149, v149
    v_mfma_f32_16x16x32_bf16 a[44:47], v[104:107], v[220:223], a[44:47]
    buffer_load_dwordx4 v44, s[8:11], s46 offen offset:0 lds
    v_cvt_pk_bf16_f32 v198, v148, v149
    v_mfma_f32_16x16x32_bf16 a[48:51], v[108:111], v[208:211], a[48:51]
    v_exp_f32 v150, v150
    v_mfma_f32_16x16x32_bf16 a[52:55], v[108:111], v[212:215], a[52:55]
    ds_read_b128 a[216:219], v42 offset:53248
    v_mfma_f32_16x16x32_bf16 a[56:59], v[108:111], v[216:219], a[56:59]
    v_exp_f32 v151, v151
    v_mfma_f32_16x16x32_bf16 a[60:63], v[108:111], v[220:223], a[60:63]
    ds_read_b64_tr_b16 v[88:89], v22 offset:32768
    v_cvt_pk_bf16_f32 v199, v150, v151
    v_mfma_f32_16x16x32_bf16 v[244:247], v[32:35], v[212:215], v[244:247]
    v_exp_f32 v152, v152
    v_mfma_f32_16x16x32_bf16 a[64:67], v[112:115], v[208:211], a[64:67]
    ds_read_b64_tr_b16 v[90:91], v22 offset:36864
    v_add_f32 v58, v58, v152
    v_mfma_f32_16x16x32_bf16 a[68:71], v[112:115], v[212:215], a[68:71]
    v_exp_f32 v153, v153
    v_mfma_f32_16x16x32_bf16 a[72:75], v[112:115], v[216:219], a[72:75]
    buffer_load_dwordx4 v45, s[8:11], s46 offen offset:1024 lds
    v_add_f32 v58, v58, v153
    v_mfma_f32_16x16x32_bf16 a[76:79], v[112:115], v[220:223], a[76:79]
    v_exp_f32 v154, v154
    v_mfma_f32_16x16x32_bf16 a[80:83], v[116:119], v[208:211], a[80:83]
    ds_read_b128 a[220:223], v43 offset:53248
    v_cvt_pk_bf16_f32 v202, v152, v153
    v_mfma_f32_16x16x32_bf16 a[84:87], v[116:119], v[212:215], a[84:87]
    v_exp_f32 v155, v155
    v_mfma_f32_16x16x32_bf16 a[88:91], v[116:119], v[216:219], a[88:91]
    ds_read_b64_tr_b16 v[92:93], v23 offset:32768
    v_add_f32 v58, v58, v154
    v_mfma_f32_16x16x32_bf16 a[92:95], v[116:119], v[220:223], a[92:95]
    v_exp_f32 v156, v156
    v_mfma_f32_16x16x32_bf16 a[96:99], v[120:123], v[208:211], a[96:99]
    ds_read_b64_tr_b16 v[94:95], v23 offset:36864
    v_add_f32 v58, v58, v155
    v_mfma_f32_16x16x32_bf16 a[100:103], v[120:123], v[212:215], a[100:103]
    v_exp_f32 v157, v157
    v_mfma_f32_16x16x32_bf16 a[104:107], v[120:123], v[216:219], a[104:107]
    buffer_load_dwordx4 v46, s[8:11], s46 offen offset:2048 lds
    v_cvt_pk_bf16_f32 v203, v154, v155
    v_mfma_f32_16x16x32_bf16 a[108:111], v[120:123], v[220:223], a[108:111]
    v_exp_f32 v158, v158
    v_mfma_f32_16x16x32_bf16 a[112:115], v[124:127], v[208:211], a[112:115]
    buffer_load_dwordx4 v47, s[8:11], s46 offen offset:3072 lds
    v_add_f32 v59, v59, v156
    v_mfma_f32_16x16x32_bf16 a[116:119], v[124:127], v[212:215], a[116:119]
    s_waitcnt lgkmcnt(0)
    v_exp_f32 v159, v159
    v_mfma_f32_16x16x32_bf16 a[120:123], v[124:127], v[216:219], a[120:123]
    v_add_f32 v59, v59, v157
    v_cvt_pk_bf16_f32 v206, v156, v157
    v_add_f32 v59, v59, v158
    v_mfma_f32_16x16x32_bf16 a[124:127], v[124:127], v[220:223], a[124:127]
    v_add_f32 v59, v59, v159
    v_cvt_pk_bf16_f32 v207, v158, v159
    s_add_u32 s46, s46, 16384
    s_min_u32 s46, s46, s65
    v_mfma_f32_16x16x32_bf16 v[128:131], a[192:195], a[128:131], v[224:227]
    v_exp_f32 v160, v160
    v_mfma_f32_16x16x32_bf16 v[128:131], a[196:199], a[132:135], v[128:131]
    ds_read_b128 a[224:227], v40 offset:57344
    v_mfma_f32_16x16x32_bf16 v[128:131], a[200:203], a[136:139], v[128:131]
    v_exp_f32 v161, v161
    v_mfma_f32_16x16x32_bf16 v[128:131], a[204:207], a[140:143], v[128:131]
    ds_read_b64_tr_b16 v[96:97], v16 offset:40960
    v_cvt_pk_bf16_f32 v208, v160, v161
    v_mfma_f32_16x16x32_bf16 v[132:135], a[192:195], a[144:147], v[228:231]
    v_exp_f32 v162, v162
    v_mfma_f32_16x16x32_bf16 v[132:135], a[196:199], a[148:151], v[132:135]
    ds_read_b64_tr_b16 v[98:99], v16 offset:45056
    v_mfma_f32_16x16x32_bf16 v[132:135], a[200:203], a[152:155], v[132:135]
    v_exp_f32 v163, v163
    v_mfma_f32_16x16x32_bf16 v[132:135], a[204:207], a[156:159], v[132:135]
    ds_read_b128 a[228:231], v41 offset:57344
    v_cvt_pk_bf16_f32 v209, v162, v163
    v_mfma_f32_16x16x32_bf16 v[136:139], a[192:195], a[160:163], v[232:235]
    s_add_u32 m0, s44, 65536
    v_exp_f32 v164, v164
    v_mfma_f32_16x16x32_bf16 v[136:139], a[196:199], a[164:167], v[136:139]
    buffer_load_dwordx4 v48, s[12:15], s47 offen offset:0 lds
    v_mfma_f32_16x16x32_bf16 v[136:139], a[200:203], a[168:171], v[136:139]
    v_exp_f32 v165, v165
    v_mfma_f32_16x16x32_bf16 v[136:139], a[204:207], a[172:175], v[136:139]
    ds_read_b64_tr_b16 v[100:101], v17 offset:40960
    v_cvt_pk_bf16_f32 v212, v164, v165
    v_mfma_f32_16x16x32_bf16 v[140:143], a[192:195], a[176:179], v[236:239]
    v_exp_f32 v166, v166
    v_mfma_f32_16x16x32_bf16 v[140:143], a[196:199], a[180:183], v[140:143]
    ds_read_b64_tr_b16 v[102:103], v17 offset:45056
    v_mfma_f32_16x16x32_bf16 v[140:143], a[200:203], a[184:187], v[140:143]
    v_exp_f32 v167, v167
    v_mfma_f32_16x16x32_bf16 v[140:143], a[204:207], a[188:191], v[140:143]
    ds_read_b128 a[232:235], v42 offset:57344
    v_cvt_pk_bf16_f32 v213, v166, v167
    v_mfma_f32_16x16x32_bf16 v[144:147], a[208:211], a[128:131], v[224:227]
    v_exp_f32 v168, v168
    v_mfma_f32_16x16x32_bf16 v[144:147], a[212:215], a[132:135], v[144:147]
    buffer_load_dwordx4 v49, s[12:15], s47 offen offset:1024 lds
    v_add_f32 v58, v58, v168
    v_mfma_f32_16x16x32_bf16 v[144:147], a[216:219], a[136:139], v[144:147]
    v_exp_f32 v169, v169
    v_mfma_f32_16x16x32_bf16 v[144:147], a[220:223], a[140:143], v[144:147]
    ds_read_b64_tr_b16 v[104:105], v18 offset:40960
    v_add_f32 v58, v58, v169
    v_mfma_f32_16x16x32_bf16 v[148:151], a[208:211], a[144:147], v[228:231]
    v_exp_f32 v170, v170
    v_mfma_f32_16x16x32_bf16 v[148:151], a[212:215], a[148:151], v[148:151]
    ds_read_b64_tr_b16 v[106:107], v18 offset:45056
    v_cvt_pk_bf16_f32 v216, v168, v169
    v_mfma_f32_16x16x32_bf16 v[148:151], a[216:219], a[152:155], v[148:151]
    v_exp_f32 v171, v171
    v_mfma_f32_16x16x32_bf16 v[148:151], a[220:223], a[156:159], v[148:151]
    ds_read_b128 a[236:239], v43 offset:57344
    v_add_f32 v58, v58, v170
    v_mfma_f32_16x16x32_bf16 v[152:155], a[208:211], a[160:163], v[232:235]
    v_exp_f32 v172, v172
    v_mfma_f32_16x16x32_bf16 v[152:155], a[212:215], a[164:167], v[152:155]
    ds_read_b64_tr_b16 v[108:109], v19 offset:40960
    v_add_f32 v58, v58, v171
    v_mfma_f32_16x16x32_bf16 v[152:155], a[216:219], a[168:171], v[152:155]
    v_exp_f32 v173, v173
    v_mfma_f32_16x16x32_bf16 v[152:155], a[220:223], a[172:175], v[152:155]
    buffer_load_dwordx4 v48, s[12:15], s47 offen offset:2048 lds
    v_cvt_pk_bf16_f32 v217, v170, v171
    v_mfma_f32_16x16x32_bf16 v[156:159], a[208:211], a[176:179], v[236:239]
    v_exp_f32 v174, v174
    v_mfma_f32_16x16x32_bf16 v[156:159], a[212:215], a[180:183], v[156:159]
    ds_read_b64_tr_b16 v[110:111], v19 offset:45056
    v_add_f32 v59, v59, v172
    v_mfma_f32_16x16x32_bf16 v[156:159], a[216:219], a[184:187], v[156:159]
    v_exp_f32 v175, v175
    v_mfma_f32_16x16x32_bf16 v[156:159], a[220:223], a[188:191], v[156:159]
    ds_read_b128 a[240:243], v40 offset:61440
    v_add_f32 v59, v59, v173
    v_mfma_f32_16x16x32_bf16 a[0:3], v[64:67], v[192:195], a[0:3]
    ds_read_b64_tr_b16 v[112:113], v20 offset:40960
    v_cvt_pk_bf16_f32 v220, v172, v173
    v_mfma_f32_16x16x32_bf16 a[4:7], v[64:67], v[196:199], a[4:7]
    v_exp_f32 v176, v176
    v_mfma_f32_16x16x32_bf16 a[8:11], v[64:67], v[200:203], a[8:11]
    buffer_load_dwordx4 v49, s[12:15], s47 offen offset:3072 lds
    v_add_f32 v59, v59, v174
    v_mfma_f32_16x16x32_bf16 a[12:15], v[64:67], v[204:207], a[12:15]
    v_exp_f32 v177, v177
    v_mfma_f32_16x16x32_bf16 a[16:19], v[68:71], v[192:195], a[16:19]
    ds_read_b64_tr_b16 v[114:115], v20 offset:45056
    v_add_f32 v59, v59, v175
    v_mfma_f32_16x16x32_bf16 a[20:23], v[68:71], v[196:199], a[20:23]
    v_exp_f32 v178, v178
    v_mfma_f32_16x16x32_bf16 a[24:27], v[68:71], v[200:203], a[24:27]
    ds_read_b128 a[244:247], v41 offset:61440
    v_cvt_pk_bf16_f32 v221, v174, v175
    v_mfma_f32_16x16x32_bf16 a[28:31], v[68:71], v[204:207], a[28:31]
    v_exp_f32 v179, v179
    v_mfma_f32_16x16x32_bf16 v[240:243], v[32:35], v[192:195], v[240:243]
    ds_read_b64_tr_b16 v[116:117], v21 offset:40960
    v_cvt_pk_bf16_f32 v210, v176, v177
    v_mfma_f32_16x16x32_bf16 a[32:35], v[72:75], v[192:195], a[32:35]
    v_exp_f32 v180, v180
    v_mfma_f32_16x16x32_bf16 a[36:39], v[72:75], v[196:199], a[36:39]
    ds_read_b64_tr_b16 v[118:119], v21 offset:45056
    v_cvt_pk_bf16_f32 v211, v178, v179
    v_mfma_f32_16x16x32_bf16 a[40:43], v[72:75], v[200:203], a[40:43]
    s_add_u32 s47, s47, 16384
    s_min_u32 s47, s47, s65
    s_add_u32 m0, s44, 81920
    v_exp_f32 v181, v181
    v_mfma_f32_16x16x32_bf16 a[44:47], v[72:75], v[204:207], a[44:47]
    buffer_load_dwordx4 v48, s[12:15], s47 offen offset:0 lds
    v_cvt_pk_bf16_f32 v214, v180, v181
    v_mfma_f32_16x16x32_bf16 a[48:51], v[76:79], v[192:195], a[48:51]
    v_exp_f32 v182, v182
    v_mfma_f32_16x16x32_bf16 a[52:55], v[76:79], v[196:199], a[52:55]
    ds_read_b128 a[248:251], v42 offset:61440
    v_mfma_f32_16x16x32_bf16 a[56:59], v[76:79], v[200:203], a[56:59]
    v_exp_f32 v183, v183
    v_mfma_f32_16x16x32_bf16 a[60:63], v[76:79], v[204:207], a[60:63]
    ds_read_b64_tr_b16 v[120:121], v22 offset:40960
    v_cvt_pk_bf16_f32 v215, v182, v183
    v_mfma_f32_16x16x32_bf16 v[244:247], v[32:35], v[196:199], v[244:247]
    v_exp_f32 v184, v184
    v_mfma_f32_16x16x32_bf16 a[64:67], v[80:83], v[192:195], a[64:67]
    ds_read_b64_tr_b16 v[122:123], v22 offset:45056
    v_add_f32 v58, v58, v184
    v_mfma_f32_16x16x32_bf16 a[68:71], v[80:83], v[196:199], a[68:71]
    v_exp_f32 v185, v185
    v_mfma_f32_16x16x32_bf16 a[72:75], v[80:83], v[200:203], a[72:75]
    buffer_load_dwordx4 v49, s[12:15], s47 offen offset:1024 lds
    v_add_f32 v58, v58, v185
    v_mfma_f32_16x16x32_bf16 a[76:79], v[80:83], v[204:207], a[76:79]
    v_exp_f32 v186, v186
    v_mfma_f32_16x16x32_bf16 a[80:83], v[84:87], v[192:195], a[80:83]
    ds_read_b128 a[252:255], v43 offset:61440
    v_cvt_pk_bf16_f32 v218, v184, v185
    v_mfma_f32_16x16x32_bf16 a[84:87], v[84:87], v[196:199], a[84:87]
    v_exp_f32 v187, v187
    v_mfma_f32_16x16x32_bf16 a[88:91], v[84:87], v[200:203], a[88:91]
    ds_read_b64_tr_b16 v[124:125], v23 offset:40960
    v_add_f32 v58, v58, v186
    v_mfma_f32_16x16x32_bf16 a[92:95], v[84:87], v[204:207], a[92:95]
    v_exp_f32 v188, v188
    v_mfma_f32_16x16x32_bf16 a[96:99], v[88:91], v[192:195], a[96:99]
    ds_read_b64_tr_b16 v[126:127], v23 offset:45056
    v_add_f32 v58, v58, v187
    v_mfma_f32_16x16x32_bf16 a[100:103], v[88:91], v[196:199], a[100:103]
    v_exp_f32 v189, v189
    v_mfma_f32_16x16x32_bf16 a[104:107], v[88:91], v[200:203], a[104:107]
    buffer_load_dwordx4 v48, s[12:15], s47 offen offset:2048 lds
    v_cvt_pk_bf16_f32 v219, v186, v187
    v_mfma_f32_16x16x32_bf16 a[108:111], v[88:91], v[204:207], a[108:111]
    v_exp_f32 v190, v190
    v_mfma_f32_16x16x32_bf16 a[112:115], v[92:95], v[192:195], a[112:115]
    buffer_load_dwordx4 v49, s[12:15], s47 offen offset:3072 lds
    v_add_f32 v59, v59, v188
    v_mfma_f32_16x16x32_bf16 a[116:119], v[92:95], v[196:199], a[116:119]
    s_waitcnt lgkmcnt(0)
    v_exp_f32 v191, v191
    v_mfma_f32_16x16x32_bf16 a[120:123], v[92:95], v[200:203], a[120:123]
    v_add_f32 v59, v59, v189
    v_cvt_pk_bf16_f32 v222, v188, v189
    v_add_f32 v59, v59, v190
    v_mfma_f32_16x16x32_bf16 a[124:127], v[92:95], v[204:207], a[124:127]
    v_add_f32 v59, v59, v191
    v_cvt_pk_bf16_f32 v223, v190, v191
    s_add_u32 s47, s47, 16384
    s_min_u32 s47, s47, s65
    v_mfma_f32_16x16x32_bf16 v[160:163], a[224:227], a[128:131], v[224:227]
    v_exp_f32 v128, v128
    v_mfma_f32_16x16x32_bf16 v[160:163], a[228:231], a[132:135], v[160:163]
    ds_read_b128 a[192:195], v40 offset:0
    v_mfma_f32_16x16x32_bf16 v[160:163], a[232:235], a[136:139], v[160:163]
    v_exp_f32 v129, v129
    v_mfma_f32_16x16x32_bf16 v[160:163], a[236:239], a[140:143], v[160:163]
    ds_read_b64_tr_b16 v[64:65], v16 offset:49152
    v_cvt_pk_bf16_f32 v192, v128, v129
    v_mfma_f32_16x16x32_bf16 v[164:167], a[224:227], a[144:147], v[228:231]
    v_exp_f32 v130, v130
    v_mfma_f32_16x16x32_bf16 v[164:167], a[228:231], a[148:151], v[164:167]
    ds_read_b64_tr_b16 v[66:67], v16 offset:53248
    v_mfma_f32_16x16x32_bf16 v[164:167], a[232:235], a[152:155], v[164:167]
    v_exp_f32 v131, v131
    v_mfma_f32_16x16x32_bf16 v[164:167], a[236:239], a[156:159], v[164:167]
    ds_read_b128 a[196:199], v41 offset:0
    v_cvt_pk_bf16_f32 v193, v130, v131
    v_mfma_f32_16x16x32_bf16 v[168:171], a[224:227], a[160:163], v[232:235]
    v_exp_f32 v132, v132
    v_mfma_f32_16x16x32_bf16 v[168:171], a[228:231], a[164:167], v[168:171]
    v_mfma_f32_16x16x32_bf16 v[168:171], a[232:235], a[168:171], v[168:171]
    v_exp_f32 v133, v133
    v_mfma_f32_16x16x32_bf16 v[168:171], a[236:239], a[172:175], v[168:171]
    ds_read_b64_tr_b16 v[68:69], v17 offset:49152
    v_cvt_pk_bf16_f32 v196, v132, v133
    v_mfma_f32_16x16x32_bf16 v[172:175], a[224:227], a[176:179], v[236:239]
    v_exp_f32 v134, v134
    v_mfma_f32_16x16x32_bf16 v[172:175], a[228:231], a[180:183], v[172:175]
    ds_read_b64_tr_b16 v[70:71], v17 offset:53248
    v_mfma_f32_16x16x32_bf16 v[172:175], a[232:235], a[184:187], v[172:175]
    v_exp_f32 v135, v135
    v_mfma_f32_16x16x32_bf16 v[172:175], a[236:239], a[188:191], v[172:175]
    ds_read_b128 a[200:203], v42 offset:0
    v_cvt_pk_bf16_f32 v197, v134, v135
    v_mfma_f32_16x16x32_bf16 v[176:179], a[240:243], a[128:131], v[224:227]
    v_exp_f32 v136, v136
    v_mfma_f32_16x16x32_bf16 v[176:179], a[244:247], a[132:135], v[176:179]
    v_add_f32 v58, v58, v136
    v_mfma_f32_16x16x32_bf16 v[176:179], a[248:251], a[136:139], v[176:179]
    v_exp_f32 v137, v137
    v_mfma_f32_16x16x32_bf16 v[176:179], a[252:255], a[140:143], v[176:179]
    ds_read_b64_tr_b16 v[72:73], v18 offset:49152
    v_add_f32 v58, v58, v137
    v_mfma_f32_16x16x32_bf16 v[180:183], a[240:243], a[144:147], v[228:231]
    v_exp_f32 v138, v138
    v_mfma_f32_16x16x32_bf16 v[180:183], a[244:247], a[148:151], v[180:183]
    ds_read_b64_tr_b16 v[74:75], v18 offset:53248
    v_cvt_pk_bf16_f32 v200, v136, v137
    v_mfma_f32_16x16x32_bf16 v[180:183], a[248:251], a[152:155], v[180:183]
    v_exp_f32 v139, v139
    v_mfma_f32_16x16x32_bf16 v[180:183], a[252:255], a[156:159], v[180:183]
    ds_read_b128 a[204:207], v43 offset:0
    v_add_f32 v58, v58, v138
    v_mfma_f32_16x16x32_bf16 v[184:187], a[240:243], a[160:163], v[232:235]
    v_exp_f32 v140, v140
    v_mfma_f32_16x16x32_bf16 v[184:187], a[244:247], a[164:167], v[184:187]
    ds_read_b64_tr_b16 v[76:77], v19 offset:49152
    v_add_f32 v58, v58, v139
    v_mfma_f32_16x16x32_bf16 v[184:187], a[248:251], a[168:171], v[184:187]
    v_exp_f32 v141, v141
    v_mfma_f32_16x16x32_bf16 v[184:187], a[252:255], a[172:175], v[184:187]
    v_cvt_pk_bf16_f32 v201, v138, v139
    v_add_f32 v59, v59, v140
    v_mfma_f32_16x16x32_bf16 v[188:191], a[240:243], a[176:179], v[236:239]
    v_exp_f32 v142, v142
    v_mfma_f32_16x16x32_bf16 v[188:191], a[244:247], a[180:183], v[188:191]
    ds_read_b64_tr_b16 v[78:79], v19 offset:53248
    v_add_f32 v59, v59, v141
    v_mfma_f32_16x16x32_bf16 v[188:191], a[248:251], a[184:187], v[188:191]
    v_exp_f32 v143, v143
    v_mfma_f32_16x16x32_bf16 v[188:191], a[252:255], a[188:191], v[188:191]
    ds_read_b128 a[208:211], v40 offset:4096
    v_cvt_pk_bf16_f32 v204, v140, v141
    v_mfma_f32_16x16x32_bf16 a[0:3], v[96:99], v[208:211], a[0:3]
    ds_read_b64_tr_b16 v[80:81], v20 offset:49152
    v_add_f32 v59, v59, v142
    v_mfma_f32_16x16x32_bf16 a[4:7], v[96:99], v[212:215], a[4:7]
    v_exp_f32 v144, v144
    v_mfma_f32_16x16x32_bf16 a[8:11], v[96:99], v[216:219], a[8:11]
    v_add_f32 v59, v59, v143
    v_cvt_pk_bf16_f32 v205, v142, v143
    v_mfma_f32_16x16x32_bf16 a[12:15], v[96:99], v[220:223], a[12:15]
    v_exp_f32 v145, v145
    v_mfma_f32_16x16x32_bf16 a[16:19], v[100:103], v[208:211], a[16:19]
    ds_read_b64_tr_b16 v[82:83], v20 offset:53248
    v_cvt_pk_bf16_f32 v194, v144, v145
    v_mfma_f32_16x16x32_bf16 a[20:23], v[100:103], v[212:215], a[20:23]
    v_exp_f32 v146, v146
    v_mfma_f32_16x16x32_bf16 a[24:27], v[100:103], v[216:219], a[24:27]
    ds_read_b128 a[212:215], v41 offset:4096
    v_mfma_f32_16x16x32_bf16 a[28:31], v[100:103], v[220:223], a[28:31]
    v_exp_f32 v147, v147
    v_mfma_f32_16x16x32_bf16 v[240:243], v[32:35], v[208:211], v[240:243]
    ds_read_b64_tr_b16 v[84:85], v21 offset:49152
    v_cvt_pk_bf16_f32 v195, v146, v147
    v_mfma_f32_16x16x32_bf16 a[32:35], v[104:107], v[208:211], a[32:35]
    v_exp_f32 v148, v148
    v_mfma_f32_16x16x32_bf16 a[36:39], v[104:107], v[212:215], a[36:39]
    ds_read_b64_tr_b16 v[86:87], v21 offset:53248
    v_mfma_f32_16x16x32_bf16 a[40:43], v[104:107], v[216:219], a[40:43]
    v_exp_f32 v149, v149
    v_mfma_f32_16x16x32_bf16 a[44:47], v[104:107], v[220:223], a[44:47]
    v_cvt_pk_bf16_f32 v198, v148, v149
    v_mfma_f32_16x16x32_bf16 a[48:51], v[108:111], v[208:211], a[48:51]
    v_exp_f32 v150, v150
    v_mfma_f32_16x16x32_bf16 a[52:55], v[108:111], v[212:215], a[52:55]
    ds_read_b128 a[216:219], v42 offset:4096
    v_mfma_f32_16x16x32_bf16 a[56:59], v[108:111], v[216:219], a[56:59]
    v_exp_f32 v151, v151
    v_mfma_f32_16x16x32_bf16 a[60:63], v[108:111], v[220:223], a[60:63]
    ds_read_b64_tr_b16 v[88:89], v22 offset:49152
    v_cvt_pk_bf16_f32 v199, v150, v151
    v_mfma_f32_16x16x32_bf16 v[244:247], v[32:35], v[212:215], v[244:247]
    v_exp_f32 v152, v152
    v_mfma_f32_16x16x32_bf16 a[64:67], v[112:115], v[208:211], a[64:67]
    ds_read_b64_tr_b16 v[90:91], v22 offset:53248
    v_add_f32 v58, v58, v152
    v_mfma_f32_16x16x32_bf16 a[68:71], v[112:115], v[212:215], a[68:71]
    v_exp_f32 v153, v153
    v_mfma_f32_16x16x32_bf16 a[72:75], v[112:115], v[216:219], a[72:75]
    v_add_f32 v58, v58, v153
    v_cvt_pk_bf16_f32 v202, v152, v153
    v_mfma_f32_16x16x32_bf16 a[76:79], v[112:115], v[220:223], a[76:79]
    v_exp_f32 v154, v154
    v_mfma_f32_16x16x32_bf16 a[80:83], v[116:119], v[208:211], a[80:83]
    ds_read_b128 a[220:223], v43 offset:4096
    v_add_f32 v58, v58, v154
    v_mfma_f32_16x16x32_bf16 a[84:87], v[116:119], v[212:215], a[84:87]
    v_exp_f32 v155, v155
    v_mfma_f32_16x16x32_bf16 a[88:91], v[116:119], v[216:219], a[88:91]
    ds_read_b64_tr_b16 v[92:93], v23 offset:49152
    v_add_f32 v58, v58, v155
    v_mfma_f32_16x16x32_bf16 a[92:95], v[116:119], v[220:223], a[92:95]
    v_exp_f32 v156, v156
    v_mfma_f32_16x16x32_bf16 a[96:99], v[120:123], v[208:211], a[96:99]
    ds_read_b64_tr_b16 v[94:95], v23 offset:53248
    v_cvt_pk_bf16_f32 v203, v154, v155
    v_mfma_f32_16x16x32_bf16 a[100:103], v[120:123], v[212:215], a[100:103]
    v_exp_f32 v157, v157
    v_mfma_f32_16x16x32_bf16 a[104:107], v[120:123], v[216:219], a[104:107]
    v_add_f32 v59, v59, v156
    v_add_f32 v59, v59, v157
    v_mfma_f32_16x16x32_bf16 a[108:111], v[120:123], v[220:223], a[108:111]
    v_exp_f32 v158, v158
    v_mfma_f32_16x16x32_bf16 a[112:115], v[124:127], v[208:211], a[112:115]
    v_cvt_pk_bf16_f32 v206, v156, v157
    v_add_f32 v59, v59, v158
    v_mfma_f32_16x16x32_bf16 a[116:119], v[124:127], v[212:215], a[116:119]
    s_waitcnt lgkmcnt(0)
    v_exp_f32 v159, v159
    v_mfma_f32_16x16x32_bf16 a[120:123], v[124:127], v[216:219], a[120:123]
    v_add_f32 v59, v59, v159
    v_cvt_pk_bf16_f32 v207, v158, v159
    v_mfma_f32_16x16x32_bf16 a[124:127], v[124:127], v[220:223], a[124:127]
    v_mfma_f32_16x16x32_bf16 v[128:131], a[192:195], a[128:131], v[224:227]
    v_exp_f32 v160, v160
    v_mfma_f32_16x16x32_bf16 v[128:131], a[196:199], a[132:135], v[128:131]
    ds_read_b128 a[224:227], v40 offset:8192
    v_mfma_f32_16x16x32_bf16 v[128:131], a[200:203], a[136:139], v[128:131]
    v_exp_f32 v161, v161
    v_mfma_f32_16x16x32_bf16 v[128:131], a[204:207], a[140:143], v[128:131]
    ds_read_b64_tr_b16 v[96:97], v16 offset:57344
    v_cvt_pk_bf16_f32 v208, v160, v161
    v_mfma_f32_16x16x32_bf16 v[132:135], a[192:195], a[144:147], v[228:231]
    v_exp_f32 v162, v162
    v_mfma_f32_16x16x32_bf16 v[132:135], a[196:199], a[148:151], v[132:135]
    ds_read_b64_tr_b16 v[98:99], v16 offset:61440
    v_mfma_f32_16x16x32_bf16 v[132:135], a[200:203], a[152:155], v[132:135]
    v_exp_f32 v163, v163
    v_mfma_f32_16x16x32_bf16 v[132:135], a[204:207], a[156:159], v[132:135]
    ds_read_b128 a[228:231], v41 offset:8192
    v_cvt_pk_bf16_f32 v209, v162, v163
    v_mfma_f32_16x16x32_bf16 v[136:139], a[192:195], a[160:163], v[232:235]
    v_exp_f32 v164, v164
    v_mfma_f32_16x16x32_bf16 v[136:139], a[196:199], a[164:167], v[136:139]
    v_mfma_f32_16x16x32_bf16 v[136:139], a[200:203], a[168:171], v[136:139]
    v_exp_f32 v165, v165
    v_mfma_f32_16x16x32_bf16 v[136:139], a[204:207], a[172:175], v[136:139]
    ds_read_b64_tr_b16 v[100:101], v17 offset:57344
    v_cvt_pk_bf16_f32 v212, v164, v165
    v_mfma_f32_16x16x32_bf16 v[140:143], a[192:195], a[176:179], v[236:239]
    v_exp_f32 v166, v166
    v_mfma_f32_16x16x32_bf16 v[140:143], a[196:199], a[180:183], v[140:143]
    ds_read_b64_tr_b16 v[102:103], v17 offset:61440
    v_mfma_f32_16x16x32_bf16 v[140:143], a[200:203], a[184:187], v[140:143]
    v_exp_f32 v167, v167
    v_mfma_f32_16x16x32_bf16 v[140:143], a[204:207], a[188:191], v[140:143]
    ds_read_b128 a[232:235], v42 offset:8192
    v_cvt_pk_bf16_f32 v213, v166, v167
    v_mfma_f32_16x16x32_bf16 v[144:147], a[208:211], a[128:131], v[224:227]
    v_exp_f32 v168, v168
    v_mfma_f32_16x16x32_bf16 v[144:147], a[212:215], a[132:135], v[144:147]
    v_add_f32 v58, v58, v168
    v_mfma_f32_16x16x32_bf16 v[144:147], a[216:219], a[136:139], v[144:147]
    v_exp_f32 v169, v169
    v_mfma_f32_16x16x32_bf16 v[144:147], a[220:223], a[140:143], v[144:147]
    ds_read_b64_tr_b16 v[104:105], v18 offset:57344
    v_add_f32 v58, v58, v169
    v_mfma_f32_16x16x32_bf16 v[148:151], a[208:211], a[144:147], v[228:231]
    v_exp_f32 v170, v170
    v_mfma_f32_16x16x32_bf16 v[148:151], a[212:215], a[148:151], v[148:151]
    ds_read_b64_tr_b16 v[106:107], v18 offset:61440
    v_cvt_pk_bf16_f32 v216, v168, v169
    v_mfma_f32_16x16x32_bf16 v[148:151], a[216:219], a[152:155], v[148:151]
    v_exp_f32 v171, v171
    v_mfma_f32_16x16x32_bf16 v[148:151], a[220:223], a[156:159], v[148:151]
    ds_read_b128 a[236:239], v43 offset:8192
    v_add_f32 v58, v58, v170
    v_mfma_f32_16x16x32_bf16 v[152:155], a[208:211], a[160:163], v[232:235]
    v_exp_f32 v172, v172
    v_mfma_f32_16x16x32_bf16 v[152:155], a[212:215], a[164:167], v[152:155]
    ds_read_b64_tr_b16 v[108:109], v19 offset:57344
    v_add_f32 v58, v58, v171
    v_mfma_f32_16x16x32_bf16 v[152:155], a[216:219], a[168:171], v[152:155]
    v_exp_f32 v173, v173
    v_mfma_f32_16x16x32_bf16 v[152:155], a[220:223], a[172:175], v[152:155]
    v_cvt_pk_bf16_f32 v217, v170, v171
    v_add_f32 v59, v59, v172
    v_mfma_f32_16x16x32_bf16 v[156:159], a[208:211], a[176:179], v[236:239]
    v_exp_f32 v174, v174
    v_mfma_f32_16x16x32_bf16 v[156:159], a[212:215], a[180:183], v[156:159]
    ds_read_b64_tr_b16 v[110:111], v19 offset:61440
    v_add_f32 v59, v59, v173
    v_mfma_f32_16x16x32_bf16 v[156:159], a[216:219], a[184:187], v[156:159]
    v_exp_f32 v175, v175
    v_mfma_f32_16x16x32_bf16 v[156:159], a[220:223], a[188:191], v[156:159]
    ds_read_b128 a[240:243], v40 offset:12288
    v_cvt_pk_bf16_f32 v220, v172, v173
    v_mfma_f32_16x16x32_bf16 a[0:3], v[64:67], v[192:195], a[0:3]
    ds_read_b64_tr_b16 v[112:113], v20 offset:57344
    v_add_f32 v59, v59, v174
    v_mfma_f32_16x16x32_bf16 a[4:7], v[64:67], v[196:199], a[4:7]
    v_exp_f32 v176, v176
    v_mfma_f32_16x16x32_bf16 a[8:11], v[64:67], v[200:203], a[8:11]
    v_add_f32 v59, v59, v175
    v_cvt_pk_bf16_f32 v221, v174, v175
    v_mfma_f32_16x16x32_bf16 a[12:15], v[64:67], v[204:207], a[12:15]
    v_exp_f32 v177, v177
    v_mfma_f32_16x16x32_bf16 a[16:19], v[68:71], v[192:195], a[16:19]
    ds_read_b64_tr_b16 v[114:115], v20 offset:61440
    v_cvt_pk_bf16_f32 v210, v176, v177
    v_mfma_f32_16x16x32_bf16 a[20:23], v[68:71], v[196:199], a[20:23]
    v_exp_f32 v178, v178
    v_mfma_f32_16x16x32_bf16 a[24:27], v[68:71], v[200:203], a[24:27]
    ds_read_b128 a[244:247], v41 offset:12288
    v_mfma_f32_16x16x32_bf16 a[28:31], v[68:71], v[204:207], a[28:31]
    v_exp_f32 v179, v179
    v_mfma_f32_16x16x32_bf16 v[240:243], v[32:35], v[192:195], v[240:243]
    ds_read_b64_tr_b16 v[116:117], v21 offset:57344
    v_cvt_pk_bf16_f32 v211, v178, v179
    v_mfma_f32_16x16x32_bf16 a[32:35], v[72:75], v[192:195], a[32:35]
    v_exp_f32 v180, v180
    v_mfma_f32_16x16x32_bf16 a[36:39], v[72:75], v[196:199], a[36:39]
    ds_read_b64_tr_b16 v[118:119], v21 offset:61440
    v_mfma_f32_16x16x32_bf16 a[40:43], v[72:75], v[200:203], a[40:43]
    v_exp_f32 v181, v181
    v_mfma_f32_16x16x32_bf16 a[44:47], v[72:75], v[204:207], a[44:47]
    v_cvt_pk_bf16_f32 v214, v180, v181
    v_mfma_f32_16x16x32_bf16 a[48:51], v[76:79], v[192:195], a[48:51]
    v_exp_f32 v182, v182
    v_mfma_f32_16x16x32_bf16 a[52:55], v[76:79], v[196:199], a[52:55]
    ds_read_b128 a[248:251], v42 offset:12288
    v_mfma_f32_16x16x32_bf16 a[56:59], v[76:79], v[200:203], a[56:59]
    v_exp_f32 v183, v183
    v_mfma_f32_16x16x32_bf16 a[60:63], v[76:79], v[204:207], a[60:63]
    ds_read_b64_tr_b16 v[120:121], v22 offset:57344
    v_cvt_pk_bf16_f32 v215, v182, v183
    v_mfma_f32_16x16x32_bf16 v[244:247], v[32:35], v[196:199], v[244:247]
    v_exp_f32 v184, v184
    v_mfma_f32_16x16x32_bf16 a[64:67], v[80:83], v[192:195], a[64:67]
    ds_read_b64_tr_b16 v[122:123], v22 offset:61440
    v_add_f32 v58, v58, v184
    v_mfma_f32_16x16x32_bf16 a[68:71], v[80:83], v[196:199], a[68:71]
    v_exp_f32 v185, v185
    v_mfma_f32_16x16x32_bf16 a[72:75], v[80:83], v[200:203], a[72:75]
    v_add_f32 v58, v58, v185
    v_cvt_pk_bf16_f32 v218, v184, v185
    v_mfma_f32_16x16x32_bf16 a[76:79], v[80:83], v[204:207], a[76:79]
    v_exp_f32 v186, v186
    v_mfma_f32_16x16x32_bf16 a[80:83], v[84:87], v[192:195], a[80:83]
    ds_read_b128 a[252:255], v43 offset:12288
    v_add_f32 v58, v58, v186
    v_mfma_f32_16x16x32_bf16 a[84:87], v[84:87], v[196:199], a[84:87]
    v_exp_f32 v187, v187
    v_mfma_f32_16x16x32_bf16 a[88:91], v[84:87], v[200:203], a[88:91]
    ds_read_b64_tr_b16 v[124:125], v23 offset:57344
    v_add_f32 v58, v58, v187
    v_mfma_f32_16x16x32_bf16 a[92:95], v[84:87], v[204:207], a[92:95]
    v_exp_f32 v188, v188
    v_mfma_f32_16x16x32_bf16 a[96:99], v[88:91], v[192:195], a[96:99]
    ds_read_b64_tr_b16 v[126:127], v23 offset:61440
    v_cvt_pk_bf16_f32 v219, v186, v187
    v_mfma_f32_16x16x32_bf16 a[100:103], v[88:91], v[196:199], a[100:103]
    v_exp_f32 v189, v189
    v_mfma_f32_16x16x32_bf16 a[104:107], v[88:91], v[200:203], a[104:107]
    v_add_f32 v59, v59, v188
    v_add_f32 v59, v59, v189
    v_mfma_f32_16x16x32_bf16 a[108:111], v[88:91], v[204:207], a[108:111]
    v_exp_f32 v190, v190
    v_mfma_f32_16x16x32_bf16 a[112:115], v[92:95], v[192:195], a[112:115]
    v_cvt_pk_bf16_f32 v222, v188, v189
    v_add_f32 v59, v59, v190
    v_mfma_f32_16x16x32_bf16 a[116:119], v[92:95], v[196:199], a[116:119]
    v_exp_f32 v191, v191
    v_mfma_f32_16x16x32_bf16 a[120:123], v[92:95], v[200:203], a[120:123]
    v_add_f32 v59, v59, v191
    v_cvt_pk_bf16_f32 v223, v190, v191
    v_mfma_f32_16x16x32_bf16 a[124:127], v[92:95], v[204:207], a[124:127]
    s_waitcnt lgkmcnt(0)
    s_cmp_eq_u32 s48, 1
    s_cbranch_scc1 L_k1_loopdone
    s_waitcnt vmcnt(0)
    s_barrier
    s_sub_u32 s48, s48, 1
    s_branch L_k1_loop
L_k1_loopdone:
    s_waitcnt vmcnt(0)
    s_barrier
    s_nop 1
    v_mfma_f32_16x16x32_bf16 v[240:243], v[32:35], v[208:211], v[240:243]
    v_mfma_f32_16x16x32_bf16 v[244:247], v[32:35], v[212:215], v[244:247]
    v_mfma_f32_16x16x32_bf16 a[0:3], v[96:99], v[208:211], a[0:3]
    v_mfma_f32_16x16x32_bf16 a[4:7], v[96:99], v[212:215], a[4:7]
    v_mfma_f32_16x16x32_bf16 a[8:11], v[96:99], v[216:219], a[8:11]
    v_mfma_f32_16x16x32_bf16 a[12:15], v[96:99], v[220:223], a[12:15]
    v_mfma_f32_16x16x32_bf16 a[16:19], v[100:103], v[208:211], a[16:19]
    v_mfma_f32_16x16x32_bf16 a[20:23], v[100:103], v[212:215], a[20:23]
    v_mfma_f32_16x16x32_bf16 a[24:27], v[100:103], v[216:219], a[24:27]
    v_mfma_f32_16x16x32_bf16 a[28:31], v[100:103], v[220:223], a[28:31]
    v_mov_b32 v1, v58
    s_nop 1
    v_permlane32_swap_b32 v1, v58
    s_nop 1
    v_add_f32 v58, v58, v1
    v_mov_b32 v1, v58
    s_nop 1
    v_permlane16_swap_b32 v1, v58
    s_nop 1
    v_add_f32 v58, v58, v1
    v_mov_b32 v1, v59
    s_nop 1
    v_permlane32_swap_b32 v1, v59
    s_nop 1
    v_add_f32 v59, v59, v1
    v_mov_b32 v1, v59
    s_nop 1
    v_permlane16_swap_b32 v1, v59
    s_nop 1
    v_add_f32 v59, v59, v1
    s_mov_b32 s50, 0x4e800000
    v_add_f32 v2, v240, v244
    v_add_f32 v3, v58, v59
    v_add_f32 v2, v2, v3
    v_cmp_nge_f32 vcc, s50, v2
    v_mfma_f32_16x16x32_bf16 a[32:35], v[104:107], v[208:211], a[32:35]
    v_mfma_f32_16x16x32_bf16 a[36:39], v[104:107], v[212:215], a[36:39]
    v_mfma_f32_16x16x32_bf16 a[40:43], v[104:107], v[216:219], a[40:43]
    v_mfma_f32_16x16x32_bf16 a[44:47], v[104:107], v[220:223], a[44:47]
    v_mfma_f32_16x16x32_bf16 a[48:51], v[108:111], v[208:211], a[48:51]
    v_mfma_f32_16x16x32_bf16 a[52:55], v[108:111], v[212:215], a[52:55]
    v_mfma_f32_16x16x32_bf16 a[56:59], v[108:111], v[216:219], a[56:59]
    v_mfma_f32_16x16x32_bf16 a[60:63], v[108:111], v[220:223], a[60:63]
    s_cbranch_vccnz L_k1_fallback
L_k1_norm:
    v_rcp_f32 v240, v240
    v_rcp_f32 v244, v244
    v_rcp_f32 v58, v58
    v_rcp_f32 v59, v59
    s_nop 1
    v_mfma_f32_16x16x32_bf16 a[64:67], v[112:115], v[208:211], a[64:67]
    v_accvgpr_read_b32 v128, a0
    v_accvgpr_read_b32 v129, a1
    v_accvgpr_read_b32 v130, a2
    v_accvgpr_read_b32 v131, a3
    v_mfma_f32_16x16x32_bf16 a[68:71], v[112:115], v[212:215], a[68:71]
    v_accvgpr_read_b32 v132, a16
    v_accvgpr_read_b32 v133, a17
    v_accvgpr_read_b32 v134, a18
    v_accvgpr_read_b32 v135, a19
    v_mul_f32 v128, v128, v240
    v_mul_f32 v129, v129, v240
    v_mul_f32 v130, v130, v240
    v_mul_f32 v131, v131, v240
    v_mul_f32 v132, v132, v240
    v_mul_f32 v133, v133, v240
    v_mul_f32 v134, v134, v240
    v_mul_f32 v135, v135, v240
    v_cvt_pk_bf16_f32 v136, v128, v129
    v_cvt_pk_bf16_f32 v137, v130, v131
    v_cvt_pk_bf16_f32 v138, v132, v133
    v_cvt_pk_bf16_f32 v139, v134, v135
    buffer_store_dwordx4 v[136:139], v54, s[36:39], s58 offen offset:0 sc1
    v_mfma_f32_16x16x32_bf16 a[72:75], v[112:115], v[216:219], a[72:75]
    v_accvgpr_read_b32 v140, a4
    v_accvgpr_read_b32 v141, a5
    v_accvgpr_read_b32 v142, a6
    v_accvgpr_read_b32 v143, a7
    v_mfma_f32_16x16x32_bf16 a[76:79], v[112:115], v[220:223], a[76:79]
    v_accvgpr_read_b32 v144, a20
    v_accvgpr_read_b32 v145, a21
    v_accvgpr_read_b32 v146, a22
    v_accvgpr_read_b32 v147, a23
    v_mul_f32 v140, v140, v244
    v_mul_f32 v141, v141, v244
    v_mul_f32 v142, v142, v244
    v_mul_f32 v143, v143, v244
    v_mul_f32 v144, v144, v244
    v_mul_f32 v145, v145, v244
    v_mul_f32 v146, v146, v244
    v_mul_f32 v147, v147, v244
    v_cvt_pk_bf16_f32 v148, v140, v141
    v_cvt_pk_bf16_f32 v149, v142, v143
    v_cvt_pk_bf16_f32 v150, v144, v145
    v_cvt_pk_bf16_f32 v151, v146, v147
    buffer_store_dwordx4 v[148:151], v54, s[36:39], s59 offen offset:0 sc1
    v_mfma_f32_16x16x32_bf16 a[80:83], v[116:119], v[208:211], a[80:83]
    v_accvgpr_read_b32 v152, a8
    v_accvgpr_read_b32 v153, a9
    v_accvgpr_read_b32 v154, a10
    v_accvgpr_read_b32 v155, a11
    v_mfma_f32_16x16x32_bf16 a[84:87], v[116:119], v[212:215], a[84:87]
    v_accvgpr_read_b32 v156, a24
    v_accvgpr_read_b32 v157, a25
    v_accvgpr_read_b32 v158, a26
    v_accvgpr_read_b32 v159, a27
    v_mul_f32 v152, v152, v58
    v_mul_f32 v153, v153, v58
    v_mul_f32 v154, v154, v58
    v_mul_f32 v155, v155, v58
    v_mul_f32 v156, v156, v58
    v_mul_f32 v157, v157, v58
    v_mul_f32 v158, v158, v58
    v_mul_f32 v159, v159, v58
    v_cvt_pk_bf16_f32 v160, v152, v153
    v_cvt_pk_bf16_f32 v161, v154, v155
    v_cvt_pk_bf16_f32 v162, v156, v157
    v_cvt_pk_bf16_f32 v163, v158, v159
    buffer_store_dwordx4 v[160:163], v54, s[36:39], s60 offen offset:0 sc1
    v_mfma_f32_16x16x32_bf16 a[88:91], v[116:119], v[216:219], a[88:91]
    v_accvgpr_read_b32 v164, a12
    v_accvgpr_read_b32 v165, a13
    v_accvgpr_read_b32 v166, a14
    v_accvgpr_read_b32 v167, a15
    v_mfma_f32_16x16x32_bf16 a[92:95], v[116:119], v[220:223], a[92:95]
    v_accvgpr_read_b32 v168, a28
    v_accvgpr_read_b32 v169, a29
    v_accvgpr_read_b32 v170, a30
    v_accvgpr_read_b32 v171, a31
    v_mul_f32 v164, v164, v59
    v_mul_f32 v165, v165, v59
    v_mul_f32 v166, v166, v59
    v_mul_f32 v167, v167, v59
    v_mul_f32 v168, v168, v59
    v_mul_f32 v169, v169, v59
    v_mul_f32 v170, v170, v59
    v_mul_f32 v171, v171, v59
    v_cvt_pk_bf16_f32 v172, v164, v165
    v_cvt_pk_bf16_f32 v173, v166, v167
    v_cvt_pk_bf16_f32 v174, v168, v169
    v_cvt_pk_bf16_f32 v175, v170, v171
    buffer_store_dwordx4 v[172:175], v54, s[36:39], s61 offen offset:0 sc1
    v_mfma_f32_16x16x32_bf16 a[96:99], v[120:123], v[208:211], a[96:99]
    v_accvgpr_read_b32 v128, a32
    v_accvgpr_read_b32 v129, a33
    v_accvgpr_read_b32 v130, a34
    v_accvgpr_read_b32 v131, a35
    v_mfma_f32_16x16x32_bf16 a[100:103], v[120:123], v[212:215], a[100:103]
    v_accvgpr_read_b32 v132, a48
    v_accvgpr_read_b32 v133, a49
    v_accvgpr_read_b32 v134, a50
    v_accvgpr_read_b32 v135, a51
    v_mul_f32 v128, v128, v240
    v_mul_f32 v129, v129, v240
    v_mul_f32 v130, v130, v240
    v_mul_f32 v131, v131, v240
    v_mul_f32 v132, v132, v240
    v_mul_f32 v133, v133, v240
    v_mul_f32 v134, v134, v240
    v_mul_f32 v135, v135, v240
    v_cvt_pk_bf16_f32 v136, v128, v129
    v_cvt_pk_bf16_f32 v137, v130, v131
    v_cvt_pk_bf16_f32 v138, v132, v133
    v_cvt_pk_bf16_f32 v139, v134, v135
    buffer_store_dwordx4 v[136:139], v54, s[36:39], s58 offen offset:1024 sc1
    v_mfma_f32_16x16x32_bf16 a[104:107], v[120:123], v[216:219], a[104:107]
    v_accvgpr_read_b32 v140, a36
    v_accvgpr_read_b32 v141, a37
    v_accvgpr_read_b32 v142, a38
    v_accvgpr_read_b32 v143, a39
    v_mfma_f32_16x16x32_bf16 a[108:111], v[120:123], v[220:223], a[108:111]
    v_accvgpr_read_b32 v144, a52
    v_accvgpr_read_b32 v145, a53
    v_accvgpr_read_b32 v146, a54
    v_accvgpr_read_b32 v147, a55
    v_mul_f32 v140, v140, v244
    v_mul_f32 v141, v141, v244
    v_mul_f32 v142, v142, v244
    v_mul_f32 v143, v143, v244
    v_mul_f32 v144, v144, v244
    v_mul_f32 v145, v145, v244
    v_mul_f32 v146, v146, v244
    v_mul_f32 v147, v147, v244
    v_cvt_pk_bf16_f32 v148, v140, v141
    v_cvt_pk_bf16_f32 v149, v142, v143
    v_cvt_pk_bf16_f32 v150, v144, v145
    v_cvt_pk_bf16_f32 v151, v146, v147
    buffer_store_dwordx4 v[148:151], v54, s[36:39], s59 offen offset:1024 sc1
    v_mfma_f32_16x16x32_bf16 a[112:115], v[124:127], v[208:211], a[112:115]
    v_accvgpr_read_b32 v152, a40
    v_accvgpr_read_b32 v153, a41
    v_accvgpr_read_b32 v154, a42
    v_accvgpr_read_b32 v155, a43
    v_mfma_f32_16x16x32_bf16 a[116:119], v[124:127], v[212:215], a[116:119]
    v_accvgpr_read_b32 v156, a56
    v_accvgpr_read_b32 v157, a57
    v_accvgpr_read_b32 v158, a58
    v_accvgpr_read_b32 v159, a59
    v_mul_f32 v152, v152, v58
    v_mul_f32 v153, v153, v58
    v_mul_f32 v154, v154, v58
    v_mul_f32 v155, v155, v58
    v_mul_f32 v156, v156, v58
    v_mul_f32 v157, v157, v58
    v_mul_f32 v158, v158, v58
    v_mul_f32 v159, v159, v58
    v_cvt_pk_bf16_f32 v160, v152, v153
    v_cvt_pk_bf16_f32 v161, v154, v155
    v_cvt_pk_bf16_f32 v162, v156, v157
    v_cvt_pk_bf16_f32 v163, v158, v159
    buffer_store_dwordx4 v[160:163], v54, s[36:39], s60 offen offset:1024 sc1
    v_mfma_f32_16x16x32_bf16 a[120:123], v[124:127], v[216:219], a[120:123]
    v_accvgpr_read_b32 v164, a44
    v_accvgpr_read_b32 v165, a45
    v_accvgpr_read_b32 v166, a46
    v_accvgpr_read_b32 v167, a47
    v_mfma_f32_16x16x32_bf16 a[124:127], v[124:127], v[220:223], a[124:127]
    v_accvgpr_read_b32 v168, a60
    v_accvgpr_read_b32 v169, a61
    v_accvgpr_read_b32 v170, a62
    v_accvgpr_read_b32 v171, a63
    v_mul_f32 v164, v164, v59
    v_mul_f32 v165, v165, v59
    v_mul_f32 v166, v166, v59
    v_mul_f32 v167, v167, v59
    v_mul_f32 v168, v168, v59
    v_mul_f32 v169, v169, v59
    v_mul_f32 v170, v170, v59
    v_mul_f32 v171, v171, v59
    v_cvt_pk_bf16_f32 v172, v164, v165
    v_cvt_pk_bf16_f32 v173, v166, v167
    v_cvt_pk_bf16_f32 v174, v168, v169
    v_cvt_pk_bf16_f32 v175, v170, v171
    buffer_store_dwordx4 v[172:175], v54, s[36:39], s61 offen offset:1024 sc1
    v_accvgpr_read_b32 v128, a64
    v_accvgpr_read_b32 v129, a65
    v_accvgpr_read_b32 v130, a66
    v_accvgpr_read_b32 v131, a67
    v_accvgpr_read_b32 v132, a80
    v_accvgpr_read_b32 v133, a81
    v_accvgpr_read_b32 v134, a82
    v_accvgpr_read_b32 v135, a83
    v_mul_f32 v128, v128, v240
    v_mul_f32 v129, v129, v240
    v_mul_f32 v130, v130, v240
    v_mul_f32 v131, v131, v240
    v_mul_f32 v132, v132, v240
    v_mul_f32 v133, v133, v240
    v_mul_f32 v134, v134, v240
    v_mul_f32 v135, v135, v240
    v_cvt_pk_bf16_f32 v136, v128, v129
    v_cvt_pk_bf16_f32 v137, v130, v131
    v_cvt_pk_bf16_f32 v138, v132, v133
    v_cvt_pk_bf16_f32 v139, v134, v135
    buffer_store_dwordx4 v[136:139], v54, s[36:39], s58 offen offset:2048 sc1
    v_accvgpr_read_b32 v140, a68
    v_accvgpr_read_b32 v141, a69
    v_accvgpr_read_b32 v142, a70
    v_accvgpr_read_b32 v143, a71
    v_accvgpr_read_b32 v144, a84
    v_accvgpr_read_b32 v145, a85
    v_accvgpr_read_b32 v146, a86
    v_accvgpr_read_b32 v147, a87
    v_mul_f32 v140, v140, v244
    v_mul_f32 v141, v141, v244
    v_mul_f32 v142, v142, v244
    v_mul_f32 v143, v143, v244
    v_mul_f32 v144, v144, v244
    v_mul_f32 v145, v145, v244
    v_mul_f32 v146, v146, v244
    v_mul_f32 v147, v147, v244
    v_cvt_pk_bf16_f32 v148, v140, v141
    v_cvt_pk_bf16_f32 v149, v142, v143
    v_cvt_pk_bf16_f32 v150, v144, v145
    v_cvt_pk_bf16_f32 v151, v146, v147
    buffer_store_dwordx4 v[148:151], v54, s[36:39], s59 offen offset:2048 sc1
    v_accvgpr_read_b32 v152, a72
    v_accvgpr_read_b32 v153, a73
    v_accvgpr_read_b32 v154, a74
    v_accvgpr_read_b32 v155, a75
    v_accvgpr_read_b32 v156, a88
    v_accvgpr_read_b32 v157, a89
    v_accvgpr_read_b32 v158, a90
    v_accvgpr_read_b32 v159, a91
    v_mul_f32 v152, v152, v58
    v_mul_f32 v153, v153, v58
    v_mul_f32 v154, v154, v58
    v_mul_f32 v155, v155, v58
    v_mul_f32 v156, v156, v58
    v_mul_f32 v157, v157, v58
    v_mul_f32 v158, v158, v58
    v_mul_f32 v159, v159, v58
    v_cvt_pk_bf16_f32 v160, v152, v153
    v_cvt_pk_bf16_f32 v161, v154, v155
    v_cvt_pk_bf16_f32 v162, v156, v157
    v_cvt_pk_bf16_f32 v163, v158, v159
    buffer_store_dwordx4 v[160:163], v54, s[36:39], s60 offen offset:2048 sc1
    v_accvgpr_read_b32 v164, a76
    v_accvgpr_read_b32 v165, a77
    v_accvgpr_read_b32 v166, a78
    v_accvgpr_read_b32 v167, a79
    v_accvgpr_read_b32 v168, a92
    v_accvgpr_read_b32 v169, a93
    v_accvgpr_read_b32 v170, a94
    v_accvgpr_read_b32 v171, a95
    v_mul_f32 v164, v164, v59
    v_mul_f32 v165, v165, v59
    v_mul_f32 v166, v166, v59
    v_mul_f32 v167, v167, v59
    v_mul_f32 v168, v168, v59
    v_mul_f32 v169, v169, v59
    v_mul_f32 v170, v170, v59
    v_mul_f32 v171, v171, v59
    v_cvt_pk_bf16_f32 v172, v164, v165
    v_cvt_pk_bf16_f32 v173, v166, v167
    v_cvt_pk_bf16_f32 v174, v168, v169
    v_cvt_pk_bf16_f32 v175, v170, v171
    buffer_store_dwordx4 v[172:175], v54, s[36:39], s61 offen offset:2048 sc1
    v_accvgpr_read_b32 v128, a96
    v_accvgpr_read_b32 v129, a97
    v_accvgpr_read_b32 v130, a98
    v_accvgpr_read_b32 v131, a99
    v_accvgpr_read_b32 v132, a112
    v_accvgpr_read_b32 v133, a113
    v_accvgpr_read_b32 v134, a114
    v_accvgpr_read_b32 v135, a115
    v_mul_f32 v128, v128, v240
    v_mul_f32 v129, v129, v240
    v_mul_f32 v130, v130, v240
    v_mul_f32 v131, v131, v240
    v_mul_f32 v132, v132, v240
    v_mul_f32 v133, v133, v240
    v_mul_f32 v134, v134, v240
    v_mul_f32 v135, v135, v240
    v_cvt_pk_bf16_f32 v136, v128, v129
    v_cvt_pk_bf16_f32 v137, v130, v131
    v_cvt_pk_bf16_f32 v138, v132, v133
    v_cvt_pk_bf16_f32 v139, v134, v135
    buffer_store_dwordx4 v[136:139], v54, s[36:39], s58 offen offset:3072 sc1
    v_accvgpr_read_b32 v140, a100
    v_accvgpr_read_b32 v141, a101
    v_accvgpr_read_b32 v142, a102
    v_accvgpr_read_b32 v143, a103
    v_accvgpr_read_b32 v144, a116
    v_accvgpr_read_b32 v145, a117
    v_accvgpr_read_b32 v146, a118
    v_accvgpr_read_b32 v147, a119
    v_mul_f32 v140, v140, v244
    v_mul_f32 v141, v141, v244
    v_mul_f32 v142, v142, v244
    v_mul_f32 v143, v143, v244
    v_mul_f32 v144, v144, v244
    v_mul_f32 v145, v145, v244
    v_mul_f32 v146, v146, v244
    v_mul_f32 v147, v147, v244
    v_cvt_pk_bf16_f32 v148, v140, v141
    v_cvt_pk_bf16_f32 v149, v142, v143
    v_cvt_pk_bf16_f32 v150, v144, v145
    v_cvt_pk_bf16_f32 v151, v146, v147
    buffer_store_dwordx4 v[148:151], v54, s[36:39], s59 offen offset:3072 sc1
    v_accvgpr_read_b32 v152, a104
    v_accvgpr_read_b32 v153, a105
    v_accvgpr_read_b32 v154, a106
    v_accvgpr_read_b32 v155, a107
    v_accvgpr_read_b32 v156, a120
    v_accvgpr_read_b32 v157, a121
    v_accvgpr_read_b32 v158, a122
    v_accvgpr_read_b32 v159, a123
    v_mul_f32 v152, v152, v58
    v_mul_f32 v153, v153, v58
    v_mul_f32 v154, v154, v58
    v_mul_f32 v155, v155, v58
    v_mul_f32 v156, v156, v58
    v_mul_f32 v157, v157, v58
    v_mul_f32 v158, v158, v58
    v_mul_f32 v159, v159, v58
    v_cvt_pk_bf16_f32 v160, v152, v153
    v_cvt_pk_bf16_f32 v161, v154, v155
    v_cvt_pk_bf16_f32 v162, v156, v157
    v_cvt_pk_bf16_f32 v163, v158, v159
    buffer_store_dwordx4 v[160:163], v54, s[36:39], s60 offen offset:3072 sc1
    v_accvgpr_read_b32 v164, a108
    v_accvgpr_read_b32 v165, a109
    v_accvgpr_read_b32 v166, a110
    v_accvgpr_read_b32 v167, a111
    v_accvgpr_read_b32 v168, a124
    v_accvgpr_read_b32 v169, a125
    v_accvgpr_read_b32 v170, a126
    v_accvgpr_read_b32 v171, a127
    v_mul_f32 v164, v164, v59
    v_mul_f32 v165, v165, v59
    v_mul_f32 v166, v166, v59
    v_mul_f32 v167, v167, v59
    v_mul_f32 v168, v168, v59
    v_mul_f32 v169, v169, v59
    v_mul_f32 v170, v170, v59
    v_mul_f32 v171, v171, v59
    v_cvt_pk_bf16_f32 v172, v164, v165
    v_cvt_pk_bf16_f32 v173, v166, v167
    v_cvt_pk_bf16_f32 v174, v168, v169
    v_cvt_pk_bf16_f32 v175, v170, v171
    buffer_store_dwordx4 v[172:175], v54, s[36:39], s61 offen offset:3072 sc1
    s_lshl_b32 s98, s5, 7
    s_lshl_b32 s50, s4, 2
    s_add_u32 s98, s98, s50
    s_add_u32 s98, s98, 29368320
L_k1_codeend:
out_kernel:
    s_load_dwordx2 s[16:17], s[0:1], 0
    s_load_dwordx2 s[28:29], s[0:1], 32
    s_load_dwordx2 s[32:33], s[0:1], 64
    s_load_dwordx2 s[20:21], s[0:1], 72
    s_load_dwordx2 s[24:25], s[0:1], 88
    s_and_b32 s52, s2, 7
    s_lshr_b32 s4, s52, 1
    s_and_b32 s53, s52, 1
    s_lshr_b32 s54, s2, 3
    s_lshr_b32 s55, s54, 2
    s_lshl_b32 s53, s53, 3
    s_add_u32 s6, s53, s55
    s_and_b32 s7, s54, 3
    s_lshl_b32 s5, s6, 2
    s_add_u32 s5, s5, s7
    v_lshrrev_b32 v1, 6, v0
    v_and_b32 v2, 63, v0
    v_readfirstlane_b32 s3, v1
    v_and_b32 v3, 15, v2
    v_lshrrev_b32 v4, 4, v2
    v_lshlrev_b32 v20, 4, v2
    s_and_b32 s56, s3, 1
    s_lshr_b32 s57, s3, 1
    v_lshrrev_b32 v5, 2, v3
    v_and_b32 v6, 3, v3
    v_lshl_add_u32 v7, v4, 2, v5
    v_and_b32 v160, 7, v7
    v_lshlrev_b32 v160, 1, v160
    v_lshrrev_b32 v161, 1, v6
    s_lshl_b32 s58, s56, 3
    v_add_u32 v161, s58, v161
    v_and_b32 v162, 1, v6
    v_lshlrev_b32 v162, 3, v162
    v_lshl_add_u32 v162, v7, 8, v162
    v_add_u32 v163, 0, v161
    v_xor_b32 v163, v163, v160
    v_lshl_add_u32 v8, v163, 4, v162
    v_add_u32 v12, 0x10000, v8
    v_add_u32 v163, 2, v161
    v_xor_b32 v163, v163, v160
    v_lshl_add_u32 v9, v163, 4, v162
    v_add_u32 v13, 0x10000, v9
    v_add_u32 v163, 4, v161
    v_xor_b32 v163, v163, v160
    v_lshl_add_u32 v10, v163, 4, v162
    v_add_u32 v14, 0x10000, v10
    v_add_u32 v163, 6, v161
    v_xor_b32 v163, v163, v160
    v_lshl_add_u32 v11, v163, 4, v162
    v_add_u32 v15, 0x10000, v11
    s_lshl_b32 s58, s57, 13
    s_add_u32 s58, s58, 16384
    v_add_u32 v16, s58, v20
    v_add_u32 v17, 0x10000, v16
    s_lshl_b32 s58, s3, 14
    v_add_u32 v5, 0, v4
    v_lshlrev_b32 v5, 1, v5
    v_xor_b32 v5, v5, v3
    v_lshlrev_b32 v5, 4, v5
    v_lshl_add_u32 v5, v4, 10, v5
    v_add_u32 v18, s58, v5
    v_add_u32 v5, 4, v4
    v_lshlrev_b32 v5, 1, v5
    v_xor_b32 v5, v5, v3
    v_lshlrev_b32 v5, 4, v5
    v_lshl_add_u32 v5, v4, 10, v5
    v_add_u32 v19, s58, v5
    s_lshl_b32 s50, s3, 12
    s_lshl_b32 s51, s3, 12
    s_add_u32 s51, s51, 16384
    s_lshl_b32 s58, s6, 7
    s_lshl_b32 s59, s57, 6
    s_add_u32 s58, s58, s59
    s_lshl_b32 s59, s4, 4
    s_add_u32 s58, s58, s59
    s_lshl_b32 s58, s58, 10
    s_lshl_b32 s59, s7, 8
    s_add_u32 s58, s58, s59
    s_lshl_b32 s59, s56, 7
    s_add_u32 s63, s58, s59
    v_lshlrev_b32 v5, 10, v3
    v_lshl_add_u32 v21, v4, 3, v5
    s_mul_i32 s52, s4, 23
    s_cmp_eq_u32 s4, 3
    s_cselect_b32 s52, 5, s52
    s_add_u32 s53, s52, 18
    s_cmp_eq_u32 s4, 2
    s_cselect_b32 s53, 0, s53
    s_lshl_b32 s54, s6, 3
    s_lshl_b32 s55, s3, 1
    s_add_u32 s54, s54, s55
    s_cmp_lt_u32 s4, 3
    s_mov_b32 s59, 57344
    s_cmp_lt_u32 s4, 3
    s_cselect_b32 s55, 0x20000, s59
    s_cselect_b32 s60, 0, 1
    s_cmp_lt_u32 s4, 2
    s_cselect_b32 s56, 0x20000, s59
    s_cselect_b32 s61, 0, 1
    s_lshl_b32 s57, s7, 8
    s_lshl_b32 s44, s52, 16
    s_add_u32 s44, s44, s57
    s_lshl_b32 s47, s53, 16
    s_add_u32 s47, s47, s57
    s_mul_i32 s45, s54, s55
    s_lshl_b32 s58, s52, 11
    s_add_u32 s45, s45, s58
    s_add_u32 s46, s45, s55
    s_mul_i32 s48, s54, s56
    s_lshl_b32 s58, s53, 11
    s_add_u32 s48, s48, s58
    s_add_u32 s49, s48, s56
    s_waitcnt lgkmcnt(0)
    s_mov_b32 s30, 0x400000
    s_mov_b32 s31, 0x20000
    s_mov_b32 s34, 1835008
    s_mov_b32 s35, 0x20000
    s_mov_b32 s18, 0x200000
    s_mov_b32 s19, 0x20000
    s_mov_b32 s22, 0x200000
    s_mov_b32 s23, 0x20000
    s_add_u32 s36, s24, 16777216
    s_addc_u32 s37, s25, 0
    s_mov_b32 s38, 16777216
    s_mov_b32 s39, 0x20000
    s_add_u32 s40, s24, 4194304
    s_addc_u32 s41, s25, 0
    s_mov_b32 s42, 7340032
    s_mov_b32 s43, 0x20000
    s_add_u32 s24, s24, 33554432
    s_addc_u32 s25, s25, 0
    s_mov_b32 s26, 0x2000000
    s_mov_b32 s27, 0x20000
    s_mov_b32 s11, 0x20000
    s_mov_b32 s15, 0x20000
    s_cmp_eq_u32 s60, 0
    s_cselect_b32 s8, s28, s32
    s_cselect_b32 s12, s36, s40
    s_cselect_b32 s9, s29, s33
    s_cselect_b32 s13, s37, s41
    s_cselect_b32 s10, s30, s34
    s_cselect_b32 s14, s38, s42
    s_waitcnt vmcnt(0)
    s_barrier
    s_cmp_eq_u32 s3, 0
    s_cbranch_scc1 L_k2_wz
    s_add_u32 m0, s50, 0
    s_add_u32 s52, s44, 0
    buffer_load_dwordx4 v18, s[8:11], s52 offen offset:0 lds
    s_add_u32 s53, s44, 3072
    buffer_load_dwordx4 v19, s[8:11], s53 offen offset:1024 lds
    s_add_u32 s52, s44, 6144
    buffer_load_dwordx4 v18, s[8:11], s52 offen offset:2048 lds
    s_add_u32 s53, s44, 9216
    buffer_load_dwordx4 v19, s[8:11], s53 offen offset:3072 lds
    s_add_u32 m0, s50, 32768
    s_add_u32 s52, s44, 65536
    buffer_load_dwordx4 v18, s[8:11], s52 offen offset:0 lds
    s_add_u32 s53, s44, 68608
    buffer_load_dwordx4 v19, s[8:11], s53 offen offset:1024 lds
    s_add_u32 s52, s44, 71680
    buffer_load_dwordx4 v18, s[8:11], s52 offen offset:2048 lds
    s_add_u32 s53, s44, 74752
    buffer_load_dwordx4 v19, s[8:11], s53 offen offset:3072 lds
    s_add_u32 m0, s50, 65536
    s_add_u32 s52, s44, 131072
    buffer_load_dwordx4 v18, s[8:11], s52 offen offset:0 lds
    s_add_u32 s53, s44, 134144
    buffer_load_dwordx4 v19, s[8:11], s53 offen offset:1024 lds
    s_add_u32 s52, s44, 137216
    buffer_load_dwordx4 v18, s[8:11], s52 offen offset:2048 lds
    s_add_u32 s53, s44, 140288
    buffer_load_dwordx4 v19, s[8:11], s53 offen offset:3072 lds
    s_add_u32 m0, s50, 98304
    s_add_u32 s52, s44, 196608
    buffer_load_dwordx4 v18, s[8:11], s52 offen offset:0 lds
    s_add_u32 s53, s44, 199680
    buffer_load_dwordx4 v19, s[8:11], s53 offen offset:1024 lds
    s_add_u32 s52, s44, 202752
    buffer_load_dwordx4 v18, s[8:11], s52 offen offset:2048 lds
    s_add_u32 s53, s44, 205824
    buffer_load_dwordx4 v19, s[8:11], s53 offen offset:3072 lds
    s_lshl_b32 s52, s5, 18
    s_lshl_b32 s53, s5, 7
    s_add_u32 s53, s53, 29360128
    v_mov_b32 v1, 0
    buffer_load_dword v2, v1, s[24:27], s52 offen sc1
    buffer_load_dword v3, v1, s[24:27], s53 offen sc1
    buffer_load_dword v4, v1, s[16:19], s63 offen
    buffer_load_dword v5, v1, s[20:23], s63 offen sc1
    s_branch L_k2_rdy
L_k2_wz:
    v_mov_b32 v1, 0
    v_mov_b32 v2, 1
    v_and_b32 v3, 31, v0
    v_lshlrev_b32 v3, 2, v3
    s_mov_b64 exec, 1
    buffer_store_dword v2, v1, s[24:27], s98 offen sc1
    s_mov_b64 exec, -1
    s_lshr_b32 s52, s6, 1
    s_lshl_b32 s52, s52, 7
    s_add_u32 s52, s52, 29368320
    s_mov_b32 s55, 0
L_k2_opoll:
    buffer_load_dword v4, v3, s[24:27], s52 offen sc1
    s_waitcnt vmcnt(0)
    v_cmp_ne_u32 vcc, 1, v4
    s_nop 4
    s_cbranch_vccz L_k2_ogo
    s_sleep 1
    s_add_u32 s55, s55, 1
    s_cmp_lt_u32 s55, 0x80000
    s_cbranch_scc1 L_k2_opoll
L_k2_ogo:
    s_add_u32 m0, s50, 0
    s_add_u32 s52, s44, 0
    buffer_load_dwordx4 v18, s[8:11], s52 offen offset:0 lds
    s_add_u32 s53, s44, 3072
    buffer_load_dwordx4 v19, s[8:11], s53 offen offset:1024 lds
    s_add_u32 s52, s44, 6144
    buffer_load_dwordx4 v18, s[8:11], s52 offen offset:2048 lds
    s_add_u32 s53, s44, 9216
    buffer_load_dwordx4 v19, s[8:11], s53 offen offset:3072 lds
    s_add_u32 m0, s50, 32768
    s_add_u32 s52, s44, 65536
    buffer_load_dwordx4 v18, s[8:11], s52 offen offset:0 lds
    s_add_u32 s53, s44, 68608
    buffer_load_dwordx4 v19, s[8:11], s53 offen offset:1024 lds
    s_add_u32 s52, s44, 71680
    buffer_load_dwordx4 v18, s[8:11], s52 offen offset:2048 lds
    s_add_u32 s53, s44, 74752
    buffer_load_dwordx4 v19, s[8:11], s53 offen offset:3072 lds
    s_add_u32 m0, s50, 65536
    s_add_u32 s52, s44, 131072
    buffer_load_dwordx4 v18, s[8:11], s52 offen offset:0 lds
    s_add_u32 s53, s44, 134144
    buffer_load_dwordx4 v19, s[8:11], s53 offen offset:1024 lds
    s_add_u32 s52, s44, 137216
    buffer_load_dwordx4 v18, s[8:11], s52 offen offset:2048 lds
    s_add_u32 s53, s44, 140288
    buffer_load_dwordx4 v19, s[8:11], s53 offen offset:3072 lds
    s_add_u32 m0, s50, 98304
    s_add_u32 s52, s44, 196608
    buffer_load_dwordx4 v18, s[8:11], s52 offen offset:0 lds
    s_add_u32 s53, s44, 199680
    buffer_load_dwordx4 v19, s[8:11], s53 offen offset:1024 lds
    s_add_u32 s52, s44, 202752
    buffer_load_dwordx4 v18, s[8:11], s52 offen offset:2048 lds
    s_add_u32 s53, s44, 205824
    buffer_load_dwordx4 v19, s[8:11], s53 offen offset:3072 lds
    s_lshl_b32 s52, s5, 18
    s_lshl_b32 s53, s5, 7
    s_add_u32 s53, s53, 29360128
    v_mov_b32 v1, 0
    buffer_load_dword v2, v1, s[24:27], s52 offen sc1
    buffer_load_dword v3, v1, s[24:27], s53 offen sc1
    buffer_load_dword v4, v1, s[16:19], s63 offen
    buffer_load_dword v5, v1, s[20:23], s63 offen sc1
L_k2_rdy:
    s_barrier
    s_add_u32 m0, s51, 0
    s_add_u32 s54, s45, 0
    buffer_load_dwordx4 v20, s[12:15], s54 offen offset:0 sc1 lds
    buffer_load_dwordx4 v20, s[12:15], s54 offen offset:1024 sc1 lds
    s_add_u32 m0, s51, 2048
    s_add_u32 s55, s46, 0
    buffer_load_dwordx4 v20, s[12:15], s55 offen offset:0 sc1 lds
    buffer_load_dwordx4 v20, s[12:15], s55 offen offset:1024 sc1 lds
    s_add_u32 m0, s51, 32768
    s_add_u32 s54, s45, 2048
    buffer_load_dwordx4 v20, s[12:15], s54 offen offset:0 sc1 lds
    buffer_load_dwordx4 v20, s[12:15], s54 offen offset:1024 sc1 lds
    s_add_u32 m0, s51, 34816
    s_add_u32 s55, s46, 2048
    buffer_load_dwordx4 v20, s[12:15], s55 offen offset:0 sc1 lds
    buffer_load_dwordx4 v20, s[12:15], s55 offen offset:1024 sc1 lds
    s_add_u32 m0, s51, 65536
    s_add_u32 s54, s45, 4096
    buffer_load_dwordx4 v20, s[12:15], s54 offen offset:0 sc1 lds
    buffer_load_dwordx4 v20, s[12:15], s54 offen offset:1024 sc1 lds
    s_add_u32 m0, s51, 67584
    s_add_u32 s55, s46, 4096
    buffer_load_dwordx4 v20, s[12:15], s55 offen offset:0 sc1 lds
    buffer_load_dwordx4 v20, s[12:15], s55 offen offset:1024 sc1 lds
    s_add_u32 m0, s51, 98304
    s_add_u32 s54, s45, 6144
    buffer_load_dwordx4 v20, s[12:15], s54 offen offset:0 sc1 lds
    buffer_load_dwordx4 v20, s[12:15], s54 offen offset:1024 sc1 lds
    s_add_u32 m0, s51, 100352
    s_add_u32 s55, s46, 6144
    buffer_load_dwordx4 v20, s[12:15], s55 offen offset:0 sc1 lds
    buffer_load_dwordx4 v20, s[12:15], s55 offen offset:1024 sc1 lds
    s_waitcnt vmcnt(12)
    s_barrier
    ds_read_b64_tr_b16 v[32:33], v8 offset:0
    ds_read_b64_tr_b16 v[34:35], v8 offset:4096
    ds_read_b128 v[96:99], v16 offset:0
    ds_read_b64_tr_b16 v[36:37], v8 offset:8192
    ds_read_b64_tr_b16 v[38:39], v8 offset:12288
    ds_read_b128 v[100:103], v16 offset:1024
    ds_read_b64_tr_b16 v[40:41], v9 offset:0
    ds_read_b64_tr_b16 v[42:43], v9 offset:4096
    ds_read_b128 v[104:107], v16 offset:2048
    ds_read_b64_tr_b16 v[44:45], v9 offset:8192
    ds_read_b64_tr_b16 v[46:47], v9 offset:12288
    ds_read_b128 v[108:111], v16 offset:3072
    ds_read_b64_tr_b16 v[48:49], v10 offset:0
    ds_read_b64_tr_b16 v[50:51], v10 offset:4096
    ds_read_b128 v[112:115], v16 offset:4096
    ds_read_b64_tr_b16 v[52:53], v10 offset:8192
    ds_read_b64_tr_b16 v[54:55], v10 offset:12288
    ds_read_b128 v[116:119], v16 offset:5120
    ds_read_b64_tr_b16 v[56:57], v11 offset:0
    ds_read_b64_tr_b16 v[58:59], v11 offset:4096
    ds_read_b128 v[120:123], v16 offset:6144
    ds_read_b64_tr_b16 v[60:61], v11 offset:8192
    ds_read_b64_tr_b16 v[62:63], v11 offset:12288
    ds_read_b128 v[124:127], v16 offset:7168
    s_waitcnt vmcnt(8) lgkmcnt(0)
    s_barrier
    s_lshl_b32 s52, s5, 18
    s_lshl_b32 s53, s4, 14
    s_add_u32 s52, s52, s53
    s_lshl_b32 s53, s3, 11
    s_add_u32 s62, s52, s53
    v_mfma_f32_16x16x32_bf16 a[0:3], v[32:35], v[96:99], 0
    ds_read_b64_tr_b16 v[64:65], v8 offset:32768
    v_mfma_f32_16x16x32_bf16 a[0:3], v[36:39], v[100:103], a[0:3]
    ds_read_b64_tr_b16 v[66:67], v8 offset:36864
    v_mfma_f32_16x16x32_bf16 a[4:7], v[32:35], v[104:107], 0
    ds_read_b128 v[128:131], v16 offset:32768
    v_mfma_f32_16x16x32_bf16 a[4:7], v[36:39], v[108:111], a[4:7]
    s_add_u32 m0, s50, 0
    s_add_u32 s52, s44, 262144
    buffer_load_dwordx4 v18, s[8:11], s52 offen offset:0 lds
    v_mfma_f32_16x16x32_bf16 a[8:11], v[32:35], v[112:115], 0
    ds_read_b64_tr_b16 v[68:69], v8 offset:40960
    v_mfma_f32_16x16x32_bf16 a[8:11], v[36:39], v[116:119], a[8:11]
    ds_read_b64_tr_b16 v[70:71], v8 offset:45056
    v_mfma_f32_16x16x32_bf16 a[12:15], v[32:35], v[120:123], 0
    ds_read_b128 v[132:135], v16 offset:33792
    v_mfma_f32_16x16x32_bf16 a[12:15], v[36:39], v[124:127], a[12:15]
    s_add_u32 s53, s44, 265216
    buffer_load_dwordx4 v19, s[8:11], s53 offen offset:1024 lds
    v_mfma_f32_16x16x32_bf16 a[16:19], v[40:43], v[96:99], 0
    ds_read_b64_tr_b16 v[72:73], v9 offset:32768
    v_mfma_f32_16x16x32_bf16 a[16:19], v[44:47], v[100:103], a[16:19]
    ds_read_b64_tr_b16 v[74:75], v9 offset:36864
    v_mfma_f32_16x16x32_bf16 a[20:23], v[40:43], v[104:107], 0
    ds_read_b128 v[136:139], v16 offset:34816
    v_mfma_f32_16x16x32_bf16 a[20:23], v[44:47], v[108:111], a[20:23]
    s_add_u32 s52, s44, 268288
    buffer_load_dwordx4 v18, s[8:11], s52 offen offset:2048 lds
    v_mfma_f32_16x16x32_bf16 a[24:27], v[40:43], v[112:115], 0
    ds_read_b64_tr_b16 v[76:77], v9 offset:40960
    v_mfma_f32_16x16x32_bf16 a[24:27], v[44:47], v[116:119], a[24:27]
    ds_read_b64_tr_b16 v[78:79], v9 offset:45056
    v_mfma_f32_16x16x32_bf16 a[28:31], v[40:43], v[120:123], 0
    ds_read_b128 v[140:143], v16 offset:35840
    v_mfma_f32_16x16x32_bf16 a[28:31], v[44:47], v[124:127], a[28:31]
    s_add_u32 s53, s44, 271360
    buffer_load_dwordx4 v19, s[8:11], s53 offen offset:3072 lds
    v_mfma_f32_16x16x32_bf16 a[32:35], v[48:51], v[96:99], 0
    ds_read_b64_tr_b16 v[80:81], v10 offset:32768
    v_mfma_f32_16x16x32_bf16 a[32:35], v[52:55], v[100:103], a[32:35]
    ds_read_b64_tr_b16 v[82:83], v10 offset:36864
    v_mfma_f32_16x16x32_bf16 a[36:39], v[48:51], v[104:107], 0
    ds_read_b128 v[144:147], v16 offset:36864
    v_mfma_f32_16x16x32_bf16 a[36:39], v[52:55], v[108:111], a[36:39]
    s_add_u32 m0, s51, 0
    s_add_u32 s54, s45, 8192
    buffer_load_dwordx4 v20, s[12:15], s54 offen offset:0 sc1 lds
    v_mfma_f32_16x16x32_bf16 a[40:43], v[48:51], v[112:115], 0
    ds_read_b64_tr_b16 v[84:85], v10 offset:40960
    v_mfma_f32_16x16x32_bf16 a[40:43], v[52:55], v[116:119], a[40:43]
    ds_read_b64_tr_b16 v[86:87], v10 offset:45056
    v_mfma_f32_16x16x32_bf16 a[44:47], v[48:51], v[120:123], 0
    ds_read_b128 v[148:151], v16 offset:37888
    v_mfma_f32_16x16x32_bf16 a[44:47], v[52:55], v[124:127], a[44:47]
    buffer_load_dwordx4 v20, s[12:15], s54 offen offset:1024 sc1 lds
    v_mfma_f32_16x16x32_bf16 a[48:51], v[56:59], v[96:99], 0
    ds_read_b64_tr_b16 v[88:89], v11 offset:32768
    v_mfma_f32_16x16x32_bf16 a[48:51], v[60:63], v[100:103], a[48:51]
    ds_read_b64_tr_b16 v[90:91], v11 offset:36864
    v_mfma_f32_16x16x32_bf16 a[52:55], v[56:59], v[104:107], 0
    ds_read_b128 v[152:155], v16 offset:38912
    v_mfma_f32_16x16x32_bf16 a[52:55], v[60:63], v[108:111], a[52:55]
    s_add_u32 m0, s51, 2048
    s_add_u32 s55, s46, 8192
    buffer_load_dwordx4 v20, s[12:15], s55 offen offset:0 sc1 lds
    v_mfma_f32_16x16x32_bf16 a[56:59], v[56:59], v[112:115], 0
    ds_read_b64_tr_b16 v[92:93], v11 offset:40960
    v_mfma_f32_16x16x32_bf16 a[56:59], v[60:63], v[116:119], a[56:59]
    buffer_load_dwordx4 v20, s[12:15], s55 offen offset:1024 sc1 lds
    v_mfma_f32_16x16x32_bf16 a[60:63], v[56:59], v[120:123], 0
    ds_read_b64_tr_b16 v[94:95], v11 offset:45056
    v_mfma_f32_16x16x32_bf16 a[60:63], v[60:63], v[124:127], a[60:63]
    ds_read_b128 v[156:159], v16 offset:39936
    s_waitcnt vmcnt(12) lgkmcnt(0)
    s_barrier
    v_mfma_f32_16x16x32_bf16 a[0:3], v[64:67], v[128:131], a[0:3]
    ds_read_b64_tr_b16 v[32:33], v12 offset:0
    v_mfma_f32_16x16x32_bf16 a[0:3], v[68:71], v[132:135], a[0:3]
    ds_read_b64_tr_b16 v[34:35], v12 offset:4096
    v_mfma_f32_16x16x32_bf16 a[4:7], v[64:67], v[136:139], a[4:7]
    ds_read_b128 v[96:99], v17 offset:0
    v_mfma_f32_16x16x32_bf16 a[4:7], v[68:71], v[140:143], a[4:7]
    s_add_u32 m0, s50, 32768
    s_add_u32 s52, s44, 327680
    buffer_load_dwordx4 v18, s[8:11], s52 offen offset:0 lds
    v_mfma_f32_16x16x32_bf16 a[8:11], v[64:67], v[144:147], a[8:11]
    ds_read_b64_tr_b16 v[36:37], v12 offset:8192
    v_mfma_f32_16x16x32_bf16 a[8:11], v[68:71], v[148:151], a[8:11]
    ds_read_b64_tr_b16 v[38:39], v12 offset:12288
    v_mfma_f32_16x16x32_bf16 a[12:15], v[64:67], v[152:155], a[12:15]
    ds_read_b128 v[100:103], v17 offset:1024
    v_mfma_f32_16x16x32_bf16 a[12:15], v[68:71], v[156:159], a[12:15]
    s_add_u32 s53, s44, 330752
    buffer_load_dwordx4 v19, s[8:11], s53 offen offset:1024 lds
    v_mfma_f32_16x16x32_bf16 a[16:19], v[72:75], v[128:131], a[16:19]
    ds_read_b64_tr_b16 v[40:41], v13 offset:0
    v_mfma_f32_16x16x32_bf16 a[16:19], v[76:79], v[132:135], a[16:19]
    ds_read_b64_tr_b16 v[42:43], v13 offset:4096
    v_mfma_f32_16x16x32_bf16 a[20:23], v[72:75], v[136:139], a[20:23]
    ds_read_b128 v[104:107], v17 offset:2048
    v_mfma_f32_16x16x32_bf16 a[20:23], v[76:79], v[140:143], a[20:23]
    s_add_u32 s52, s44, 333824
    buffer_load_dwordx4 v18, s[8:11], s52 offen offset:2048 lds
    v_mfma_f32_16x16x32_bf16 a[24:27], v[72:75], v[144:147], a[24:27]
    ds_read_b64_tr_b16 v[44:45], v13 offset:8192
    v_mfma_f32_16x16x32_bf16 a[24:27], v[76:79], v[148:151], a[24:27]
    ds_read_b64_tr_b16 v[46:47], v13 offset:12288
    v_mfma_f32_16x16x32_bf16 a[28:31], v[72:75], v[152:155], a[28:31]
    ds_read_b128 v[108:111], v17 offset:3072
    v_mfma_f32_16x16x32_bf16 a[28:31], v[76:79], v[156:159], a[28:31]
    s_add_u32 s53, s44, 336896
    buffer_load_dwordx4 v19, s[8:11], s53 offen offset:3072 lds
    v_mfma_f32_16x16x32_bf16 a[32:35], v[80:83], v[128:131], a[32:35]
    ds_read_b64_tr_b16 v[48:49], v14 offset:0
    v_mfma_f32_16x16x32_bf16 a[32:35], v[84:87], v[132:135], a[32:35]
    ds_read_b64_tr_b16 v[50:51], v14 offset:4096
    v_mfma_f32_16x16x32_bf16 a[36:39], v[80:83], v[136:139], a[36:39]
    ds_read_b128 v[112:115], v17 offset:4096
    v_mfma_f32_16x16x32_bf16 a[36:39], v[84:87], v[140:143], a[36:39]
    s_add_u32 m0, s51, 32768
    s_add_u32 s54, s45, 10240
    buffer_load_dwordx4 v20, s[12:15], s54 offen offset:0 sc1 lds
    v_mfma_f32_16x16x32_bf16 a[40:43], v[80:83], v[144:147], a[40:43]
    ds_read_b64_tr_b16 v[52:53], v14 offset:8192
    v_mfma_f32_16x16x32_bf16 a[40:43], v[84:87], v[148:151], a[40:43]
    ds_read_b64_tr_b16 v[54:55], v14 offset:12288
    v_mfma_f32_16x16x32_bf16 a[44:47], v[80:83], v[152:155], a[44:47]
    ds_read_b128 v[116:119], v17 offset:5120
    v_mfma_f32_16x16x32_bf16 a[44:47], v[84:87], v[156:159], a[44:47]
    buffer_load_dwordx4 v20, s[12:15], s54 offen offset:1024 sc1 lds
    v_mfma_f32_16x16x32_bf16 a[48:51], v[88:91], v[128:131], a[48:51]
    ds_read_b64_tr_b16 v[56:57], v15 offset:0
    v_mfma_f32_16x16x32_bf16 a[48:51], v[92:95], v[132:135], a[48:51]
    ds_read_b64_tr_b16 v[58:59], v15 offset:4096
    v_mfma_f32_16x16x32_bf16 a[52:55], v[88:91], v[136:139], a[52:55]
    ds_read_b128 v[120:123], v17 offset:6144
    v_mfma_f32_16x16x32_bf16 a[52:55], v[92:95], v[140:143], a[52:55]
    s_add_u32 m0, s51, 34816
    s_add_u32 s55, s46, 10240
    buffer_load_dwordx4 v20, s[12:15], s55 offen offset:0 sc1 lds
    v_mfma_f32_16x16x32_bf16 a[56:59], v[88:91], v[144:147], a[56:59]
    ds_read_b64_tr_b16 v[60:61], v15 offset:8192
    v_mfma_f32_16x16x32_bf16 a[56:59], v[92:95], v[148:151], a[56:59]
    buffer_load_dwordx4 v20, s[12:15], s55 offen offset:1024 sc1 lds
    v_mfma_f32_16x16x32_bf16 a[60:63], v[88:91], v[152:155], a[60:63]
    ds_read_b64_tr_b16 v[62:63], v15 offset:12288
    v_mfma_f32_16x16x32_bf16 a[60:63], v[92:95], v[156:159], a[60:63]
    ds_read_b128 v[124:127], v17 offset:7168
    s_waitcnt vmcnt(16) lgkmcnt(0)
    s_barrier
    v_mfma_f32_16x16x32_bf16 a[0:3], v[32:35], v[96:99], a[0:3]
    ds_read_b64_tr_b16 v[64:65], v12 offset:32768
    v_mfma_f32_16x16x32_bf16 a[0:3], v[36:39], v[100:103], a[0:3]
    ds_read_b64_tr_b16 v[66:67], v12 offset:36864
    v_mfma_f32_16x16x32_bf16 a[4:7], v[32:35], v[104:107], a[4:7]
    ds_read_b128 v[128:131], v17 offset:32768
    v_mfma_f32_16x16x32_bf16 a[4:7], v[36:39], v[108:111], a[4:7]
    s_add_u32 m0, s50, 65536
    s_add_u32 s52, s44, 393216
    buffer_load_dwordx4 v18, s[8:11], s52 offen offset:0 lds
    v_mfma_f32_16x16x32_bf16 a[8:11], v[32:35], v[112:115], a[8:11]
    ds_read_b64_tr_b16 v[68:69], v12 offset:40960
    v_mfma_f32_16x16x32_bf16 a[8:11], v[36:39], v[116:119], a[8:11]
    ds_read_b64_tr_b16 v[70:71], v12 offset:45056
    v_mfma_f32_16x16x32_bf16 a[12:15], v[32:35], v[120:123], a[12:15]
    ds_read_b128 v[132:135], v17 offset:33792
    v_mfma_f32_16x16x32_bf16 a[12:15], v[36:39], v[124:127], a[12:15]
    s_add_u32 s53, s44, 396288
    buffer_load_dwordx4 v19, s[8:11], s53 offen offset:1024 lds
    v_mfma_f32_16x16x32_bf16 a[16:19], v[40:43], v[96:99], a[16:19]
    ds_read_b64_tr_b16 v[72:73], v13 offset:32768
    v_mfma_f32_16x16x32_bf16 a[16:19], v[44:47], v[100:103], a[16:19]
    ds_read_b64_tr_b16 v[74:75], v13 offset:36864
    v_mfma_f32_16x16x32_bf16 a[20:23], v[40:43], v[104:107], a[20:23]
    ds_read_b128 v[136:139], v17 offset:34816
    v_mfma_f32_16x16x32_bf16 a[20:23], v[44:47], v[108:111], a[20:23]
    s_add_u32 s52, s44, 399360
    buffer_load_dwordx4 v18, s[8:11], s52 offen offset:2048 lds
    v_mfma_f32_16x16x32_bf16 a[24:27], v[40:43], v[112:115], a[24:27]
    ds_read_b64_tr_b16 v[76:77], v13 offset:40960
    v_mfma_f32_16x16x32_bf16 a[24:27], v[44:47], v[116:119], a[24:27]
    ds_read_b64_tr_b16 v[78:79], v13 offset:45056
    v_mfma_f32_16x16x32_bf16 a[28:31], v[40:43], v[120:123], a[28:31]
    ds_read_b128 v[140:143], v17 offset:35840
    v_mfma_f32_16x16x32_bf16 a[28:31], v[44:47], v[124:127], a[28:31]
    s_add_u32 s53, s44, 402432
    buffer_load_dwordx4 v19, s[8:11], s53 offen offset:3072 lds
    v_mfma_f32_16x16x32_bf16 a[32:35], v[48:51], v[96:99], a[32:35]
    ds_read_b64_tr_b16 v[80:81], v14 offset:32768
    v_mfma_f32_16x16x32_bf16 a[32:35], v[52:55], v[100:103], a[32:35]
    ds_read_b64_tr_b16 v[82:83], v14 offset:36864
    v_mfma_f32_16x16x32_bf16 a[36:39], v[48:51], v[104:107], a[36:39]
    ds_read_b128 v[144:147], v17 offset:36864
    v_mfma_f32_16x16x32_bf16 a[36:39], v[52:55], v[108:111], a[36:39]
    s_add_u32 m0, s51, 65536
    s_add_u32 s54, s45, 12288
    buffer_load_dwordx4 v20, s[12:15], s54 offen offset:0 sc1 lds
    v_mfma_f32_16x16x32_bf16 a[40:43], v[48:51], v[112:115], a[40:43]
    ds_read_b64_tr_b16 v[84:85], v14 offset:40960
    v_mfma_f32_16x16x32_bf16 a[40:43], v[52:55], v[116:119], a[40:43]
    ds_read_b64_tr_b16 v[86:87], v14 offset:45056
    v_mfma_f32_16x16x32_bf16 a[44:47], v[48:51], v[120:123], a[44:47]
    ds_read_b128 v[148:151], v17 offset:37888
    v_mfma_f32_16x16x32_bf16 a[44:47], v[52:55], v[124:127], a[44:47]
    buffer_load_dwordx4 v20, s[12:15], s54 offen offset:1024 sc1 lds
    v_mfma_f32_16x16x32_bf16 a[48:51], v[56:59], v[96:99], a[48:51]
    ds_read_b64_tr_b16 v[88:89], v15 offset:32768
    v_mfma_f32_16x16x32_bf16 a[48:51], v[60:63], v[100:103], a[48:51]
    ds_read_b64_tr_b16 v[90:91], v15 offset:36864
    v_mfma_f32_16x16x32_bf16 a[52:55], v[56:59], v[104:107], a[52:55]
    ds_read_b128 v[152:155], v17 offset:38912
    v_mfma_f32_16x16x32_bf16 a[52:55], v[60:63], v[108:111], a[52:55]
    s_add_u32 m0, s51, 67584
    s_add_u32 s55, s46, 12288
    buffer_load_dwordx4 v20, s[12:15], s55 offen offset:0 sc1 lds
    v_mfma_f32_16x16x32_bf16 a[56:59], v[56:59], v[112:115], a[56:59]
    ds_read_b64_tr_b16 v[92:93], v15 offset:40960
    v_mfma_f32_16x16x32_bf16 a[56:59], v[60:63], v[116:119], a[56:59]
    buffer_load_dwordx4 v20, s[12:15], s55 offen offset:1024 sc1 lds
    v_mfma_f32_16x16x32_bf16 a[60:63], v[56:59], v[120:123], a[60:63]
    ds_read_b64_tr_b16 v[94:95], v15 offset:45056
    v_mfma_f32_16x16x32_bf16 a[60:63], v[60:63], v[124:127], a[60:63]
    ds_read_b128 v[156:159], v17 offset:39936
    s_waitcnt vmcnt(16) lgkmcnt(0)
    s_barrier
    v_mfma_f32_16x16x32_bf16 a[0:3], v[64:67], v[128:131], a[0:3]
    ds_read_b64_tr_b16 v[32:33], v8 offset:0
    v_mfma_f32_16x16x32_bf16 a[0:3], v[68:71], v[132:135], a[0:3]
    ds_read_b64_tr_b16 v[34:35], v8 offset:4096
    v_mfma_f32_16x16x32_bf16 a[4:7], v[64:67], v[136:139], a[4:7]
    ds_read_b128 v[96:99], v16 offset:0
    v_mfma_f32_16x16x32_bf16 a[4:7], v[68:71], v[140:143], a[4:7]
    s_add_u32 m0, s50, 98304
    s_add_u32 s52, s44, 458752
    buffer_load_dwordx4 v18, s[8:11], s52 offen offset:0 lds
    v_mfma_f32_16x16x32_bf16 a[8:11], v[64:67], v[144:147], a[8:11]
    ds_read_b64_tr_b16 v[36:37], v8 offset:8192
    v_mfma_f32_16x16x32_bf16 a[8:11], v[68:71], v[148:151], a[8:11]
    ds_read_b64_tr_b16 v[38:39], v8 offset:12288
    v_mfma_f32_16x16x32_bf16 a[12:15], v[64:67], v[152:155], a[12:15]
    ds_read_b128 v[100:103], v16 offset:1024
    v_mfma_f32_16x16x32_bf16 a[12:15], v[68:71], v[156:159], a[12:15]
    s_add_u32 s53, s44, 461824
    buffer_load_dwordx4 v19, s[8:11], s53 offen offset:1024 lds
    v_mfma_f32_16x16x32_bf16 a[16:19], v[72:75], v[128:131], a[16:19]
    ds_read_b64_tr_b16 v[40:41], v9 offset:0
    v_mfma_f32_16x16x32_bf16 a[16:19], v[76:79], v[132:135], a[16:19]
    ds_read_b64_tr_b16 v[42:43], v9 offset:4096
    v_mfma_f32_16x16x32_bf16 a[20:23], v[72:75], v[136:139], a[20:23]
    ds_read_b128 v[104:107], v16 offset:2048
    v_mfma_f32_16x16x32_bf16 a[20:23], v[76:79], v[140:143], a[20:23]
    s_add_u32 s52, s44, 464896
    buffer_load_dwordx4 v18, s[8:11], s52 offen offset:2048 lds
    v_mfma_f32_16x16x32_bf16 a[24:27], v[72:75], v[144:147], a[24:27]
    ds_read_b64_tr_b16 v[44:45], v9 offset:8192
    v_mfma_f32_16x16x32_bf16 a[24:27], v[76:79], v[148:151], a[24:27]
    ds_read_b64_tr_b16 v[46:47], v9 offset:12288
    v_mfma_f32_16x16x32_bf16 a[28:31], v[72:75], v[152:155], a[28:31]
    ds_read_b128 v[108:111], v16 offset:3072
    v_mfma_f32_16x16x32_bf16 a[28:31], v[76:79], v[156:159], a[28:31]
    s_add_u32 s53, s44, 467968
    buffer_load_dwordx4 v19, s[8:11], s53 offen offset:3072 lds
    v_mfma_f32_16x16x32_bf16 a[32:35], v[80:83], v[128:131], a[32:35]
    ds_read_b64_tr_b16 v[48:49], v10 offset:0
    v_mfma_f32_16x16x32_bf16 a[32:35], v[84:87], v[132:135], a[32:35]
    ds_read_b64_tr_b16 v[50:51], v10 offset:4096
    v_mfma_f32_16x16x32_bf16 a[36:39], v[80:83], v[136:139], a[36:39]
    ds_read_b128 v[112:115], v16 offset:4096
    v_mfma_f32_16x16x32_bf16 a[36:39], v[84:87], v[140:143], a[36:39]
    s_add_u32 m0, s51, 98304
    s_add_u32 s54, s45, 14336
    buffer_load_dwordx4 v20, s[12:15], s54 offen offset:0 sc1 lds
    v_mfma_f32_16x16x32_bf16 a[40:43], v[80:83], v[144:147], a[40:43]
    ds_read_b64_tr_b16 v[52:53], v10 offset:8192
    v_mfma_f32_16x16x32_bf16 a[40:43], v[84:87], v[148:151], a[40:43]
    ds_read_b64_tr_b16 v[54:55], v10 offset:12288
    v_mfma_f32_16x16x32_bf16 a[44:47], v[80:83], v[152:155], a[44:47]
    ds_read_b128 v[116:119], v16 offset:5120
    v_mfma_f32_16x16x32_bf16 a[44:47], v[84:87], v[156:159], a[44:47]
    buffer_load_dwordx4 v20, s[12:15], s54 offen offset:1024 sc1 lds
    v_mfma_f32_16x16x32_bf16 a[48:51], v[88:91], v[128:131], a[48:51]
    ds_read_b64_tr_b16 v[56:57], v11 offset:0
    v_mfma_f32_16x16x32_bf16 a[48:51], v[92:95], v[132:135], a[48:51]
    ds_read_b64_tr_b16 v[58:59], v11 offset:4096
    v_mfma_f32_16x16x32_bf16 a[52:55], v[88:91], v[136:139], a[52:55]
    ds_read_b128 v[120:123], v16 offset:6144
    v_mfma_f32_16x16x32_bf16 a[52:55], v[92:95], v[140:143], a[52:55]
    s_add_u32 m0, s51, 100352
    s_add_u32 s55, s46, 14336
    buffer_load_dwordx4 v20, s[12:15], s55 offen offset:0 sc1 lds
    v_mfma_f32_16x16x32_bf16 a[56:59], v[88:91], v[144:147], a[56:59]
    ds_read_b64_tr_b16 v[60:61], v11 offset:8192
    v_mfma_f32_16x16x32_bf16 a[56:59], v[92:95], v[148:151], a[56:59]
    buffer_load_dwordx4 v20, s[12:15], s55 offen offset:1024 sc1 lds
    v_mfma_f32_16x16x32_bf16 a[60:63], v[88:91], v[152:155], a[60:63]
    ds_read_b64_tr_b16 v[62:63], v11 offset:12288
    v_mfma_f32_16x16x32_bf16 a[60:63], v[92:95], v[156:159], a[60:63]
    ds_read_b128 v[124:127], v16 offset:7168
    s_waitcnt vmcnt(16) lgkmcnt(0)
    s_barrier
    v_mfma_f32_16x16x32_bf16 a[0:3], v[32:35], v[96:99], a[0:3]
    ds_read_b64_tr_b16 v[64:65], v8 offset:32768
    v_mfma_f32_16x16x32_bf16 a[0:3], v[36:39], v[100:103], a[0:3]
    ds_read_b64_tr_b16 v[66:67], v8 offset:36864
    v_mfma_f32_16x16x32_bf16 a[4:7], v[32:35], v[104:107], a[4:7]
    ds_read_b128 v[128:131], v16 offset:32768
    v_mfma_f32_16x16x32_bf16 a[4:7], v[36:39], v[108:111], a[4:7]
    s_add_u32 m0, s50, 0
    s_add_u32 s52, s44, 524288
    buffer_load_dwordx4 v18, s[8:11], s52 offen offset:0 lds
    v_mfma_f32_16x16x32_bf16 a[8:11], v[32:35], v[112:115], a[8:11]
    ds_read_b64_tr_b16 v[68:69], v8 offset:40960
    v_mfma_f32_16x16x32_bf16 a[8:11], v[36:39], v[116:119], a[8:11]
    ds_read_b64_tr_b16 v[70:71], v8 offset:45056
    v_mfma_f32_16x16x32_bf16 a[12:15], v[32:35], v[120:123], a[12:15]
    ds_read_b128 v[132:135], v16 offset:33792
    v_mfma_f32_16x16x32_bf16 a[12:15], v[36:39], v[124:127], a[12:15]
    s_add_u32 s53, s44, 527360
    buffer_load_dwordx4 v19, s[8:11], s53 offen offset:1024 lds
    v_mfma_f32_16x16x32_bf16 a[16:19], v[40:43], v[96:99], a[16:19]
    ds_read_b64_tr_b16 v[72:73], v9 offset:32768
    v_mfma_f32_16x16x32_bf16 a[16:19], v[44:47], v[100:103], a[16:19]
    ds_read_b64_tr_b16 v[74:75], v9 offset:36864
    v_mfma_f32_16x16x32_bf16 a[20:23], v[40:43], v[104:107], a[20:23]
    ds_read_b128 v[136:139], v16 offset:34816
    v_mfma_f32_16x16x32_bf16 a[20:23], v[44:47], v[108:111], a[20:23]
    s_add_u32 s52, s44, 530432
    buffer_load_dwordx4 v18, s[8:11], s52 offen offset:2048 lds
    v_mfma_f32_16x16x32_bf16 a[24:27], v[40:43], v[112:115], a[24:27]
    ds_read_b64_tr_b16 v[76:77], v9 offset:40960
    v_mfma_f32_16x16x32_bf16 a[24:27], v[44:47], v[116:119], a[24:27]
    ds_read_b64_tr_b16 v[78:79], v9 offset:45056
    v_mfma_f32_16x16x32_bf16 a[28:31], v[40:43], v[120:123], a[28:31]
    ds_read_b128 v[140:143], v16 offset:35840
    v_mfma_f32_16x16x32_bf16 a[28:31], v[44:47], v[124:127], a[28:31]
    s_add_u32 s53, s44, 533504
    buffer_load_dwordx4 v19, s[8:11], s53 offen offset:3072 lds
    v_mfma_f32_16x16x32_bf16 a[32:35], v[48:51], v[96:99], a[32:35]
    ds_read_b64_tr_b16 v[80:81], v10 offset:32768
    v_mfma_f32_16x16x32_bf16 a[32:35], v[52:55], v[100:103], a[32:35]
    ds_read_b64_tr_b16 v[82:83], v10 offset:36864
    v_mfma_f32_16x16x32_bf16 a[36:39], v[48:51], v[104:107], a[36:39]
    ds_read_b128 v[144:147], v16 offset:36864
    v_mfma_f32_16x16x32_bf16 a[36:39], v[52:55], v[108:111], a[36:39]
    s_add_u32 m0, s51, 0
    s_add_u32 s54, s45, 16384
    buffer_load_dwordx4 v20, s[12:15], s54 offen offset:0 sc1 lds
    v_mfma_f32_16x16x32_bf16 a[40:43], v[48:51], v[112:115], a[40:43]
    ds_read_b64_tr_b16 v[84:85], v10 offset:40960
    v_mfma_f32_16x16x32_bf16 a[40:43], v[52:55], v[116:119], a[40:43]
    ds_read_b64_tr_b16 v[86:87], v10 offset:45056
    v_mfma_f32_16x16x32_bf16 a[44:47], v[48:51], v[120:123], a[44:47]
    ds_read_b128 v[148:151], v16 offset:37888
    v_mfma_f32_16x16x32_bf16 a[44:47], v[52:55], v[124:127], a[44:47]
    buffer_load_dwordx4 v20, s[12:15], s54 offen offset:1024 sc1 lds
    v_mfma_f32_16x16x32_bf16 a[48:51], v[56:59], v[96:99], a[48:51]
    ds_read_b64_tr_b16 v[88:89], v11 offset:32768
    v_mfma_f32_16x16x32_bf16 a[48:51], v[60:63], v[100:103], a[48:51]
    ds_read_b64_tr_b16 v[90:91], v11 offset:36864
    v_mfma_f32_16x16x32_bf16 a[52:55], v[56:59], v[104:107], a[52:55]
    ds_read_b128 v[152:155], v16 offset:38912
    v_mfma_f32_16x16x32_bf16 a[52:55], v[60:63], v[108:111], a[52:55]
    s_add_u32 m0, s51, 2048
    s_add_u32 s55, s46, 16384
    buffer_load_dwordx4 v20, s[12:15], s55 offen offset:0 sc1 lds
    v_mfma_f32_16x16x32_bf16 a[56:59], v[56:59], v[112:115], a[56:59]
    ds_read_b64_tr_b16 v[92:93], v11 offset:40960
    v_mfma_f32_16x16x32_bf16 a[56:59], v[60:63], v[116:119], a[56:59]
    buffer_load_dwordx4 v20, s[12:15], s55 offen offset:1024 sc1 lds
    v_mfma_f32_16x16x32_bf16 a[60:63], v[56:59], v[120:123], a[60:63]
    ds_read_b64_tr_b16 v[94:95], v11 offset:45056
    v_mfma_f32_16x16x32_bf16 a[60:63], v[60:63], v[124:127], a[60:63]
    ds_read_b128 v[156:159], v16 offset:39936
    s_waitcnt vmcnt(16) lgkmcnt(0)
    s_barrier
    v_mfma_f32_16x16x32_bf16 a[0:3], v[64:67], v[128:131], a[0:3]
    ds_read_b64_tr_b16 v[32:33], v12 offset:0
    v_mfma_f32_16x16x32_bf16 a[0:3], v[68:71], v[132:135], a[0:3]
    ds_read_b64_tr_b16 v[34:35], v12 offset:4096
    v_mfma_f32_16x16x32_bf16 a[4:7], v[64:67], v[136:139], a[4:7]
    ds_read_b128 v[96:99], v17 offset:0
    v_mfma_f32_16x16x32_bf16 a[4:7], v[68:71], v[140:143], a[4:7]
    s_add_u32 m0, s50, 32768
    s_add_u32 s52, s44, 589824
    buffer_load_dwordx4 v18, s[8:11], s52 offen offset:0 lds
    v_mfma_f32_16x16x32_bf16 a[8:11], v[64:67], v[144:147], a[8:11]
    ds_read_b64_tr_b16 v[36:37], v12 offset:8192
    v_mfma_f32_16x16x32_bf16 a[8:11], v[68:71], v[148:151], a[8:11]
    ds_read_b64_tr_b16 v[38:39], v12 offset:12288
    v_mfma_f32_16x16x32_bf16 a[12:15], v[64:67], v[152:155], a[12:15]
    ds_read_b128 v[100:103], v17 offset:1024
    v_mfma_f32_16x16x32_bf16 a[12:15], v[68:71], v[156:159], a[12:15]
    s_add_u32 s53, s44, 592896
    buffer_load_dwordx4 v19, s[8:11], s53 offen offset:1024 lds
    v_mfma_f32_16x16x32_bf16 a[16:19], v[72:75], v[128:131], a[16:19]
    ds_read_b64_tr_b16 v[40:41], v13 offset:0
    v_mfma_f32_16x16x32_bf16 a[16:19], v[76:79], v[132:135], a[16:19]
    ds_read_b64_tr_b16 v[42:43], v13 offset:4096
    v_mfma_f32_16x16x32_bf16 a[20:23], v[72:75], v[136:139], a[20:23]
    ds_read_b128 v[104:107], v17 offset:2048
    v_mfma_f32_16x16x32_bf16 a[20:23], v[76:79], v[140:143], a[20:23]
    s_add_u32 s52, s44, 595968
    buffer_load_dwordx4 v18, s[8:11], s52 offen offset:2048 lds
    v_mfma_f32_16x16x32_bf16 a[24:27], v[72:75], v[144:147], a[24:27]
    ds_read_b64_tr_b16 v[44:45], v13 offset:8192
    v_mfma_f32_16x16x32_bf16 a[24:27], v[76:79], v[148:151], a[24:27]
    ds_read_b64_tr_b16 v[46:47], v13 offset:12288
    v_mfma_f32_16x16x32_bf16 a[28:31], v[72:75], v[152:155], a[28:31]
    ds_read_b128 v[108:111], v17 offset:3072
    v_mfma_f32_16x16x32_bf16 a[28:31], v[76:79], v[156:159], a[28:31]
    s_add_u32 s53, s44, 599040
    buffer_load_dwordx4 v19, s[8:11], s53 offen offset:3072 lds
    v_mfma_f32_16x16x32_bf16 a[32:35], v[80:83], v[128:131], a[32:35]
    ds_read_b64_tr_b16 v[48:49], v14 offset:0
    v_mfma_f32_16x16x32_bf16 a[32:35], v[84:87], v[132:135], a[32:35]
    ds_read_b64_tr_b16 v[50:51], v14 offset:4096
    v_mfma_f32_16x16x32_bf16 a[36:39], v[80:83], v[136:139], a[36:39]
    ds_read_b128 v[112:115], v17 offset:4096
    v_mfma_f32_16x16x32_bf16 a[36:39], v[84:87], v[140:143], a[36:39]
    s_add_u32 m0, s51, 32768
    s_add_u32 s54, s45, 18432
    buffer_load_dwordx4 v20, s[12:15], s54 offen offset:0 sc1 lds
    v_mfma_f32_16x16x32_bf16 a[40:43], v[80:83], v[144:147], a[40:43]
    ds_read_b64_tr_b16 v[52:53], v14 offset:8192
    v_mfma_f32_16x16x32_bf16 a[40:43], v[84:87], v[148:151], a[40:43]
    ds_read_b64_tr_b16 v[54:55], v14 offset:12288
    v_mfma_f32_16x16x32_bf16 a[44:47], v[80:83], v[152:155], a[44:47]
    ds_read_b128 v[116:119], v17 offset:5120
    v_mfma_f32_16x16x32_bf16 a[44:47], v[84:87], v[156:159], a[44:47]
    buffer_load_dwordx4 v20, s[12:15], s54 offen offset:1024 sc1 lds
    v_mfma_f32_16x16x32_bf16 a[48:51], v[88:91], v[128:131], a[48:51]
    ds_read_b64_tr_b16 v[56:57], v15 offset:0
    v_mfma_f32_16x16x32_bf16 a[48:51], v[92:95], v[132:135], a[48:51]
    ds_read_b64_tr_b16 v[58:59], v15 offset:4096
    v_mfma_f32_16x16x32_bf16 a[52:55], v[88:91], v[136:139], a[52:55]
    ds_read_b128 v[120:123], v17 offset:6144
    v_mfma_f32_16x16x32_bf16 a[52:55], v[92:95], v[140:143], a[52:55]
    s_add_u32 m0, s51, 34816
    s_add_u32 s55, s46, 18432
    buffer_load_dwordx4 v20, s[12:15], s55 offen offset:0 sc1 lds
    v_mfma_f32_16x16x32_bf16 a[56:59], v[88:91], v[144:147], a[56:59]
    ds_read_b64_tr_b16 v[60:61], v15 offset:8192
    v_mfma_f32_16x16x32_bf16 a[56:59], v[92:95], v[148:151], a[56:59]
    buffer_load_dwordx4 v20, s[12:15], s55 offen offset:1024 sc1 lds
    v_mfma_f32_16x16x32_bf16 a[60:63], v[88:91], v[152:155], a[60:63]
    ds_read_b64_tr_b16 v[62:63], v15 offset:12288
    v_mfma_f32_16x16x32_bf16 a[60:63], v[92:95], v[156:159], a[60:63]
    ds_read_b128 v[124:127], v17 offset:7168
    s_waitcnt vmcnt(16) lgkmcnt(0)
    s_barrier
    v_mfma_f32_16x16x32_bf16 a[0:3], v[32:35], v[96:99], a[0:3]
    ds_read_b64_tr_b16 v[64:65], v12 offset:32768
    v_mfma_f32_16x16x32_bf16 a[0:3], v[36:39], v[100:103], a[0:3]
    ds_read_b64_tr_b16 v[66:67], v12 offset:36864
    v_mfma_f32_16x16x32_bf16 a[4:7], v[32:35], v[104:107], a[4:7]
    ds_read_b128 v[128:131], v17 offset:32768
    v_mfma_f32_16x16x32_bf16 a[4:7], v[36:39], v[108:111], a[4:7]
    s_add_u32 m0, s50, 65536
    s_add_u32 s52, s44, 655360
    buffer_load_dwordx4 v18, s[8:11], s52 offen offset:0 lds
    v_mfma_f32_16x16x32_bf16 a[8:11], v[32:35], v[112:115], a[8:11]
    ds_read_b64_tr_b16 v[68:69], v12 offset:40960
    v_mfma_f32_16x16x32_bf16 a[8:11], v[36:39], v[116:119], a[8:11]
    ds_read_b64_tr_b16 v[70:71], v12 offset:45056
    v_mfma_f32_16x16x32_bf16 a[12:15], v[32:35], v[120:123], a[12:15]
    ds_read_b128 v[132:135], v17 offset:33792
    v_mfma_f32_16x16x32_bf16 a[12:15], v[36:39], v[124:127], a[12:15]
    s_add_u32 s53, s44, 658432
    buffer_load_dwordx4 v19, s[8:11], s53 offen offset:1024 lds
    v_mfma_f32_16x16x32_bf16 a[16:19], v[40:43], v[96:99], a[16:19]
    ds_read_b64_tr_b16 v[72:73], v13 offset:32768
    v_mfma_f32_16x16x32_bf16 a[16:19], v[44:47], v[100:103], a[16:19]
    ds_read_b64_tr_b16 v[74:75], v13 offset:36864
    v_mfma_f32_16x16x32_bf16 a[20:23], v[40:43], v[104:107], a[20:23]
    ds_read_b128 v[136:139], v17 offset:34816
    v_mfma_f32_16x16x32_bf16 a[20:23], v[44:47], v[108:111], a[20:23]
    s_add_u32 s52, s44, 661504
    buffer_load_dwordx4 v18, s[8:11], s52 offen offset:2048 lds
    v_mfma_f32_16x16x32_bf16 a[24:27], v[40:43], v[112:115], a[24:27]
    ds_read_b64_tr_b16 v[76:77], v13 offset:40960
    v_mfma_f32_16x16x32_bf16 a[24:27], v[44:47], v[116:119], a[24:27]
    ds_read_b64_tr_b16 v[78:79], v13 offset:45056
    v_mfma_f32_16x16x32_bf16 a[28:31], v[40:43], v[120:123], a[28:31]
    ds_read_b128 v[140:143], v17 offset:35840
    v_mfma_f32_16x16x32_bf16 a[28:31], v[44:47], v[124:127], a[28:31]
    s_add_u32 s53, s44, 664576
    buffer_load_dwordx4 v19, s[8:11], s53 offen offset:3072 lds
    v_mfma_f32_16x16x32_bf16 a[32:35], v[48:51], v[96:99], a[32:35]
    ds_read_b64_tr_b16 v[80:81], v14 offset:32768
    v_mfma_f32_16x16x32_bf16 a[32:35], v[52:55], v[100:103], a[32:35]
    ds_read_b64_tr_b16 v[82:83], v14 offset:36864
    v_mfma_f32_16x16x32_bf16 a[36:39], v[48:51], v[104:107], a[36:39]
    ds_read_b128 v[144:147], v17 offset:36864
    v_mfma_f32_16x16x32_bf16 a[36:39], v[52:55], v[108:111], a[36:39]
    s_add_u32 m0, s51, 65536
    s_add_u32 s54, s45, 20480
    buffer_load_dwordx4 v20, s[12:15], s54 offen offset:0 sc1 lds
    v_mfma_f32_16x16x32_bf16 a[40:43], v[48:51], v[112:115], a[40:43]
    ds_read_b64_tr_b16 v[84:85], v14 offset:40960
    v_mfma_f32_16x16x32_bf16 a[40:43], v[52:55], v[116:119], a[40:43]
    ds_read_b64_tr_b16 v[86:87], v14 offset:45056
    v_mfma_f32_16x16x32_bf16 a[44:47], v[48:51], v[120:123], a[44:47]
    ds_read_b128 v[148:151], v17 offset:37888
    v_mfma_f32_16x16x32_bf16 a[44:47], v[52:55], v[124:127], a[44:47]
    buffer_load_dwordx4 v20, s[12:15], s54 offen offset:1024 sc1 lds
    v_mfma_f32_16x16x32_bf16 a[48:51], v[56:59], v[96:99], a[48:51]
    ds_read_b64_tr_b16 v[88:89], v15 offset:32768
    v_mfma_f32_16x16x32_bf16 a[48:51], v[60:63], v[100:103], a[48:51]
    ds_read_b64_tr_b16 v[90:91], v15 offset:36864
    v_mfma_f32_16x16x32_bf16 a[52:55], v[56:59], v[104:107], a[52:55]
    ds_read_b128 v[152:155], v17 offset:38912
    v_mfma_f32_16x16x32_bf16 a[52:55], v[60:63], v[108:111], a[52:55]
    s_add_u32 m0, s51, 67584
    s_add_u32 s55, s46, 20480
    buffer_load_dwordx4 v20, s[12:15], s55 offen offset:0 sc1 lds
    v_mfma_f32_16x16x32_bf16 a[56:59], v[56:59], v[112:115], a[56:59]
    ds_read_b64_tr_b16 v[92:93], v15 offset:40960
    v_mfma_f32_16x16x32_bf16 a[56:59], v[60:63], v[116:119], a[56:59]
    buffer_load_dwordx4 v20, s[12:15], s55 offen offset:1024 sc1 lds
    v_mfma_f32_16x16x32_bf16 a[60:63], v[56:59], v[120:123], a[60:63]
    ds_read_b64_tr_b16 v[94:95], v15 offset:45056
    v_mfma_f32_16x16x32_bf16 a[60:63], v[60:63], v[124:127], a[60:63]
    ds_read_b128 v[156:159], v17 offset:39936
    s_waitcnt vmcnt(16) lgkmcnt(0)
    s_barrier
    v_mfma_f32_16x16x32_bf16 a[0:3], v[64:67], v[128:131], a[0:3]
    ds_read_b64_tr_b16 v[32:33], v8 offset:0
    v_mfma_f32_16x16x32_bf16 a[0:3], v[68:71], v[132:135], a[0:3]
    ds_read_b64_tr_b16 v[34:35], v8 offset:4096
    v_mfma_f32_16x16x32_bf16 a[4:7], v[64:67], v[136:139], a[4:7]
    ds_read_b128 v[96:99], v16 offset:0
    v_mfma_f32_16x16x32_bf16 a[4:7], v[68:71], v[140:143], a[4:7]
    s_add_u32 m0, s50, 98304
    s_add_u32 s52, s44, 720896
    buffer_load_dwordx4 v18, s[8:11], s52 offen offset:0 lds
    v_mfma_f32_16x16x32_bf16 a[8:11], v[64:67], v[144:147], a[8:11]
    ds_read_b64_tr_b16 v[36:37], v8 offset:8192
    v_mfma_f32_16x16x32_bf16 a[8:11], v[68:71], v[148:151], a[8:11]
    ds_read_b64_tr_b16 v[38:39], v8 offset:12288
    v_mfma_f32_16x16x32_bf16 a[12:15], v[64:67], v[152:155], a[12:15]
    ds_read_b128 v[100:103], v16 offset:1024
    v_mfma_f32_16x16x32_bf16 a[12:15], v[68:71], v[156:159], a[12:15]
    s_add_u32 s53, s44, 723968
    buffer_load_dwordx4 v19, s[8:11], s53 offen offset:1024 lds
    v_mfma_f32_16x16x32_bf16 a[16:19], v[72:75], v[128:131], a[16:19]
    ds_read_b64_tr_b16 v[40:41], v9 offset:0
    v_mfma_f32_16x16x32_bf16 a[16:19], v[76:79], v[132:135], a[16:19]
    ds_read_b64_tr_b16 v[42:43], v9 offset:4096
    v_mfma_f32_16x16x32_bf16 a[20:23], v[72:75], v[136:139], a[20:23]
    ds_read_b128 v[104:107], v16 offset:2048
    v_mfma_f32_16x16x32_bf16 a[20:23], v[76:79], v[140:143], a[20:23]
    s_add_u32 s52, s44, 727040
    buffer_load_dwordx4 v18, s[8:11], s52 offen offset:2048 lds
    v_mfma_f32_16x16x32_bf16 a[24:27], v[72:75], v[144:147], a[24:27]
    ds_read_b64_tr_b16 v[44:45], v9 offset:8192
    v_mfma_f32_16x16x32_bf16 a[24:27], v[76:79], v[148:151], a[24:27]
    ds_read_b64_tr_b16 v[46:47], v9 offset:12288
    v_mfma_f32_16x16x32_bf16 a[28:31], v[72:75], v[152:155], a[28:31]
    ds_read_b128 v[108:111], v16 offset:3072
    v_mfma_f32_16x16x32_bf16 a[28:31], v[76:79], v[156:159], a[28:31]
    s_add_u32 s53, s44, 730112
    buffer_load_dwordx4 v19, s[8:11], s53 offen offset:3072 lds
    v_mfma_f32_16x16x32_bf16 a[32:35], v[80:83], v[128:131], a[32:35]
    ds_read_b64_tr_b16 v[48:49], v10 offset:0
    v_mfma_f32_16x16x32_bf16 a[32:35], v[84:87], v[132:135], a[32:35]
    ds_read_b64_tr_b16 v[50:51], v10 offset:4096
    v_mfma_f32_16x16x32_bf16 a[36:39], v[80:83], v[136:139], a[36:39]
    ds_read_b128 v[112:115], v16 offset:4096
    v_mfma_f32_16x16x32_bf16 a[36:39], v[84:87], v[140:143], a[36:39]
    s_add_u32 m0, s51, 98304
    s_add_u32 s54, s45, 22528
    buffer_load_dwordx4 v20, s[12:15], s54 offen offset:0 sc1 lds
    v_mfma_f32_16x16x32_bf16 a[40:43], v[80:83], v[144:147], a[40:43]
    ds_read_b64_tr_b16 v[52:53], v10 offset:8192
    v_mfma_f32_16x16x32_bf16 a[40:43], v[84:87], v[148:151], a[40:43]
    ds_read_b64_tr_b16 v[54:55], v10 offset:12288
    v_mfma_f32_16x16x32_bf16 a[44:47], v[80:83], v[152:155], a[44:47]
    ds_read_b128 v[116:119], v16 offset:5120
    v_mfma_f32_16x16x32_bf16 a[44:47], v[84:87], v[156:159], a[44:47]
    buffer_load_dwordx4 v20, s[12:15], s54 offen offset:1024 sc1 lds
    v_mfma_f32_16x16x32_bf16 a[48:51], v[88:91], v[128:131], a[48:51]
    ds_read_b64_tr_b16 v[56:57], v11 offset:0
    v_mfma_f32_16x16x32_bf16 a[48:51], v[92:95], v[132:135], a[48:51]
    ds_read_b64_tr_b16 v[58:59], v11 offset:4096
    v_mfma_f32_16x16x32_bf16 a[52:55], v[88:91], v[136:139], a[52:55]
    ds_read_b128 v[120:123], v16 offset:6144
    v_mfma_f32_16x16x32_bf16 a[52:55], v[92:95], v[140:143], a[52:55]
    s_add_u32 m0, s51, 100352
    s_add_u32 s55, s46, 22528
    buffer_load_dwordx4 v20, s[12:15], s55 offen offset:0 sc1 lds
    v_mfma_f32_16x16x32_bf16 a[56:59], v[88:91], v[144:147], a[56:59]
    ds_read_b64_tr_b16 v[60:61], v11 offset:8192
    v_mfma_f32_16x16x32_bf16 a[56:59], v[92:95], v[148:151], a[56:59]
    buffer_load_dwordx4 v20, s[12:15], s55 offen offset:1024 sc1 lds
    v_mfma_f32_16x16x32_bf16 a[60:63], v[88:91], v[152:155], a[60:63]
    ds_read_b64_tr_b16 v[62:63], v11 offset:12288
    v_mfma_f32_16x16x32_bf16 a[60:63], v[92:95], v[156:159], a[60:63]
    ds_read_b128 v[124:127], v16 offset:7168
    s_waitcnt vmcnt(16) lgkmcnt(0)
    s_barrier
    v_mfma_f32_16x16x32_bf16 a[0:3], v[32:35], v[96:99], a[0:3]
    ds_read_b64_tr_b16 v[64:65], v8 offset:32768
    v_mfma_f32_16x16x32_bf16 a[0:3], v[36:39], v[100:103], a[0:3]
    ds_read_b64_tr_b16 v[66:67], v8 offset:36864
    v_mfma_f32_16x16x32_bf16 a[4:7], v[32:35], v[104:107], a[4:7]
    ds_read_b128 v[128:131], v16 offset:32768
    v_mfma_f32_16x16x32_bf16 a[4:7], v[36:39], v[108:111], a[4:7]
    s_add_u32 m0, s50, 0
    s_add_u32 s52, s44, 786432
    buffer_load_dwordx4 v18, s[8:11], s52 offen offset:0 lds
    v_mfma_f32_16x16x32_bf16 a[8:11], v[32:35], v[112:115], a[8:11]
    ds_read_b64_tr_b16 v[68:69], v8 offset:40960
    v_mfma_f32_16x16x32_bf16 a[8:11], v[36:39], v[116:119], a[8:11]
    ds_read_b64_tr_b16 v[70:71], v8 offset:45056
    v_mfma_f32_16x16x32_bf16 a[12:15], v[32:35], v[120:123], a[12:15]
    ds_read_b128 v[132:135], v16 offset:33792
    v_mfma_f32_16x16x32_bf16 a[12:15], v[36:39], v[124:127], a[12:15]
    s_add_u32 s53, s44, 789504
    buffer_load_dwordx4 v19, s[8:11], s53 offen offset:1024 lds
    v_mfma_f32_16x16x32_bf16 a[16:19], v[40:43], v[96:99], a[16:19]
    ds_read_b64_tr_b16 v[72:73], v9 offset:32768
    v_mfma_f32_16x16x32_bf16 a[16:19], v[44:47], v[100:103], a[16:19]
    ds_read_b64_tr_b16 v[74:75], v9 offset:36864
    v_mfma_f32_16x16x32_bf16 a[20:23], v[40:43], v[104:107], a[20:23]
    ds_read_b128 v[136:139], v16 offset:34816
    v_mfma_f32_16x16x32_bf16 a[20:23], v[44:47], v[108:111], a[20:23]
    s_add_u32 s52, s44, 792576
    buffer_load_dwordx4 v18, s[8:11], s52 offen offset:2048 lds
    v_mfma_f32_16x16x32_bf16 a[24:27], v[40:43], v[112:115], a[24:27]
    ds_read_b64_tr_b16 v[76:77], v9 offset:40960
    v_mfma_f32_16x16x32_bf16 a[24:27], v[44:47], v[116:119], a[24:27]
    ds_read_b64_tr_b16 v[78:79], v9 offset:45056
    v_mfma_f32_16x16x32_bf16 a[28:31], v[40:43], v[120:123], a[28:31]
    ds_read_b128 v[140:143], v16 offset:35840
    v_mfma_f32_16x16x32_bf16 a[28:31], v[44:47], v[124:127], a[28:31]
    s_add_u32 s53, s44, 795648
    buffer_load_dwordx4 v19, s[8:11], s53 offen offset:3072 lds
    v_mfma_f32_16x16x32_bf16 a[32:35], v[48:51], v[96:99], a[32:35]
    ds_read_b64_tr_b16 v[80:81], v10 offset:32768
    v_mfma_f32_16x16x32_bf16 a[32:35], v[52:55], v[100:103], a[32:35]
    ds_read_b64_tr_b16 v[82:83], v10 offset:36864
    v_mfma_f32_16x16x32_bf16 a[36:39], v[48:51], v[104:107], a[36:39]
    ds_read_b128 v[144:147], v16 offset:36864
    v_mfma_f32_16x16x32_bf16 a[36:39], v[52:55], v[108:111], a[36:39]
    s_add_u32 m0, s51, 0
    s_add_u32 s54, s45, 24576
    buffer_load_dwordx4 v20, s[12:15], s54 offen offset:0 sc1 lds
    v_mfma_f32_16x16x32_bf16 a[40:43], v[48:51], v[112:115], a[40:43]
    ds_read_b64_tr_b16 v[84:85], v10 offset:40960
    v_mfma_f32_16x16x32_bf16 a[40:43], v[52:55], v[116:119], a[40:43]
    ds_read_b64_tr_b16 v[86:87], v10 offset:45056
    v_mfma_f32_16x16x32_bf16 a[44:47], v[48:51], v[120:123], a[44:47]
    ds_read_b128 v[148:151], v16 offset:37888
    v_mfma_f32_16x16x32_bf16 a[44:47], v[52:55], v[124:127], a[44:47]
    buffer_load_dwordx4 v20, s[12:15], s54 offen offset:1024 sc1 lds
    v_mfma_f32_16x16x32_bf16 a[48:51], v[56:59], v[96:99], a[48:51]
    ds_read_b64_tr_b16 v[88:89], v11 offset:32768
    v_mfma_f32_16x16x32_bf16 a[48:51], v[60:63], v[100:103], a[48:51]
    ds_read_b64_tr_b16 v[90:91], v11 offset:36864
    v_mfma_f32_16x16x32_bf16 a[52:55], v[56:59], v[104:107], a[52:55]
    ds_read_b128 v[152:155], v16 offset:38912
    v_mfma_f32_16x16x32_bf16 a[52:55], v[60:63], v[108:111], a[52:55]
    s_add_u32 m0, s51, 2048
    s_add_u32 s55, s46, 24576
    buffer_load_dwordx4 v20, s[12:15], s55 offen offset:0 sc1 lds
    v_mfma_f32_16x16x32_bf16 a[56:59], v[56:59], v[112:115], a[56:59]
    ds_read_b64_tr_b16 v[92:93], v11 offset:40960
    v_mfma_f32_16x16x32_bf16 a[56:59], v[60:63], v[116:119], a[56:59]
    buffer_load_dwordx4 v20, s[12:15], s55 offen offset:1024 sc1 lds
    v_mfma_f32_16x16x32_bf16 a[60:63], v[56:59], v[120:123], a[60:63]
    ds_read_b64_tr_b16 v[94:95], v11 offset:45056
    v_mfma_f32_16x16x32_bf16 a[60:63], v[60:63], v[124:127], a[60:63]
    ds_read_b128 v[156:159], v16 offset:39936
    s_waitcnt vmcnt(16) lgkmcnt(0)
    s_barrier
    v_mfma_f32_16x16x32_bf16 a[0:3], v[64:67], v[128:131], a[0:3]
    ds_read_b64_tr_b16 v[32:33], v12 offset:0
    v_mfma_f32_16x16x32_bf16 a[0:3], v[68:71], v[132:135], a[0:3]
    ds_read_b64_tr_b16 v[34:35], v12 offset:4096
    v_mfma_f32_16x16x32_bf16 a[4:7], v[64:67], v[136:139], a[4:7]
    ds_read_b128 v[96:99], v17 offset:0
    v_mfma_f32_16x16x32_bf16 a[4:7], v[68:71], v[140:143], a[4:7]
    s_add_u32 m0, s50, 32768
    s_add_u32 s52, s44, 851968
    buffer_load_dwordx4 v18, s[8:11], s52 offen offset:0 lds
    v_mfma_f32_16x16x32_bf16 a[8:11], v[64:67], v[144:147], a[8:11]
    ds_read_b64_tr_b16 v[36:37], v12 offset:8192
    v_mfma_f32_16x16x32_bf16 a[8:11], v[68:71], v[148:151], a[8:11]
    ds_read_b64_tr_b16 v[38:39], v12 offset:12288
    v_mfma_f32_16x16x32_bf16 a[12:15], v[64:67], v[152:155], a[12:15]
    ds_read_b128 v[100:103], v17 offset:1024
    v_mfma_f32_16x16x32_bf16 a[12:15], v[68:71], v[156:159], a[12:15]
    s_add_u32 s53, s44, 855040
    buffer_load_dwordx4 v19, s[8:11], s53 offen offset:1024 lds
    v_mfma_f32_16x16x32_bf16 a[16:19], v[72:75], v[128:131], a[16:19]
    ds_read_b64_tr_b16 v[40:41], v13 offset:0
    v_mfma_f32_16x16x32_bf16 a[16:19], v[76:79], v[132:135], a[16:19]
    ds_read_b64_tr_b16 v[42:43], v13 offset:4096
    v_mfma_f32_16x16x32_bf16 a[20:23], v[72:75], v[136:139], a[20:23]
    ds_read_b128 v[104:107], v17 offset:2048
    v_mfma_f32_16x16x32_bf16 a[20:23], v[76:79], v[140:143], a[20:23]
    s_add_u32 s52, s44, 858112
    buffer_load_dwordx4 v18, s[8:11], s52 offen offset:2048 lds
    v_mfma_f32_16x16x32_bf16 a[24:27], v[72:75], v[144:147], a[24:27]
    ds_read_b64_tr_b16 v[44:45], v13 offset:8192
    v_mfma_f32_16x16x32_bf16 a[24:27], v[76:79], v[148:151], a[24:27]
    ds_read_b64_tr_b16 v[46:47], v13 offset:12288
    v_mfma_f32_16x16x32_bf16 a[28:31], v[72:75], v[152:155], a[28:31]
    ds_read_b128 v[108:111], v17 offset:3072
    v_mfma_f32_16x16x32_bf16 a[28:31], v[76:79], v[156:159], a[28:31]
    s_add_u32 s53, s44, 861184
    buffer_load_dwordx4 v19, s[8:11], s53 offen offset:3072 lds
    v_mfma_f32_16x16x32_bf16 a[32:35], v[80:83], v[128:131], a[32:35]
    ds_read_b64_tr_b16 v[48:49], v14 offset:0
    v_mfma_f32_16x16x32_bf16 a[32:35], v[84:87], v[132:135], a[32:35]
    ds_read_b64_tr_b16 v[50:51], v14 offset:4096
    v_mfma_f32_16x16x32_bf16 a[36:39], v[80:83], v[136:139], a[36:39]
    ds_read_b128 v[112:115], v17 offset:4096
    v_mfma_f32_16x16x32_bf16 a[36:39], v[84:87], v[140:143], a[36:39]
    s_add_u32 m0, s51, 32768
    s_add_u32 s54, s45, 26624
    buffer_load_dwordx4 v20, s[12:15], s54 offen offset:0 sc1 lds
    v_mfma_f32_16x16x32_bf16 a[40:43], v[80:83], v[144:147], a[40:43]
    ds_read_b64_tr_b16 v[52:53], v14 offset:8192
    v_mfma_f32_16x16x32_bf16 a[40:43], v[84:87], v[148:151], a[40:43]
    ds_read_b64_tr_b16 v[54:55], v14 offset:12288
    v_mfma_f32_16x16x32_bf16 a[44:47], v[80:83], v[152:155], a[44:47]
    ds_read_b128 v[116:119], v17 offset:5120
    v_mfma_f32_16x16x32_bf16 a[44:47], v[84:87], v[156:159], a[44:47]
    buffer_load_dwordx4 v20, s[12:15], s54 offen offset:1024 sc1 lds
    v_mfma_f32_16x16x32_bf16 a[48:51], v[88:91], v[128:131], a[48:51]
    ds_read_b64_tr_b16 v[56:57], v15 offset:0
    v_mfma_f32_16x16x32_bf16 a[48:51], v[92:95], v[132:135], a[48:51]
    ds_read_b64_tr_b16 v[58:59], v15 offset:4096
    v_mfma_f32_16x16x32_bf16 a[52:55], v[88:91], v[136:139], a[52:55]
    ds_read_b128 v[120:123], v17 offset:6144
    v_mfma_f32_16x16x32_bf16 a[52:55], v[92:95], v[140:143], a[52:55]
    s_add_u32 m0, s51, 34816
    s_add_u32 s55, s46, 26624
    buffer_load_dwordx4 v20, s[12:15], s55 offen offset:0 sc1 lds
    v_mfma_f32_16x16x32_bf16 a[56:59], v[88:91], v[144:147], a[56:59]
    ds_read_b64_tr_b16 v[60:61], v15 offset:8192
    v_mfma_f32_16x16x32_bf16 a[56:59], v[92:95], v[148:151], a[56:59]
    buffer_load_dwordx4 v20, s[12:15], s55 offen offset:1024 sc1 lds
    v_mfma_f32_16x16x32_bf16 a[60:63], v[88:91], v[152:155], a[60:63]
    ds_read_b64_tr_b16 v[62:63], v15 offset:12288
    v_mfma_f32_16x16x32_bf16 a[60:63], v[92:95], v[156:159], a[60:63]
    ds_read_b128 v[124:127], v17 offset:7168
    s_waitcnt vmcnt(16) lgkmcnt(0)
    s_barrier
    v_mfma_f32_16x16x32_bf16 a[0:3], v[32:35], v[96:99], a[0:3]
    ds_read_b64_tr_b16 v[64:65], v12 offset:32768
    v_mfma_f32_16x16x32_bf16 a[0:3], v[36:39], v[100:103], a[0:3]
    ds_read_b64_tr_b16 v[66:67], v12 offset:36864
    v_mfma_f32_16x16x32_bf16 a[4:7], v[32:35], v[104:107], a[4:7]
    ds_read_b128 v[128:131], v17 offset:32768
    v_mfma_f32_16x16x32_bf16 a[4:7], v[36:39], v[108:111], a[4:7]
    s_add_u32 m0, s50, 65536
    s_add_u32 s52, s44, 917504
    buffer_load_dwordx4 v18, s[8:11], s52 offen offset:0 lds
    v_mfma_f32_16x16x32_bf16 a[8:11], v[32:35], v[112:115], a[8:11]
    ds_read_b64_tr_b16 v[68:69], v12 offset:40960
    v_mfma_f32_16x16x32_bf16 a[8:11], v[36:39], v[116:119], a[8:11]
    ds_read_b64_tr_b16 v[70:71], v12 offset:45056
    v_mfma_f32_16x16x32_bf16 a[12:15], v[32:35], v[120:123], a[12:15]
    ds_read_b128 v[132:135], v17 offset:33792
    v_mfma_f32_16x16x32_bf16 a[12:15], v[36:39], v[124:127], a[12:15]
    s_add_u32 s53, s44, 920576
    buffer_load_dwordx4 v19, s[8:11], s53 offen offset:1024 lds
    v_mfma_f32_16x16x32_bf16 a[16:19], v[40:43], v[96:99], a[16:19]
    ds_read_b64_tr_b16 v[72:73], v13 offset:32768
    v_mfma_f32_16x16x32_bf16 a[16:19], v[44:47], v[100:103], a[16:19]
    ds_read_b64_tr_b16 v[74:75], v13 offset:36864
    v_mfma_f32_16x16x32_bf16 a[20:23], v[40:43], v[104:107], a[20:23]
    ds_read_b128 v[136:139], v17 offset:34816
    v_mfma_f32_16x16x32_bf16 a[20:23], v[44:47], v[108:111], a[20:23]
    s_add_u32 s52, s44, 923648
    buffer_load_dwordx4 v18, s[8:11], s52 offen offset:2048 lds
    v_mfma_f32_16x16x32_bf16 a[24:27], v[40:43], v[112:115], a[24:27]
    ds_read_b64_tr_b16 v[76:77], v13 offset:40960
    v_mfma_f32_16x16x32_bf16 a[24:27], v[44:47], v[116:119], a[24:27]
    ds_read_b64_tr_b16 v[78:79], v13 offset:45056
    v_mfma_f32_16x16x32_bf16 a[28:31], v[40:43], v[120:123], a[28:31]
    ds_read_b128 v[140:143], v17 offset:35840
    v_mfma_f32_16x16x32_bf16 a[28:31], v[44:47], v[124:127], a[28:31]
    s_add_u32 s53, s44, 926720
    buffer_load_dwordx4 v19, s[8:11], s53 offen offset:3072 lds
    v_mfma_f32_16x16x32_bf16 a[32:35], v[48:51], v[96:99], a[32:35]
    ds_read_b64_tr_b16 v[80:81], v14 offset:32768
    v_mfma_f32_16x16x32_bf16 a[32:35], v[52:55], v[100:103], a[32:35]
    ds_read_b64_tr_b16 v[82:83], v14 offset:36864
    v_mfma_f32_16x16x32_bf16 a[36:39], v[48:51], v[104:107], a[36:39]
    ds_read_b128 v[144:147], v17 offset:36864
    v_mfma_f32_16x16x32_bf16 a[36:39], v[52:55], v[108:111], a[36:39]
    s_add_u32 m0, s51, 65536
    s_add_u32 s54, s45, 28672
    buffer_load_dwordx4 v20, s[12:15], s54 offen offset:0 sc1 lds
    v_mfma_f32_16x16x32_bf16 a[40:43], v[48:51], v[112:115], a[40:43]
    ds_read_b64_tr_b16 v[84:85], v14 offset:40960
    v_mfma_f32_16x16x32_bf16 a[40:43], v[52:55], v[116:119], a[40:43]
    ds_read_b64_tr_b16 v[86:87], v14 offset:45056
    v_mfma_f32_16x16x32_bf16 a[44:47], v[48:51], v[120:123], a[44:47]
    ds_read_b128 v[148:151], v17 offset:37888
    v_mfma_f32_16x16x32_bf16 a[44:47], v[52:55], v[124:127], a[44:47]
    buffer_load_dwordx4 v20, s[12:15], s54 offen offset:1024 sc1 lds
    v_mfma_f32_16x16x32_bf16 a[48:51], v[56:59], v[96:99], a[48:51]
    ds_read_b64_tr_b16 v[88:89], v15 offset:32768
    v_mfma_f32_16x16x32_bf16 a[48:51], v[60:63], v[100:103], a[48:51]
    ds_read_b64_tr_b16 v[90:91], v15 offset:36864
    v_mfma_f32_16x16x32_bf16 a[52:55], v[56:59], v[104:107], a[52:55]
    ds_read_b128 v[152:155], v17 offset:38912
    v_mfma_f32_16x16x32_bf16 a[52:55], v[60:63], v[108:111], a[52:55]
    s_add_u32 m0, s51, 67584
    s_add_u32 s55, s46, 28672
    buffer_load_dwordx4 v20, s[12:15], s55 offen offset:0 sc1 lds
    v_mfma_f32_16x16x32_bf16 a[56:59], v[56:59], v[112:115], a[56:59]
    ds_read_b64_tr_b16 v[92:93], v15 offset:40960
    v_mfma_f32_16x16x32_bf16 a[56:59], v[60:63], v[116:119], a[56:59]
    buffer_load_dwordx4 v20, s[12:15], s55 offen offset:1024 sc1 lds
    v_mfma_f32_16x16x32_bf16 a[60:63], v[56:59], v[120:123], a[60:63]
    ds_read_b64_tr_b16 v[94:95], v15 offset:45056
    v_mfma_f32_16x16x32_bf16 a[60:63], v[60:63], v[124:127], a[60:63]
    ds_read_b128 v[156:159], v17 offset:39936
    s_waitcnt vmcnt(16) lgkmcnt(0)
    s_barrier
    v_mfma_f32_16x16x32_bf16 a[0:3], v[64:67], v[128:131], a[0:3]
    ds_read_b64_tr_b16 v[32:33], v8 offset:0
    v_mfma_f32_16x16x32_bf16 a[0:3], v[68:71], v[132:135], a[0:3]
    ds_read_b64_tr_b16 v[34:35], v8 offset:4096
    v_mfma_f32_16x16x32_bf16 a[4:7], v[64:67], v[136:139], a[4:7]
    ds_read_b128 v[96:99], v16 offset:0
    v_mfma_f32_16x16x32_bf16 a[4:7], v[68:71], v[140:143], a[4:7]
    s_add_u32 m0, s50, 98304
    s_add_u32 s52, s44, 983040
    buffer_load_dwordx4 v18, s[8:11], s52 offen offset:0 lds
    v_mfma_f32_16x16x32_bf16 a[8:11], v[64:67], v[144:147], a[8:11]
    ds_read_b64_tr_b16 v[36:37], v8 offset:8192
    v_mfma_f32_16x16x32_bf16 a[8:11], v[68:71], v[148:151], a[8:11]
    ds_read_b64_tr_b16 v[38:39], v8 offset:12288
    v_mfma_f32_16x16x32_bf16 a[12:15], v[64:67], v[152:155], a[12:15]
    ds_read_b128 v[100:103], v16 offset:1024
    v_mfma_f32_16x16x32_bf16 a[12:15], v[68:71], v[156:159], a[12:15]
    s_add_u32 s53, s44, 986112
    buffer_load_dwordx4 v19, s[8:11], s53 offen offset:1024 lds
    v_mfma_f32_16x16x32_bf16 a[16:19], v[72:75], v[128:131], a[16:19]
    ds_read_b64_tr_b16 v[40:41], v9 offset:0
    v_mfma_f32_16x16x32_bf16 a[16:19], v[76:79], v[132:135], a[16:19]
    ds_read_b64_tr_b16 v[42:43], v9 offset:4096
    v_mfma_f32_16x16x32_bf16 a[20:23], v[72:75], v[136:139], a[20:23]
    ds_read_b128 v[104:107], v16 offset:2048
    v_mfma_f32_16x16x32_bf16 a[20:23], v[76:79], v[140:143], a[20:23]
    s_add_u32 s52, s44, 989184
    buffer_load_dwordx4 v18, s[8:11], s52 offen offset:2048 lds
    v_mfma_f32_16x16x32_bf16 a[24:27], v[72:75], v[144:147], a[24:27]
    ds_read_b64_tr_b16 v[44:45], v9 offset:8192
    v_mfma_f32_16x16x32_bf16 a[24:27], v[76:79], v[148:151], a[24:27]
    ds_read_b64_tr_b16 v[46:47], v9 offset:12288
    v_mfma_f32_16x16x32_bf16 a[28:31], v[72:75], v[152:155], a[28:31]
    ds_read_b128 v[108:111], v16 offset:3072
    v_mfma_f32_16x16x32_bf16 a[28:31], v[76:79], v[156:159], a[28:31]
    s_add_u32 s53, s44, 992256
    buffer_load_dwordx4 v19, s[8:11], s53 offen offset:3072 lds
    v_mfma_f32_16x16x32_bf16 a[32:35], v[80:83], v[128:131], a[32:35]
    ds_read_b64_tr_b16 v[48:49], v10 offset:0
    v_mfma_f32_16x16x32_bf16 a[32:35], v[84:87], v[132:135], a[32:35]
    ds_read_b64_tr_b16 v[50:51], v10 offset:4096
    v_mfma_f32_16x16x32_bf16 a[36:39], v[80:83], v[136:139], a[36:39]
    ds_read_b128 v[112:115], v16 offset:4096
    v_mfma_f32_16x16x32_bf16 a[36:39], v[84:87], v[140:143], a[36:39]
    s_add_u32 m0, s51, 98304
    s_add_u32 s54, s45, 30720
    buffer_load_dwordx4 v20, s[12:15], s54 offen offset:0 sc1 lds
    v_mfma_f32_16x16x32_bf16 a[40:43], v[80:83], v[144:147], a[40:43]
    ds_read_b64_tr_b16 v[52:53], v10 offset:8192
    v_mfma_f32_16x16x32_bf16 a[40:43], v[84:87], v[148:151], a[40:43]
    ds_read_b64_tr_b16 v[54:55], v10 offset:12288
    v_mfma_f32_16x16x32_bf16 a[44:47], v[80:83], v[152:155], a[44:47]
    ds_read_b128 v[116:119], v16 offset:5120
    v_mfma_f32_16x16x32_bf16 a[44:47], v[84:87], v[156:159], a[44:47]
    buffer_load_dwordx4 v20, s[12:15], s54 offen offset:1024 sc1 lds
    v_mfma_f32_16x16x32_bf16 a[48:51], v[88:91], v[128:131], a[48:51]
    ds_read_b64_tr_b16 v[56:57], v11 offset:0
    v_mfma_f32_16x16x32_bf16 a[48:51], v[92:95], v[132:135], a[48:51]
    ds_read_b64_tr_b16 v[58:59], v11 offset:4096
    v_mfma_f32_16x16x32_bf16 a[52:55], v[88:91], v[136:139], a[52:55]
    ds_read_b128 v[120:123], v16 offset:6144
    v_mfma_f32_16x16x32_bf16 a[52:55], v[92:95], v[140:143], a[52:55]
    s_add_u32 m0, s51, 100352
    s_add_u32 s55, s46, 30720
    buffer_load_dwordx4 v20, s[12:15], s55 offen offset:0 sc1 lds
    v_mfma_f32_16x16x32_bf16 a[56:59], v[88:91], v[144:147], a[56:59]
    ds_read_b64_tr_b16 v[60:61], v11 offset:8192
    v_mfma_f32_16x16x32_bf16 a[56:59], v[92:95], v[148:151], a[56:59]
    buffer_load_dwordx4 v20, s[12:15], s55 offen offset:1024 sc1 lds
    v_mfma_f32_16x16x32_bf16 a[60:63], v[88:91], v[152:155], a[60:63]
    ds_read_b64_tr_b16 v[62:63], v11 offset:12288
    v_mfma_f32_16x16x32_bf16 a[60:63], v[92:95], v[156:159], a[60:63]
    ds_read_b128 v[124:127], v16 offset:7168
    s_waitcnt vmcnt(16) lgkmcnt(0)
    s_barrier
    v_mfma_f32_16x16x32_bf16 a[0:3], v[32:35], v[96:99], a[0:3]
    ds_read_b64_tr_b16 v[64:65], v8 offset:32768
    v_mfma_f32_16x16x32_bf16 a[0:3], v[36:39], v[100:103], a[0:3]
    ds_read_b64_tr_b16 v[66:67], v8 offset:36864
    v_mfma_f32_16x16x32_bf16 a[4:7], v[32:35], v[104:107], a[4:7]
    ds_read_b128 v[128:131], v16 offset:32768
    v_mfma_f32_16x16x32_bf16 a[4:7], v[36:39], v[108:111], a[4:7]
    s_add_u32 m0, s50, 0
    s_add_u32 s52, s44, 1048576
    buffer_load_dwordx4 v18, s[8:11], s52 offen offset:0 lds
    v_mfma_f32_16x16x32_bf16 a[8:11], v[32:35], v[112:115], a[8:11]
    ds_read_b64_tr_b16 v[68:69], v8 offset:40960
    v_mfma_f32_16x16x32_bf16 a[8:11], v[36:39], v[116:119], a[8:11]
    ds_read_b64_tr_b16 v[70:71], v8 offset:45056
    v_mfma_f32_16x16x32_bf16 a[12:15], v[32:35], v[120:123], a[12:15]
    ds_read_b128 v[132:135], v16 offset:33792
    v_mfma_f32_16x16x32_bf16 a[12:15], v[36:39], v[124:127], a[12:15]
    s_add_u32 s53, s44, 1051648
    buffer_load_dwordx4 v19, s[8:11], s53 offen offset:1024 lds
    v_mfma_f32_16x16x32_bf16 a[16:19], v[40:43], v[96:99], a[16:19]
    ds_read_b64_tr_b16 v[72:73], v9 offset:32768
    v_mfma_f32_16x16x32_bf16 a[16:19], v[44:47], v[100:103], a[16:19]
    ds_read_b64_tr_b16 v[74:75], v9 offset:36864
    v_mfma_f32_16x16x32_bf16 a[20:23], v[40:43], v[104:107], a[20:23]
    ds_read_b128 v[136:139], v16 offset:34816
    v_mfma_f32_16x16x32_bf16 a[20:23], v[44:47], v[108:111], a[20:23]
    s_add_u32 s52, s44, 1054720
    buffer_load_dwordx4 v18, s[8:11], s52 offen offset:2048 lds
    v_mfma_f32_16x16x32_bf16 a[24:27], v[40:43], v[112:115], a[24:27]
    ds_read_b64_tr_b16 v[76:77], v9 offset:40960
    v_mfma_f32_16x16x32_bf16 a[24:27], v[44:47], v[116:119], a[24:27]
    ds_read_b64_tr_b16 v[78:79], v9 offset:45056
    v_mfma_f32_16x16x32_bf16 a[28:31], v[40:43], v[120:123], a[28:31]
    ds_read_b128 v[140:143], v16 offset:35840
    v_mfma_f32_16x16x32_bf16 a[28:31], v[44:47], v[124:127], a[28:31]
    s_add_u32 s53, s44, 1057792
    buffer_load_dwordx4 v19, s[8:11], s53 offen offset:3072 lds
    v_mfma_f32_16x16x32_bf16 a[32:35], v[48:51], v[96:99], a[32:35]
    ds_read_b64_tr_b16 v[80:81], v10 offset:32768
    v_mfma_f32_16x16x32_bf16 a[32:35], v[52:55], v[100:103], a[32:35]
    ds_read_b64_tr_b16 v[82:83], v10 offset:36864
    v_mfma_f32_16x16x32_bf16 a[36:39], v[48:51], v[104:107], a[36:39]
    ds_read_b128 v[144:147], v16 offset:36864
    v_mfma_f32_16x16x32_bf16 a[36:39], v[52:55], v[108:111], a[36:39]
    s_add_u32 m0, s51, 0
    s_add_u32 s54, s45, 32768
    buffer_load_dwordx4 v20, s[12:15], s54 offen offset:0 sc1 lds
    v_mfma_f32_16x16x32_bf16 a[40:43], v[48:51], v[112:115], a[40:43]
    ds_read_b64_tr_b16 v[84:85], v10 offset:40960
    v_mfma_f32_16x16x32_bf16 a[40:43], v[52:55], v[116:119], a[40:43]
    ds_read_b64_tr_b16 v[86:87], v10 offset:45056
    v_mfma_f32_16x16x32_bf16 a[44:47], v[48:51], v[120:123], a[44:47]
    ds_read_b128 v[148:151], v16 offset:37888
    v_mfma_f32_16x16x32_bf16 a[44:47], v[52:55], v[124:127], a[44:47]
    buffer_load_dwordx4 v20, s[12:15], s54 offen offset:1024 sc1 lds
    v_mfma_f32_16x16x32_bf16 a[48:51], v[56:59], v[96:99], a[48:51]
    ds_read_b64_tr_b16 v[88:89], v11 offset:32768
    v_mfma_f32_16x16x32_bf16 a[48:51], v[60:63], v[100:103], a[48:51]
    ds_read_b64_tr_b16 v[90:91], v11 offset:36864
    v_mfma_f32_16x16x32_bf16 a[52:55], v[56:59], v[104:107], a[52:55]
    ds_read_b128 v[152:155], v16 offset:38912
    v_mfma_f32_16x16x32_bf16 a[52:55], v[60:63], v[108:111], a[52:55]
    s_add_u32 m0, s51, 2048
    s_add_u32 s55, s46, 32768
    buffer_load_dwordx4 v20, s[12:15], s55 offen offset:0 sc1 lds
    v_mfma_f32_16x16x32_bf16 a[56:59], v[56:59], v[112:115], a[56:59]
    ds_read_b64_tr_b16 v[92:93], v11 offset:40960
    v_mfma_f32_16x16x32_bf16 a[56:59], v[60:63], v[116:119], a[56:59]
    buffer_load_dwordx4 v20, s[12:15], s55 offen offset:1024 sc1 lds
    v_mfma_f32_16x16x32_bf16 a[60:63], v[56:59], v[120:123], a[60:63]
    ds_read_b64_tr_b16 v[94:95], v11 offset:45056
    v_mfma_f32_16x16x32_bf16 a[60:63], v[60:63], v[124:127], a[60:63]
    ds_read_b128 v[156:159], v16 offset:39936
    s_waitcnt vmcnt(16) lgkmcnt(0)
    s_barrier
    v_mfma_f32_16x16x32_bf16 a[0:3], v[64:67], v[128:131], a[0:3]
    ds_read_b64_tr_b16 v[32:33], v12 offset:0
    v_mfma_f32_16x16x32_bf16 a[0:3], v[68:71], v[132:135], a[0:3]
    ds_read_b64_tr_b16 v[34:35], v12 offset:4096
    v_mfma_f32_16x16x32_bf16 a[4:7], v[64:67], v[136:139], a[4:7]
    ds_read_b128 v[96:99], v17 offset:0
    v_mfma_f32_16x16x32_bf16 a[4:7], v[68:71], v[140:143], a[4:7]
    s_add_u32 m0, s50, 32768
    s_add_u32 s52, s44, 1114112
    buffer_load_dwordx4 v18, s[8:11], s52 offen offset:0 lds
    v_mfma_f32_16x16x32_bf16 a[8:11], v[64:67], v[144:147], a[8:11]
    ds_read_b64_tr_b16 v[36:37], v12 offset:8192
    v_mfma_f32_16x16x32_bf16 a[8:11], v[68:71], v[148:151], a[8:11]
    ds_read_b64_tr_b16 v[38:39], v12 offset:12288
    v_mfma_f32_16x16x32_bf16 a[12:15], v[64:67], v[152:155], a[12:15]
    ds_read_b128 v[100:103], v17 offset:1024
    v_mfma_f32_16x16x32_bf16 a[12:15], v[68:71], v[156:159], a[12:15]
    s_add_u32 s53, s44, 1117184
    buffer_load_dwordx4 v19, s[8:11], s53 offen offset:1024 lds
    v_mfma_f32_16x16x32_bf16 a[16:19], v[72:75], v[128:131], a[16:19]
    ds_read_b64_tr_b16 v[40:41], v13 offset:0
    v_mfma_f32_16x16x32_bf16 a[16:19], v[76:79], v[132:135], a[16:19]
    ds_read_b64_tr_b16 v[42:43], v13 offset:4096
    v_mfma_f32_16x16x32_bf16 a[20:23], v[72:75], v[136:139], a[20:23]
    ds_read_b128 v[104:107], v17 offset:2048
    v_mfma_f32_16x16x32_bf16 a[20:23], v[76:79], v[140:143], a[20:23]
    s_add_u32 s52, s44, 1120256
    buffer_load_dwordx4 v18, s[8:11], s52 offen offset:2048 lds
    v_mfma_f32_16x16x32_bf16 a[24:27], v[72:75], v[144:147], a[24:27]
    ds_read_b64_tr_b16 v[44:45], v13 offset:8192
    v_mfma_f32_16x16x32_bf16 a[24:27], v[76:79], v[148:151], a[24:27]
    ds_read_b64_tr_b16 v[46:47], v13 offset:12288
    v_mfma_f32_16x16x32_bf16 a[28:31], v[72:75], v[152:155], a[28:31]
    ds_read_b128 v[108:111], v17 offset:3072
    v_mfma_f32_16x16x32_bf16 a[28:31], v[76:79], v[156:159], a[28:31]
    s_add_u32 s53, s44, 1123328
    buffer_load_dwordx4 v19, s[8:11], s53 offen offset:3072 lds
    v_mfma_f32_16x16x32_bf16 a[32:35], v[80:83], v[128:131], a[32:35]
    ds_read_b64_tr_b16 v[48:49], v14 offset:0
    v_mfma_f32_16x16x32_bf16 a[32:35], v[84:87], v[132:135], a[32:35]
    ds_read_b64_tr_b16 v[50:51], v14 offset:4096
    v_mfma_f32_16x16x32_bf16 a[36:39], v[80:83], v[136:139], a[36:39]
    ds_read_b128 v[112:115], v17 offset:4096
    v_mfma_f32_16x16x32_bf16 a[36:39], v[84:87], v[140:143], a[36:39]
    s_add_u32 m0, s51, 32768
    s_add_u32 s54, s45, 34816
    buffer_load_dwordx4 v20, s[12:15], s54 offen offset:0 sc1 lds
    v_mfma_f32_16x16x32_bf16 a[40:43], v[80:83], v[144:147], a[40:43]
    ds_read_b64_tr_b16 v[52:53], v14 offset:8192
    v_mfma_f32_16x16x32_bf16 a[40:43], v[84:87], v[148:151], a[40:43]
    ds_read_b64_tr_b16 v[54:55], v14 offset:12288
    v_mfma_f32_16x16x32_bf16 a[44:47], v[80:83], v[152:155], a[44:47]
    ds_read_b128 v[116:119], v17 offset:5120
    v_mfma_f32_16x16x32_bf16 a[44:47], v[84:87], v[156:159], a[44:47]
    buffer_load_dwordx4 v20, s[12:15], s54 offen offset:1024 sc1 lds
    v_mfma_f32_16x16x32_bf16 a[48:51], v[88:91], v[128:131], a[48:51]
    ds_read_b64_tr_b16 v[56:57], v15 offset:0
    v_mfma_f32_16x16x32_bf16 a[48:51], v[92:95], v[132:135], a[48:51]
    ds_read_b64_tr_b16 v[58:59], v15 offset:4096
    v_mfma_f32_16x16x32_bf16 a[52:55], v[88:91], v[136:139], a[52:55]
    ds_read_b128 v[120:123], v17 offset:6144
    v_mfma_f32_16x16x32_bf16 a[52:55], v[92:95], v[140:143], a[52:55]
    s_add_u32 m0, s51, 34816
    s_add_u32 s55, s46, 34816
    buffer_load_dwordx4 v20, s[12:15], s55 offen offset:0 sc1 lds
    v_mfma_f32_16x16x32_bf16 a[56:59], v[88:91], v[144:147], a[56:59]
    ds_read_b64_tr_b16 v[60:61], v15 offset:8192
    v_mfma_f32_16x16x32_bf16 a[56:59], v[92:95], v[148:151], a[56:59]
    buffer_load_dwordx4 v20, s[12:15], s55 offen offset:1024 sc1 lds
    v_mfma_f32_16x16x32_bf16 a[60:63], v[88:91], v[152:155], a[60:63]
    ds_read_b64_tr_b16 v[62:63], v15 offset:12288
    v_mfma_f32_16x16x32_bf16 a[60:63], v[92:95], v[156:159], a[60:63]
    ds_read_b128 v[124:127], v17 offset:7168
    s_waitcnt vmcnt(16) lgkmcnt(0)
    s_barrier
    v_mfma_f32_16x16x32_bf16 a[0:3], v[32:35], v[96:99], a[0:3]
    ds_read_b64_tr_b16 v[64:65], v12 offset:32768
    v_mfma_f32_16x16x32_bf16 a[0:3], v[36:39], v[100:103], a[0:3]
    ds_read_b64_tr_b16 v[66:67], v12 offset:36864
    v_mfma_f32_16x16x32_bf16 a[4:7], v[32:35], v[104:107], a[4:7]
    ds_read_b128 v[128:131], v17 offset:32768
    v_mfma_f32_16x16x32_bf16 a[4:7], v[36:39], v[108:111], a[4:7]
    s_cmp_eq_u32 s61, 0
    s_cselect_b32 s8, s28, s32
    s_cselect_b32 s12, s36, s40
    s_cselect_b32 s9, s29, s33
    s_cselect_b32 s13, s37, s41
    s_cselect_b32 s10, s30, s34
    s_cselect_b32 s14, s38, s42
    s_mov_b32 s44, s47
    s_mov_b32 s45, s48
    s_mov_b32 s46, s49
    s_add_u32 m0, s50, 65536
    s_add_u32 s52, s44, 0
    buffer_load_dwordx4 v18, s[8:11], s52 offen offset:0 lds
    v_mfma_f32_16x16x32_bf16 a[8:11], v[32:35], v[112:115], a[8:11]
    ds_read_b64_tr_b16 v[68:69], v12 offset:40960
    v_mfma_f32_16x16x32_bf16 a[8:11], v[36:39], v[116:119], a[8:11]
    ds_read_b64_tr_b16 v[70:71], v12 offset:45056
    v_mfma_f32_16x16x32_bf16 a[12:15], v[32:35], v[120:123], a[12:15]
    ds_read_b128 v[132:135], v17 offset:33792
    v_mfma_f32_16x16x32_bf16 a[12:15], v[36:39], v[124:127], a[12:15]
    s_add_u32 s53, s44, 3072
    buffer_load_dwordx4 v19, s[8:11], s53 offen offset:1024 lds
    v_mfma_f32_16x16x32_bf16 a[16:19], v[40:43], v[96:99], a[16:19]
    ds_read_b64_tr_b16 v[72:73], v13 offset:32768
    v_mfma_f32_16x16x32_bf16 a[16:19], v[44:47], v[100:103], a[16:19]
    ds_read_b64_tr_b16 v[74:75], v13 offset:36864
    v_mfma_f32_16x16x32_bf16 a[20:23], v[40:43], v[104:107], a[20:23]
    ds_read_b128 v[136:139], v17 offset:34816
    v_mfma_f32_16x16x32_bf16 a[20:23], v[44:47], v[108:111], a[20:23]
    s_add_u32 s52, s44, 6144
    buffer_load_dwordx4 v18, s[8:11], s52 offen offset:2048 lds
    v_mfma_f32_16x16x32_bf16 a[24:27], v[40:43], v[112:115], a[24:27]
    ds_read_b64_tr_b16 v[76:77], v13 offset:40960
    v_mfma_f32_16x16x32_bf16 a[24:27], v[44:47], v[116:119], a[24:27]
    ds_read_b64_tr_b16 v[78:79], v13 offset:45056
    v_mfma_f32_16x16x32_bf16 a[28:31], v[40:43], v[120:123], a[28:31]
    ds_read_b128 v[140:143], v17 offset:35840
    v_mfma_f32_16x16x32_bf16 a[28:31], v[44:47], v[124:127], a[28:31]
    s_add_u32 s53, s44, 9216
    buffer_load_dwordx4 v19, s[8:11], s53 offen offset:3072 lds
    v_mfma_f32_16x16x32_bf16 a[32:35], v[48:51], v[96:99], a[32:35]
    ds_read_b64_tr_b16 v[80:81], v14 offset:32768
    v_mfma_f32_16x16x32_bf16 a[32:35], v[52:55], v[100:103], a[32:35]
    ds_read_b64_tr_b16 v[82:83], v14 offset:36864
    v_mfma_f32_16x16x32_bf16 a[36:39], v[48:51], v[104:107], a[36:39]
    ds_read_b128 v[144:147], v17 offset:36864
    v_mfma_f32_16x16x32_bf16 a[36:39], v[52:55], v[108:111], a[36:39]
    s_add_u32 m0, s51, 65536
    s_add_u32 s54, s45, 0
    buffer_load_dwordx4 v20, s[12:15], s54 offen offset:0 sc1 lds
    v_mfma_f32_16x16x32_bf16 a[40:43], v[48:51], v[112:115], a[40:43]
    ds_read_b64_tr_b16 v[84:85], v14 offset:40960
    v_mfma_f32_16x16x32_bf16 a[40:43], v[52:55], v[116:119], a[40:43]
    ds_read_b64_tr_b16 v[86:87], v14 offset:45056
    v_mfma_f32_16x16x32_bf16 a[44:47], v[48:51], v[120:123], a[44:47]
    ds_read_b128 v[148:151], v17 offset:37888
    v_mfma_f32_16x16x32_bf16 a[44:47], v[52:55], v[124:127], a[44:47]
    buffer_load_dwordx4 v20, s[12:15], s54 offen offset:1024 sc1 lds
    v_mfma_f32_16x16x32_bf16 a[48:51], v[56:59], v[96:99], a[48:51]
    ds_read_b64_tr_b16 v[88:89], v15 offset:32768
    v_mfma_f32_16x16x32_bf16 a[48:51], v[60:63], v[100:103], a[48:51]
    ds_read_b64_tr_b16 v[90:91], v15 offset:36864
    v_mfma_f32_16x16x32_bf16 a[52:55], v[56:59], v[104:107], a[52:55]
    ds_read_b128 v[152:155], v17 offset:38912
    v_mfma_f32_16x16x32_bf16 a[52:55], v[60:63], v[108:111], a[52:55]
    s_add_u32 m0, s51, 67584
    s_add_u32 s55, s46, 0
    buffer_load_dwordx4 v20, s[12:15], s55 offen offset:0 sc1 lds
    v_mfma_f32_16x16x32_bf16 a[56:59], v[56:59], v[112:115], a[56:59]
    ds_read_b64_tr_b16 v[92:93], v15 offset:40960
    v_mfma_f32_16x16x32_bf16 a[56:59], v[60:63], v[116:119], a[56:59]
    buffer_load_dwordx4 v20, s[12:15], s55 offen offset:1024 sc1 lds
    v_mfma_f32_16x16x32_bf16 a[60:63], v[56:59], v[120:123], a[60:63]
    ds_read_b64_tr_b16 v[94:95], v15 offset:45056
    v_mfma_f32_16x16x32_bf16 a[60:63], v[60:63], v[124:127], a[60:63]
    ds_read_b128 v[156:159], v17 offset:39936
    s_waitcnt vmcnt(16) lgkmcnt(0)
    s_barrier
    v_mfma_f32_16x16x32_bf16 a[0:3], v[64:67], v[128:131], a[0:3]
    ds_read_b64_tr_b16 v[32:33], v8 offset:0
    v_mfma_f32_16x16x32_bf16 a[0:3], v[68:71], v[132:135], a[0:3]
    ds_read_b64_tr_b16 v[34:35], v8 offset:4096
    v_mfma_f32_16x16x32_bf16 a[4:7], v[64:67], v[136:139], a[4:7]
    ds_read_b128 v[96:99], v16 offset:0
    v_mfma_f32_16x16x32_bf16 a[4:7], v[68:71], v[140:143], a[4:7]
    s_add_u32 m0, s50, 98304
    s_add_u32 s52, s44, 65536
    buffer_load_dwordx4 v18, s[8:11], s52 offen offset:0 lds
    v_mfma_f32_16x16x32_bf16 a[8:11], v[64:67], v[144:147], a[8:11]
    ds_read_b64_tr_b16 v[36:37], v8 offset:8192
    v_mfma_f32_16x16x32_bf16 a[8:11], v[68:71], v[148:151], a[8:11]
    ds_read_b64_tr_b16 v[38:39], v8 offset:12288
    v_mfma_f32_16x16x32_bf16 a[12:15], v[64:67], v[152:155], a[12:15]
    ds_read_b128 v[100:103], v16 offset:1024
    v_mfma_f32_16x16x32_bf16 a[12:15], v[68:71], v[156:159], a[12:15]
    s_add_u32 s53, s44, 68608
    buffer_load_dwordx4 v19, s[8:11], s53 offen offset:1024 lds
    v_mfma_f32_16x16x32_bf16 a[16:19], v[72:75], v[128:131], a[16:19]
    ds_read_b64_tr_b16 v[40:41], v9 offset:0
    v_mfma_f32_16x16x32_bf16 a[16:19], v[76:79], v[132:135], a[16:19]
    ds_read_b64_tr_b16 v[42:43], v9 offset:4096
    v_mfma_f32_16x16x32_bf16 a[20:23], v[72:75], v[136:139], a[20:23]
    ds_read_b128 v[104:107], v16 offset:2048
    v_mfma_f32_16x16x32_bf16 a[20:23], v[76:79], v[140:143], a[20:23]
    s_add_u32 s52, s44, 71680
    buffer_load_dwordx4 v18, s[8:11], s52 offen offset:2048 lds
    v_mfma_f32_16x16x32_bf16 a[24:27], v[72:75], v[144:147], a[24:27]
    ds_read_b64_tr_b16 v[44:45], v9 offset:8192
    v_mfma_f32_16x16x32_bf16 a[24:27], v[76:79], v[148:151], a[24:27]
    ds_read_b64_tr_b16 v[46:47], v9 offset:12288
    v_mfma_f32_16x16x32_bf16 a[28:31], v[72:75], v[152:155], a[28:31]
    ds_read_b128 v[108:111], v16 offset:3072
    v_mfma_f32_16x16x32_bf16 a[28:31], v[76:79], v[156:159], a[28:31]
    s_add_u32 s53, s44, 74752
    buffer_load_dwordx4 v19, s[8:11], s53 offen offset:3072 lds
    v_mfma_f32_16x16x32_bf16 a[32:35], v[80:83], v[128:131], a[32:35]
    ds_read_b64_tr_b16 v[48:49], v10 offset:0
    v_mfma_f32_16x16x32_bf16 a[32:35], v[84:87], v[132:135], a[32:35]
    ds_read_b64_tr_b16 v[50:51], v10 offset:4096
    v_mfma_f32_16x16x32_bf16 a[36:39], v[80:83], v[136:139], a[36:39]
    ds_read_b128 v[112:115], v16 offset:4096
    v_mfma_f32_16x16x32_bf16 a[36:39], v[84:87], v[140:143], a[36:39]
    s_add_u32 m0, s51, 98304
    s_add_u32 s54, s45, 2048
    buffer_load_dwordx4 v20, s[12:15], s54 offen offset:0 sc1 lds
    v_mfma_f32_16x16x32_bf16 a[40:43], v[80:83], v[144:147], a[40:43]
    ds_read_b64_tr_b16 v[52:53], v10 offset:8192
    v_mfma_f32_16x16x32_bf16 a[40:43], v[84:87], v[148:151], a[40:43]
    ds_read_b64_tr_b16 v[54:55], v10 offset:12288
    v_mfma_f32_16x16x32_bf16 a[44:47], v[80:83], v[152:155], a[44:47]
    ds_read_b128 v[116:119], v16 offset:5120
    v_mfma_f32_16x16x32_bf16 a[44:47], v[84:87], v[156:159], a[44:47]
    buffer_load_dwordx4 v20, s[12:15], s54 offen offset:1024 sc1 lds
    v_mfma_f32_16x16x32_bf16 a[48:51], v[88:91], v[128:131], a[48:51]
    ds_read_b64_tr_b16 v[56:57], v11 offset:0
    v_mfma_f32_16x16x32_bf16 a[48:51], v[92:95], v[132:135], a[48:51]
    ds_read_b64_tr_b16 v[58:59], v11 offset:4096
    v_mfma_f32_16x16x32_bf16 a[52:55], v[88:91], v[136:139], a[52:55]
    ds_read_b128 v[120:123], v16 offset:6144
    v_mfma_f32_16x16x32_bf16 a[52:55], v[92:95], v[140:143], a[52:55]
    s_add_u32 m0, s51, 100352
    s_add_u32 s55, s46, 2048
    buffer_load_dwordx4 v20, s[12:15], s55 offen offset:0 sc1 lds
    v_mfma_f32_16x16x32_bf16 a[56:59], v[88:91], v[144:147], a[56:59]
    ds_read_b64_tr_b16 v[60:61], v11 offset:8192
    v_mfma_f32_16x16x32_bf16 a[56:59], v[92:95], v[148:151], a[56:59]
    buffer_load_dwordx4 v20, s[12:15], s55 offen offset:1024 sc1 lds
    v_mfma_f32_16x16x32_bf16 a[60:63], v[88:91], v[152:155], a[60:63]
    ds_read_b64_tr_b16 v[62:63], v11 offset:12288
    v_mfma_f32_16x16x32_bf16 a[60:63], v[92:95], v[156:159], a[60:63]
    ds_read_b128 v[124:127], v16 offset:7168
    s_waitcnt vmcnt(16) lgkmcnt(0)
    s_barrier
    v_mfma_f32_16x16x32_bf16 a[0:3], v[32:35], v[96:99], a[0:3]
    ds_read_b64_tr_b16 v[64:65], v8 offset:32768
    v_mfma_f32_16x16x32_bf16 a[0:3], v[36:39], v[100:103], a[0:3]
    ds_read_b64_tr_b16 v[66:67], v8 offset:36864
    v_mfma_f32_16x16x32_bf16 a[4:7], v[32:35], v[104:107], a[4:7]
    ds_read_b128 v[128:131], v16 offset:32768
    v_mfma_f32_16x16x32_bf16 a[4:7], v[36:39], v[108:111], a[4:7]
    s_add_u32 m0, s50, 0
    s_add_u32 s52, s44, 131072
    buffer_load_dwordx4 v18, s[8:11], s52 offen offset:0 lds
    v_mfma_f32_16x16x32_bf16 a[8:11], v[32:35], v[112:115], a[8:11]
    ds_read_b64_tr_b16 v[68:69], v8 offset:40960
    v_mfma_f32_16x16x32_bf16 a[8:11], v[36:39], v[116:119], a[8:11]
    ds_read_b64_tr_b16 v[70:71], v8 offset:45056
    v_mfma_f32_16x16x32_bf16 a[12:15], v[32:35], v[120:123], a[12:15]
    ds_read_b128 v[132:135], v16 offset:33792
    v_mfma_f32_16x16x32_bf16 a[12:15], v[36:39], v[124:127], a[12:15]
    s_add_u32 s53, s44, 134144
    buffer_load_dwordx4 v19, s[8:11], s53 offen offset:1024 lds
    v_mfma_f32_16x16x32_bf16 a[16:19], v[40:43], v[96:99], a[16:19]
    ds_read_b64_tr_b16 v[72:73], v9 offset:32768
    v_mfma_f32_16x16x32_bf16 a[16:19], v[44:47], v[100:103], a[16:19]
    ds_read_b64_tr_b16 v[74:75], v9 offset:36864
    v_mfma_f32_16x16x32_bf16 a[20:23], v[40:43], v[104:107], a[20:23]
    ds_read_b128 v[136:139], v16 offset:34816
    v_mfma_f32_16x16x32_bf16 a[20:23], v[44:47], v[108:111], a[20:23]
    s_add_u32 s52, s44, 137216
    buffer_load_dwordx4 v18, s[8:11], s52 offen offset:2048 lds
    v_mfma_f32_16x16x32_bf16 a[24:27], v[40:43], v[112:115], a[24:27]
    ds_read_b64_tr_b16 v[76:77], v9 offset:40960
    v_mfma_f32_16x16x32_bf16 a[24:27], v[44:47], v[116:119], a[24:27]
    ds_read_b64_tr_b16 v[78:79], v9 offset:45056
    v_mfma_f32_16x16x32_bf16 a[28:31], v[40:43], v[120:123], a[28:31]
    ds_read_b128 v[140:143], v16 offset:35840
    v_mfma_f32_16x16x32_bf16 a[28:31], v[44:47], v[124:127], a[28:31]
    s_add_u32 s53, s44, 140288
    buffer_load_dwordx4 v19, s[8:11], s53 offen offset:3072 lds
    v_mfma_f32_16x16x32_bf16 a[32:35], v[48:51], v[96:99], a[32:35]
    ds_read_b64_tr_b16 v[80:81], v10 offset:32768
    v_mfma_f32_16x16x32_bf16 a[32:35], v[52:55], v[100:103], a[32:35]
    ds_read_b64_tr_b16 v[82:83], v10 offset:36864
    v_mfma_f32_16x16x32_bf16 a[36:39], v[48:51], v[104:107], a[36:39]
    ds_read_b128 v[144:147], v16 offset:36864
    v_mfma_f32_16x16x32_bf16 a[36:39], v[52:55], v[108:111], a[36:39]
    s_add_u32 m0, s51, 0
    s_add_u32 s54, s45, 4096
    buffer_load_dwordx4 v20, s[12:15], s54 offen offset:0 sc1 lds
    v_mfma_f32_16x16x32_bf16 a[40:43], v[48:51], v[112:115], a[40:43]
    ds_read_b64_tr_b16 v[84:85], v10 offset:40960
    v_mfma_f32_16x16x32_bf16 a[40:43], v[52:55], v[116:119], a[40:43]
    ds_read_b64_tr_b16 v[86:87], v10 offset:45056
    v_mfma_f32_16x16x32_bf16 a[44:47], v[48:51], v[120:123], a[44:47]
    ds_read_b128 v[148:151], v16 offset:37888
    v_mfma_f32_16x16x32_bf16 a[44:47], v[52:55], v[124:127], a[44:47]
    buffer_load_dwordx4 v20, s[12:15], s54 offen offset:1024 sc1 lds
    v_mfma_f32_16x16x32_bf16 a[48:51], v[56:59], v[96:99], a[48:51]
    ds_read_b64_tr_b16 v[88:89], v11 offset:32768
    v_mfma_f32_16x16x32_bf16 a[48:51], v[60:63], v[100:103], a[48:51]
    ds_read_b64_tr_b16 v[90:91], v11 offset:36864
    v_mfma_f32_16x16x32_bf16 a[52:55], v[56:59], v[104:107], a[52:55]
    ds_read_b128 v[152:155], v16 offset:38912
    v_mfma_f32_16x16x32_bf16 a[52:55], v[60:63], v[108:111], a[52:55]
    s_add_u32 m0, s51, 2048
    s_add_u32 s55, s46, 4096
    buffer_load_dwordx4 v20, s[12:15], s55 offen offset:0 sc1 lds
    v_mfma_f32_16x16x32_bf16 a[56:59], v[56:59], v[112:115], a[56:59]
    ds_read_b64_tr_b16 v[92:93], v11 offset:40960
    v_mfma_f32_16x16x32_bf16 a[56:59], v[60:63], v[116:119], a[56:59]
    buffer_load_dwordx4 v20, s[12:15], s55 offen offset:1024 sc1 lds
    v_mfma_f32_16x16x32_bf16 a[60:63], v[56:59], v[120:123], a[60:63]
    ds_read_b64_tr_b16 v[94:95], v11 offset:45056
    v_mfma_f32_16x16x32_bf16 a[60:63], v[60:63], v[124:127], a[60:63]
    ds_read_b128 v[156:159], v16 offset:39936
    s_waitcnt vmcnt(16) lgkmcnt(0)
    s_barrier
    v_mfma_f32_16x16x32_bf16 a[0:3], v[64:67], v[128:131], a[0:3]
    ds_read_b64_tr_b16 v[32:33], v12 offset:0
    v_mfma_f32_16x16x32_bf16 a[0:3], v[68:71], v[132:135], a[0:3]
    ds_read_b64_tr_b16 v[34:35], v12 offset:4096
    v_mfma_f32_16x16x32_bf16 a[4:7], v[64:67], v[136:139], a[4:7]
    ds_read_b128 v[96:99], v17 offset:0
    v_mfma_f32_16x16x32_bf16 a[4:7], v[68:71], v[140:143], a[4:7]
    s_add_u32 m0, s50, 32768
    s_add_u32 s52, s44, 196608
    buffer_load_dwordx4 v18, s[8:11], s52 offen offset:0 lds
    v_mfma_f32_16x16x32_bf16 a[8:11], v[64:67], v[144:147], a[8:11]
    ds_read_b64_tr_b16 v[36:37], v12 offset:8192
    v_mfma_f32_16x16x32_bf16 a[8:11], v[68:71], v[148:151], a[8:11]
    ds_read_b64_tr_b16 v[38:39], v12 offset:12288
    v_mfma_f32_16x16x32_bf16 a[12:15], v[64:67], v[152:155], a[12:15]
    ds_read_b128 v[100:103], v17 offset:1024
    v_mfma_f32_16x16x32_bf16 a[12:15], v[68:71], v[156:159], a[12:15]
    s_add_u32 s53, s44, 199680
    buffer_load_dwordx4 v19, s[8:11], s53 offen offset:1024 lds
    v_mfma_f32_16x16x32_bf16 a[16:19], v[72:75], v[128:131], a[16:19]
    ds_read_b64_tr_b16 v[40:41], v13 offset:0
    v_mfma_f32_16x16x32_bf16 a[16:19], v[76:79], v[132:135], a[16:19]
    ds_read_b64_tr_b16 v[42:43], v13 offset:4096
    v_mfma_f32_16x16x32_bf16 a[20:23], v[72:75], v[136:139], a[20:23]
    ds_read_b128 v[104:107], v17 offset:2048
    v_mfma_f32_16x16x32_bf16 a[20:23], v[76:79], v[140:143], a[20:23]
    s_add_u32 s52, s44, 202752
    buffer_load_dwordx4 v18, s[8:11], s52 offen offset:2048 lds
    v_mfma_f32_16x16x32_bf16 a[24:27], v[72:75], v[144:147], a[24:27]
    ds_read_b64_tr_b16 v[44:45], v13 offset:8192
    v_mfma_f32_16x16x32_bf16 a[24:27], v[76:79], v[148:151], a[24:27]
    ds_read_b64_tr_b16 v[46:47], v13 offset:12288
    v_mfma_f32_16x16x32_bf16 a[28:31], v[72:75], v[152:155], a[28:31]
    ds_read_b128 v[108:111], v17 offset:3072
    v_mfma_f32_16x16x32_bf16 a[28:31], v[76:79], v[156:159], a[28:31]
    s_add_u32 s53, s44, 205824
    buffer_load_dwordx4 v19, s[8:11], s53 offen offset:3072 lds
    v_mfma_f32_16x16x32_bf16 a[32:35], v[80:83], v[128:131], a[32:35]
    ds_read_b64_tr_b16 v[48:49], v14 offset:0
    v_mfma_f32_16x16x32_bf16 a[32:35], v[84:87], v[132:135], a[32:35]
    ds_read_b64_tr_b16 v[50:51], v14 offset:4096
    v_mfma_f32_16x16x32_bf16 a[36:39], v[80:83], v[136:139], a[36:39]
    ds_read_b128 v[112:115], v17 offset:4096
    v_mfma_f32_16x16x32_bf16 a[36:39], v[84:87], v[140:143], a[36:39]
    s_add_u32 m0, s51, 32768
    s_add_u32 s54, s45, 6144
    buffer_load_dwordx4 v20, s[12:15], s54 offen offset:0 sc1 lds
    v_mfma_f32_16x16x32_bf16 a[40:43], v[80:83], v[144:147], a[40:43]
    ds_read_b64_tr_b16 v[52:53], v14 offset:8192
    v_mfma_f32_16x16x32_bf16 a[40:43], v[84:87], v[148:151], a[40:43]
    ds_read_b64_tr_b16 v[54:55], v14 offset:12288
    v_mfma_f32_16x16x32_bf16 a[44:47], v[80:83], v[152:155], a[44:47]
    ds_read_b128 v[116:119], v17 offset:5120
    v_mfma_f32_16x16x32_bf16 a[44:47], v[84:87], v[156:159], a[44:47]
    buffer_load_dwordx4 v20, s[12:15], s54 offen offset:1024 sc1 lds
    v_mfma_f32_16x16x32_bf16 a[48:51], v[88:91], v[128:131], a[48:51]
    ds_read_b64_tr_b16 v[56:57], v15 offset:0
    v_mfma_f32_16x16x32_bf16 a[48:51], v[92:95], v[132:135], a[48:51]
    ds_read_b64_tr_b16 v[58:59], v15 offset:4096
    v_mfma_f32_16x16x32_bf16 a[52:55], v[88:91], v[136:139], a[52:55]
    ds_read_b128 v[120:123], v17 offset:6144
    v_mfma_f32_16x16x32_bf16 a[52:55], v[92:95], v[140:143], a[52:55]
    s_add_u32 m0, s51, 34816
    s_add_u32 s55, s46, 6144
    buffer_load_dwordx4 v20, s[12:15], s55 offen offset:0 sc1 lds
    v_mfma_f32_16x16x32_bf16 a[56:59], v[88:91], v[144:147], a[56:59]
    ds_read_b64_tr_b16 v[60:61], v15 offset:8192
    v_mfma_f32_16x16x32_bf16 a[56:59], v[92:95], v[148:151], a[56:59]
    buffer_load_dwordx4 v20, s[12:15], s55 offen offset:1024 sc1 lds
    v_mfma_f32_16x16x32_bf16 a[60:63], v[88:91], v[152:155], a[60:63]
    ds_read_b64_tr_b16 v[62:63], v15 offset:12288
    v_mfma_f32_16x16x32_bf16 a[60:63], v[92:95], v[156:159], a[60:63]
    ds_read_b128 v[124:127], v17 offset:7168
    s_waitcnt vmcnt(16) lgkmcnt(0)
    s_barrier
    s_cmp_eq_u32 s4, 2
    s_cbranch_scc1 L_k2_tailB
    v_mfma_f32_16x16x32_bf16 a[0:3], v[32:35], v[96:99], a[0:3]
    ds_read_b64_tr_b16 v[64:65], v12 offset:32768
    v_mfma_f32_16x16x32_bf16 a[0:3], v[36:39], v[100:103], a[0:3]
    ds_read_b64_tr_b16 v[66:67], v12 offset:36864
    v_mfma_f32_16x16x32_bf16 a[4:7], v[32:35], v[104:107], a[4:7]
    ds_read_b128 v[128:131], v17 offset:32768
    v_mfma_f32_16x16x32_bf16 a[4:7], v[36:39], v[108:111], a[4:7]
    s_add_u32 m0, s50, 65536
    s_add_u32 s52, s44, 262144
    buffer_load_dwordx4 v18, s[8:11], s52 offen offset:0 lds
    v_mfma_f32_16x16x32_bf16 a[8:11], v[32:35], v[112:115], a[8:11]
    ds_read_b64_tr_b16 v[68:69], v12 offset:40960
    v_mfma_f32_16x16x32_bf16 a[8:11], v[36:39], v[116:119], a[8:11]
    ds_read_b64_tr_b16 v[70:71], v12 offset:45056
    v_mfma_f32_16x16x32_bf16 a[12:15], v[32:35], v[120:123], a[12:15]
    ds_read_b128 v[132:135], v17 offset:33792
    v_mfma_f32_16x16x32_bf16 a[12:15], v[36:39], v[124:127], a[12:15]
    s_add_u32 s53, s44, 265216
    buffer_load_dwordx4 v19, s[8:11], s53 offen offset:1024 lds
    v_mfma_f32_16x16x32_bf16 a[16:19], v[40:43], v[96:99], a[16:19]
    ds_read_b64_tr_b16 v[72:73], v13 offset:32768
    v_mfma_f32_16x16x32_bf16 a[16:19], v[44:47], v[100:103], a[16:19]
    ds_read_b64_tr_b16 v[74:75], v13 offset:36864
    v_mfma_f32_16x16x32_bf16 a[20:23], v[40:43], v[104:107], a[20:23]
    ds_read_b128 v[136:139], v17 offset:34816
    v_mfma_f32_16x16x32_bf16 a[20:23], v[44:47], v[108:111], a[20:23]
    s_add_u32 s52, s44, 268288
    buffer_load_dwordx4 v18, s[8:11], s52 offen offset:2048 lds
    v_mfma_f32_16x16x32_bf16 a[24:27], v[40:43], v[112:115], a[24:27]
    ds_read_b64_tr_b16 v[76:77], v13 offset:40960
    v_mfma_f32_16x16x32_bf16 a[24:27], v[44:47], v[116:119], a[24:27]
    ds_read_b64_tr_b16 v[78:79], v13 offset:45056
    v_mfma_f32_16x16x32_bf16 a[28:31], v[40:43], v[120:123], a[28:31]
    ds_read_b128 v[140:143], v17 offset:35840
    v_mfma_f32_16x16x32_bf16 a[28:31], v[44:47], v[124:127], a[28:31]
    s_add_u32 s53, s44, 271360
    buffer_load_dwordx4 v19, s[8:11], s53 offen offset:3072 lds
    v_mfma_f32_16x16x32_bf16 a[32:35], v[48:51], v[96:99], a[32:35]
    ds_read_b64_tr_b16 v[80:81], v14 offset:32768
    v_mfma_f32_16x16x32_bf16 a[32:35], v[52:55], v[100:103], a[32:35]
    ds_read_b64_tr_b16 v[82:83], v14 offset:36864
    v_mfma_f32_16x16x32_bf16 a[36:39], v[48:51], v[104:107], a[36:39]
    ds_read_b128 v[144:147], v17 offset:36864
    v_mfma_f32_16x16x32_bf16 a[36:39], v[52:55], v[108:111], a[36:39]
    s_add_u32 m0, s51, 65536
    s_add_u32 s54, s45, 8192
    buffer_load_dwordx4 v20, s[12:15], s54 offen offset:0 sc1 lds
    v_mfma_f32_16x16x32_bf16 a[40:43], v[48:51], v[112:115], a[40:43]
    ds_read_b64_tr_b16 v[84:85], v14 offset:40960
    v_mfma_f32_16x16x32_bf16 a[40:43], v[52:55], v[116:119], a[40:43]
    ds_read_b64_tr_b16 v[86:87], v14 offset:45056
    v_mfma_f32_16x16x32_bf16 a[44:47], v[48:51], v[120:123], a[44:47]
    ds_read_b128 v[148:151], v17 offset:37888
    v_mfma_f32_16x16x32_bf16 a[44:47], v[52:55], v[124:127], a[44:47]
    buffer_load_dwordx4 v20, s[12:15], s54 offen offset:1024 sc1 lds
    v_mfma_f32_16x16x32_bf16 a[48:51], v[56:59], v[96:99], a[48:51]
    ds_read_b64_tr_b16 v[88:89], v15 offset:32768
    v_mfma_f32_16x16x32_bf16 a[48:51], v[60:63], v[100:103], a[48:51]
    ds_read_b64_tr_b16 v[90:91], v15 offset:36864
    v_mfma_f32_16x16x32_bf16 a[52:55], v[56:59], v[104:107], a[52:55]
    ds_read_b128 v[152:155], v17 offset:38912
    v_mfma_f32_16x16x32_bf16 a[52:55], v[60:63], v[108:111], a[52:55]
    s_add_u32 m0, s51, 67584
    s_add_u32 s55, s46, 8192
    buffer_load_dwordx4 v20, s[12:15], s55 offen offset:0 sc1 lds
    v_mfma_f32_16x16x32_bf16 a[56:59], v[56:59], v[112:115], a[56:59]
    ds_read_b64_tr_b16 v[92:93], v15 offset:40960
    v_mfma_f32_16x16x32_bf16 a[56:59], v[60:63], v[116:119], a[56:59]
    buffer_load_dwordx4 v20, s[12:15], s55 offen offset:1024 sc1 lds
    v_mfma_f32_16x16x32_bf16 a[60:63], v[56:59], v[120:123], a[60:63]
    ds_read_b64_tr_b16 v[94:95], v15 offset:45056
    v_mfma_f32_16x16x32_bf16 a[60:63], v[60:63], v[124:127], a[60:63]
    ds_read_b128 v[156:159], v17 offset:39936
    s_waitcnt vmcnt(16) lgkmcnt(0)
    s_barrier
    v_mfma_f32_16x16x32_bf16 a[0:3], v[64:67], v[128:131], a[0:3]
    ds_read_b64_tr_b16 v[32:33], v8 offset:0
    v_mfma_f32_16x16x32_bf16 a[0:3], v[68:71], v[132:135], a[0:3]
    ds_read_b64_tr_b16 v[34:35], v8 offset:4096
    v_mfma_f32_16x16x32_bf16 a[4:7], v[64:67], v[136:139], a[4:7]
    ds_read_b128 v[96:99], v16 offset:0
    v_mfma_f32_16x16x32_bf16 a[4:7], v[68:71], v[140:143], a[4:7]
    buffer_load_dwordx2 v[24:25], v21, s[16:19], s63 offen offset:0
    v_mfma_f32_16x16x32_bf16 a[8:11], v[64:67], v[144:147], a[8:11]
    ds_read_b64_tr_b16 v[36:37], v8 offset:8192
    v_mfma_f32_16x16x32_bf16 a[8:11], v[68:71], v[148:151], a[8:11]
    ds_read_b64_tr_b16 v[38:39], v8 offset:12288
    v_mfma_f32_16x16x32_bf16 a[12:15], v[64:67], v[152:155], a[12:15]
    ds_read_b128 v[100:103], v16 offset:1024
    v_mfma_f32_16x16x32_bf16 a[12:15], v[68:71], v[156:159], a[12:15]
    buffer_load_dwordx2 v[26:27], v21, s[16:19], s63 offen offset:32
    v_mfma_f32_16x16x32_bf16 a[16:19], v[72:75], v[128:131], a[16:19]
    ds_read_b64_tr_b16 v[40:41], v9 offset:0
    v_mfma_f32_16x16x32_bf16 a[16:19], v[76:79], v[132:135], a[16:19]
    ds_read_b64_tr_b16 v[42:43], v9 offset:4096
    v_mfma_f32_16x16x32_bf16 a[20:23], v[72:75], v[136:139], a[20:23]
    ds_read_b128 v[104:107], v16 offset:2048
    v_mfma_f32_16x16x32_bf16 a[20:23], v[76:79], v[140:143], a[20:23]
    buffer_load_dwordx2 v[28:29], v21, s[16:19], s63 offen offset:64
    v_mfma_f32_16x16x32_bf16 a[24:27], v[72:75], v[144:147], a[24:27]
    ds_read_b64_tr_b16 v[44:45], v9 offset:8192
    v_mfma_f32_16x16x32_bf16 a[24:27], v[76:79], v[148:151], a[24:27]
    ds_read_b64_tr_b16 v[46:47], v9 offset:12288
    v_mfma_f32_16x16x32_bf16 a[28:31], v[72:75], v[152:155], a[28:31]
    ds_read_b128 v[108:111], v16 offset:3072
    v_mfma_f32_16x16x32_bf16 a[28:31], v[76:79], v[156:159], a[28:31]
    buffer_load_dwordx2 v[30:31], v21, s[16:19], s63 offen offset:96
    v_mfma_f32_16x16x32_bf16 a[32:35], v[80:83], v[128:131], a[32:35]
    ds_read_b64_tr_b16 v[48:49], v10 offset:0
    v_mfma_f32_16x16x32_bf16 a[32:35], v[84:87], v[132:135], a[32:35]
    ds_read_b64_tr_b16 v[50:51], v10 offset:4096
    v_mfma_f32_16x16x32_bf16 a[36:39], v[80:83], v[136:139], a[36:39]
    ds_read_b128 v[112:115], v16 offset:4096
    v_mfma_f32_16x16x32_bf16 a[36:39], v[84:87], v[140:143], a[36:39]
    ds_read_b64_tr_b16 v[52:53], v10 offset:8192
    v_mfma_f32_16x16x32_bf16 a[40:43], v[80:83], v[144:147], a[40:43]
    ds_read_b64_tr_b16 v[54:55], v10 offset:12288
    v_mfma_f32_16x16x32_bf16 a[40:43], v[84:87], v[148:151], a[40:43]
    ds_read_b128 v[116:119], v16 offset:5120
    v_mfma_f32_16x16x32_bf16 a[44:47], v[80:83], v[152:155], a[44:47]
    ds_read_b64_tr_b16 v[56:57], v11 offset:0
    v_mfma_f32_16x16x32_bf16 a[44:47], v[84:87], v[156:159], a[44:47]
    ds_read_b64_tr_b16 v[58:59], v11 offset:4096
    v_mfma_f32_16x16x32_bf16 a[48:51], v[88:91], v[128:131], a[48:51]
    ds_read_b128 v[120:123], v16 offset:6144
    v_mfma_f32_16x16x32_bf16 a[48:51], v[92:95], v[132:135], a[48:51]
    ds_read_b64_tr_b16 v[60:61], v11 offset:8192
    v_mfma_f32_16x16x32_bf16 a[52:55], v[88:91], v[136:139], a[52:55]
    ds_read_b64_tr_b16 v[62:63], v11 offset:12288
    v_mfma_f32_16x16x32_bf16 a[52:55], v[92:95], v[140:143], a[52:55]
    ds_read_b128 v[124:127], v16 offset:7168
    v_mfma_f32_16x16x32_bf16 a[56:59], v[88:91], v[144:147], a[56:59]
    v_mfma_f32_16x16x32_bf16 a[56:59], v[92:95], v[148:151], a[56:59]
    v_mfma_f32_16x16x32_bf16 a[60:63], v[88:91], v[152:155], a[60:63]
    v_mfma_f32_16x16x32_bf16 a[60:63], v[92:95], v[156:159], a[60:63]
    s_waitcnt vmcnt(12) lgkmcnt(0)
    s_barrier
    v_mfma_f32_16x16x32_bf16 a[0:3], v[32:35], v[96:99], a[0:3]
    ds_read_b64_tr_b16 v[64:65], v8 offset:32768
    v_mfma_f32_16x16x32_bf16 a[0:3], v[36:39], v[100:103], a[0:3]
    ds_read_b64_tr_b16 v[66:67], v8 offset:36864
    v_mfma_f32_16x16x32_bf16 a[4:7], v[32:35], v[104:107], a[4:7]
    ds_read_b128 v[128:131], v16 offset:32768
    v_mfma_f32_16x16x32_bf16 a[4:7], v[36:39], v[108:111], a[4:7]
    s_getpc_b64 s[56:57]
L_k2_pca:
    s_add_u32 s56, s56, L_k2_p0-L_k2_pca
    s_addc_u32 s57, s57, 0
    s_mul_i32 s52, s4, L_k2_p1-L_k2_p0
    s_lshl_b32 s53, s3, 10
    s_add_u32 s52, s52, s53
    v_add_u32 v1, s52, v20
    s_mov_b32 s52, L_k2_codeend-L_k2_p0-16
    v_min_u32 v1, s52, v1
    global_load_dwordx4 v[4:7], v1, s[56:57]
    v_mfma_f32_16x16x32_bf16 a[8:11], v[32:35], v[112:115], a[8:11]
    ds_read_b64_tr_b16 v[68:69], v8 offset:40960
    v_mfma_f32_16x16x32_bf16 a[8:11], v[36:39], v[116:119], a[8:11]
    ds_read_b64_tr_b16 v[70:71], v8 offset:45056
    v_mfma_f32_16x16x32_bf16 a[12:15], v[32:35], v[120:123], a[12:15]
    ds_read_b128 v[132:135], v16 offset:33792
    v_mfma_f32_16x16x32_bf16 a[12:15], v[36:39], v[124:127], a[12:15]
    s_lshl_b32 s53, s3, 8
    s_add_u32 s53, s53, L_k2_fin-L_k2_p0
    v_lshrrev_b32 v2, 2, v20
    v_add_u32 v2, s53, v2
    v_and_b32 v2, 0xfffffffc, v2
    v_min_u32 v2, s52, v2
    global_load_dword v3, v2, s[56:57]
    v_mfma_f32_16x16x32_bf16 a[16:19], v[40:43], v[96:99], a[16:19]
    ds_read_b64_tr_b16 v[72:73], v9 offset:32768
    v_mfma_f32_16x16x32_bf16 a[16:19], v[44:47], v[100:103], a[16:19]
    ds_read_b64_tr_b16 v[74:75], v9 offset:36864
    v_mfma_f32_16x16x32_bf16 a[20:23], v[40:43], v[104:107], a[20:23]
    ds_read_b128 v[136:139], v16 offset:34816
    v_mfma_f32_16x16x32_bf16 a[20:23], v[44:47], v[108:111], a[20:23]
    ds_read_b64_tr_b16 v[76:77], v9 offset:40960
    v_mfma_f32_16x16x32_bf16 a[24:27], v[40:43], v[112:115], a[24:27]
    ds_read_b64_tr_b16 v[78:79], v9 offset:45056
    v_mfma_f32_16x16x32_bf16 a[24:27], v[44:47], v[116:119], a[24:27]
    ds_read_b128 v[140:143], v16 offset:35840
    v_mfma_f32_16x16x32_bf16 a[28:31], v[40:43], v[120:123], a[28:31]
    ds_read_b64_tr_b16 v[80:81], v10 offset:32768
    v_mfma_f32_16x16x32_bf16 a[28:31], v[44:47], v[124:127], a[28:31]
    ds_read_b64_tr_b16 v[82:83], v10 offset:36864
    v_mfma_f32_16x16x32_bf16 a[32:35], v[48:51], v[96:99], a[32:35]
    ds_read_b128 v[144:147], v16 offset:36864
    v_mfma_f32_16x16x32_bf16 a[32:35], v[52:55], v[100:103], a[32:35]
    ds_read_b64_tr_b16 v[84:85], v10 offset:40960
    v_mfma_f32_16x16x32_bf16 a[36:39], v[48:51], v[104:107], a[36:39]
    ds_read_b64_tr_b16 v[86:87], v10 offset:45056
    v_mfma_f32_16x16x32_bf16 a[36:39], v[52:55], v[108:111], a[36:39]
    ds_read_b128 v[148:151], v16 offset:37888
    v_mfma_f32_16x16x32_bf16 a[40:43], v[48:51], v[112:115], a[40:43]
    ds_read_b64_tr_b16 v[88:89], v11 offset:32768
    v_mfma_f32_16x16x32_bf16 a[40:43], v[52:55], v[116:119], a[40:43]
    ds_read_b64_tr_b16 v[90:91], v11 offset:36864
    v_mfma_f32_16x16x32_bf16 a[44:47], v[48:51], v[120:123], a[44:47]
    ds_read_b128 v[152:155], v16 offset:38912
    v_mfma_f32_16x16x32_bf16 a[44:47], v[52:55], v[124:127], a[44:47]
    ds_read_b64_tr_b16 v[92:93], v11 offset:40960
    v_mfma_f32_16x16x32_bf16 a[48:51], v[56:59], v[96:99], a[48:51]
    ds_read_b64_tr_b16 v[94:95], v11 offset:45056
    v_mfma_f32_16x16x32_bf16 a[48:51], v[60:63], v[100:103], a[48:51]
    ds_read_b128 v[156:159], v16 offset:39936
    v_mfma_f32_16x16x32_bf16 a[52:55], v[56:59], v[104:107], a[52:55]
    v_mfma_f32_16x16x32_bf16 a[52:55], v[60:63], v[108:111], a[52:55]
    v_mfma_f32_16x16x32_bf16 a[56:59], v[56:59], v[112:115], a[56:59]
    v_mfma_f32_16x16x32_bf16 a[56:59], v[60:63], v[116:119], a[56:59]
    v_mfma_f32_16x16x32_bf16 a[60:63], v[56:59], v[120:123], a[60:63]
    v_mfma_f32_16x16x32_bf16 a[60:63], v[60:63], v[124:127], a[60:63]
    s_waitcnt vmcnt(6) lgkmcnt(0)
    s_barrier
    v_mfma_f32_16x16x32_bf16 a[0:3], v[64:67], v[128:131], a[0:3]
    ds_read_b64_tr_b16 v[32:33], v12 offset:0
    v_mfma_f32_16x16x32_bf16 a[0:3], v[68:71], v[132:135], a[0:3]
    ds_read_b64_tr_b16 v[34:35], v12 offset:4096
    v_mfma_f32_16x16x32_bf16 a[4:7], v[64:67], v[136:139], a[4:7]
    ds_read_b128 v[96:99], v17 offset:0
    v_mfma_f32_16x16x32_bf16 a[4:7], v[68:71], v[140:143], a[4:7]
    ds_read_b64_tr_b16 v[36:37], v12 offset:8192
    v_mfma_f32_16x16x32_bf16 a[8:11], v[64:67], v[144:147], a[8:11]
    ds_read_b64_tr_b16 v[38:39], v12 offset:12288
    v_mfma_f32_16x16x32_bf16 a[8:11], v[68:71], v[148:151], a[8:11]
    ds_read_b128 v[100:103], v17 offset:1024
    v_mfma_f32_16x16x32_bf16 a[12:15], v[64:67], v[152:155], a[12:15]
    ds_read_b64_tr_b16 v[40:41], v13 offset:0
    v_mfma_f32_16x16x32_bf16 a[12:15], v[68:71], v[156:159], a[12:15]
    ds_read_b64_tr_b16 v[42:43], v13 offset:4096
    v_mfma_f32_16x16x32_bf16 a[16:19], v[72:75], v[128:131], a[16:19]
    ds_read_b128 v[104:107], v17 offset:2048
    v_mfma_f32_16x16x32_bf16 a[16:19], v[76:79], v[132:135], a[16:19]
    ds_read_b64_tr_b16 v[44:45], v13 offset:8192
    v_mfma_f32_16x16x32_bf16 a[20:23], v[72:75], v[136:139], a[20:23]
    ds_read_b64_tr_b16 v[46:47], v13 offset:12288
    v_mfma_f32_16x16x32_bf16 a[20:23], v[76:79], v[140:143], a[20:23]
    ds_read_b128 v[108:111], v17 offset:3072
    v_mfma_f32_16x16x32_bf16 a[24:27], v[72:75], v[144:147], a[24:27]
    ds_read_b64_tr_b16 v[48:49], v14 offset:0
    v_mfma_f32_16x16x32_bf16 a[24:27], v[76:79], v[148:151], a[24:27]
    ds_read_b64_tr_b16 v[50:51], v14 offset:4096
    v_mfma_f32_16x16x32_bf16 a[28:31], v[72:75], v[152:155], a[28:31]
    ds_read_b128 v[112:115], v17 offset:4096
    v_mfma_f32_16x16x32_bf16 a[28:31], v[76:79], v[156:159], a[28:31]
    ds_read_b64_tr_b16 v[52:53], v14 offset:8192
    v_mfma_f32_16x16x32_bf16 a[32:35], v[80:83], v[128:131], a[32:35]
    ds_read_b64_tr_b16 v[54:55], v14 offset:12288
    v_mfma_f32_16x16x32_bf16 a[32:35], v[84:87], v[132:135], a[32:35]
    ds_read_b128 v[116:119], v17 offset:5120
    v_mfma_f32_16x16x32_bf16 a[36:39], v[80:83], v[136:139], a[36:39]
    ds_read_b64_tr_b16 v[56:57], v15 offset:0
    v_mfma_f32_16x16x32_bf16 a[36:39], v[84:87], v[140:143], a[36:39]
    ds_read_b64_tr_b16 v[58:59], v15 offset:4096
    v_mfma_f32_16x16x32_bf16 a[40:43], v[80:83], v[144:147], a[40:43]
    ds_read_b128 v[120:123], v17 offset:6144
    v_mfma_f32_16x16x32_bf16 a[40:43], v[84:87], v[148:151], a[40:43]
    ds_read_b64_tr_b16 v[60:61], v15 offset:8192
    v_mfma_f32_16x16x32_bf16 a[44:47], v[80:83], v[152:155], a[44:47]
    ds_read_b64_tr_b16 v[62:63], v15 offset:12288
    v_mfma_f32_16x16x32_bf16 a[44:47], v[84:87], v[156:159], a[44:47]
    ds_read_b128 v[124:127], v17 offset:7168
    v_mfma_f32_16x16x32_bf16 a[48:51], v[88:91], v[128:131], a[48:51]
    v_mfma_f32_16x16x32_bf16 a[48:51], v[92:95], v[132:135], a[48:51]
    v_mfma_f32_16x16x32_bf16 a[52:55], v[88:91], v[136:139], a[52:55]
    v_mfma_f32_16x16x32_bf16 a[52:55], v[92:95], v[140:143], a[52:55]
    v_mfma_f32_16x16x32_bf16 a[56:59], v[88:91], v[144:147], a[56:59]
    v_mfma_f32_16x16x32_bf16 a[56:59], v[92:95], v[148:151], a[56:59]
    v_mfma_f32_16x16x32_bf16 a[60:63], v[88:91], v[152:155], a[60:63]
    v_mfma_f32_16x16x32_bf16 a[60:63], v[92:95], v[156:159], a[60:63]
    s_waitcnt lgkmcnt(0)
    s_barrier
    v_mfma_f32_16x16x32_bf16 a[0:3], v[32:35], v[96:99], a[0:3]
    v_mfma_f32_16x16x32_bf16 a[0:3], v[36:39], v[100:103], a[0:3]
    v_mfma_f32_16x16x32_bf16 a[4:7], v[32:35], v[104:107], a[4:7]
    v_mfma_f32_16x16x32_bf16 a[4:7], v[36:39], v[108:111], a[4:7]
    v_mfma_f32_16x16x32_bf16 a[8:11], v[32:35], v[112:115], a[8:11]
    v_mfma_f32_16x16x32_bf16 a[8:11], v[36:39], v[116:119], a[8:11]
    v_mfma_f32_16x16x32_bf16 a[12:15], v[32:35], v[120:123], a[12:15]
    v_mfma_f32_16x16x32_bf16 a[12:15], v[36:39], v[124:127], a[12:15]
    v_mfma_f32_16x16x32_bf16 a[16:19], v[40:43], v[96:99], a[16:19]
    v_mfma_f32_16x16x32_bf16 a[16:19], v[44:47], v[100:103], a[16:19]
    v_mfma_f32_16x16x32_bf16 a[20:23], v[40:43], v[104:107], a[20:23]
    v_mfma_f32_16x16x32_bf16 a[20:23], v[44:47], v[108:111], a[20:23]
    v_mfma_f32_16x16x32_bf16 a[24:27], v[40:43], v[112:115], a[24:27]
    v_mfma_f32_16x16x32_bf16 a[24:27], v[44:47], v[116:119], a[24:27]
    v_mfma_f32_16x16x32_bf16 a[28:31], v[40:43], v[120:123], a[28:31]
    v_mfma_f32_16x16x32_bf16 a[28:31], v[44:47], v[124:127], a[28:31]
    v_mfma_f32_16x16x32_bf16 a[32:35], v[48:51], v[96:99], a[32:35]
    v_mfma_f32_16x16x32_bf16 a[32:35], v[52:55], v[100:103], a[32:35]
    v_mfma_f32_16x16x32_bf16 a[36:39], v[48:51], v[104:107], a[36:39]
    v_mfma_f32_16x16x32_bf16 a[36:39], v[52:55], v[108:111], a[36:39]
    v_mfma_f32_16x16x32_bf16 a[40:43], v[48:51], v[112:115], a[40:43]
    v_mfma_f32_16x16x32_bf16 a[40:43], v[52:55], v[116:119], a[40:43]
    v_mfma_f32_16x16x32_bf16 a[44:47], v[48:51], v[120:123], a[44:47]
    v_mfma_f32_16x16x32_bf16 a[44:47], v[52:55], v[124:127], a[44:47]
    v_mfma_f32_16x16x32_bf16 a[48:51], v[56:59], v[96:99], a[48:51]
    v_mfma_f32_16x16x32_bf16 a[48:51], v[60:63], v[100:103], a[48:51]
    v_mfma_f32_16x16x32_bf16 a[52:55], v[56:59], v[104:107], a[52:55]
    v_mfma_f32_16x16x32_bf16 a[52:55], v[60:63], v[108:111], a[52:55]
    v_mfma_f32_16x16x32_bf16 a[56:59], v[56:59], v[112:115], a[56:59]
    v_mfma_f32_16x16x32_bf16 a[56:59], v[60:63], v[116:119], a[56:59]
    v_mfma_f32_16x16x32_bf16 a[60:63], v[56:59], v[120:123], a[60:63]
    v_mfma_f32_16x16x32_bf16 a[60:63], v[60:63], v[124:127], a[60:63]
    s_branch L_k2_p0
L_k2_tailB:
    v_mfma_f32_16x16x32_bf16 a[64:67], v[32:35], v[96:99], 0
    ds_read_b64_tr_b16 v[64:65], v12 offset:32768
    v_accvgpr_read_b32 v160, a0
    v_mfma_f32_16x16x32_bf16 a[64:67], v[36:39], v[100:103], a[64:67]
    ds_read_b64_tr_b16 v[66:67], v12 offset:36864
    v_accvgpr_read_b32 v161, a1
    v_mfma_f32_16x16x32_bf16 a[68:71], v[32:35], v[104:107], 0
    ds_read_b128 v[128:131], v17 offset:32768
    v_accvgpr_read_b32 v162, a2
    v_mfma_f32_16x16x32_bf16 a[68:71], v[36:39], v[108:111], a[68:71]
    s_add_u32 m0, s50, 65536
    s_add_u32 s52, s44, 262144
    buffer_load_dwordx4 v18, s[8:11], s52 offen offset:0 lds
    v_accvgpr_read_b32 v163, a3
    v_mfma_f32_16x16x32_bf16 a[72:75], v[32:35], v[112:115], 0
    ds_read_b64_tr_b16 v[68:69], v12 offset:40960
    v_accvgpr_read_b32 v164, a16
    v_mfma_f32_16x16x32_bf16 a[72:75], v[36:39], v[116:119], a[72:75]
    ds_read_b64_tr_b16 v[70:71], v12 offset:45056
    v_accvgpr_read_b32 v165, a17
    v_mfma_f32_16x16x32_bf16 a[76:79], v[32:35], v[120:123], 0
    ds_read_b128 v[132:135], v17 offset:33792
    v_accvgpr_read_b32 v166, a18
    v_mfma_f32_16x16x32_bf16 a[76:79], v[36:39], v[124:127], a[76:79]
    s_add_u32 s53, s44, 265216
    buffer_load_dwordx4 v19, s[8:11], s53 offen offset:1024 lds
    v_accvgpr_read_b32 v167, a19
    v_mfma_f32_16x16x32_bf16 a[80:83], v[40:43], v[96:99], 0
    ds_read_b64_tr_b16 v[72:73], v13 offset:32768
    v_cvt_pk_bf16_f32 v168, v160, v161
    v_mfma_f32_16x16x32_bf16 a[80:83], v[44:47], v[100:103], a[80:83]
    ds_read_b64_tr_b16 v[74:75], v13 offset:36864
    v_cvt_pk_bf16_f32 v169, v162, v163
    v_mfma_f32_16x16x32_bf16 a[84:87], v[40:43], v[104:107], 0
    ds_read_b128 v[136:139], v17 offset:34816
    v_cvt_pk_bf16_f32 v170, v164, v165
    v_mfma_f32_16x16x32_bf16 a[84:87], v[44:47], v[108:111], a[84:87]
    s_add_u32 s52, s44, 268288
    buffer_load_dwordx4 v18, s[8:11], s52 offen offset:2048 lds
    v_cvt_pk_bf16_f32 v171, v166, v167
    v_mfma_f32_16x16x32_bf16 a[88:91], v[40:43], v[112:115], 0
    ds_read_b64_tr_b16 v[76:77], v13 offset:40960
    s_add_u32 s59, s62, 0
    v_mfma_f32_16x16x32_bf16 a[88:91], v[44:47], v[116:119], a[88:91]
    ds_read_b64_tr_b16 v[78:79], v13 offset:45056
    v_mfma_f32_16x16x32_bf16 a[92:95], v[40:43], v[120:123], 0
    ds_read_b128 v[140:143], v17 offset:35840
    v_mfma_f32_16x16x32_bf16 a[92:95], v[44:47], v[124:127], a[92:95]
    s_add_u32 s53, s44, 271360
    buffer_load_dwordx4 v19, s[8:11], s53 offen offset:3072 lds
    v_mfma_f32_16x16x32_bf16 a[96:99], v[48:51], v[96:99], 0
    ds_read_b64_tr_b16 v[80:81], v14 offset:32768
    v_mfma_f32_16x16x32_bf16 a[96:99], v[52:55], v[100:103], a[96:99]
    ds_read_b64_tr_b16 v[82:83], v14 offset:36864
    v_mfma_f32_16x16x32_bf16 a[100:103], v[48:51], v[104:107], 0
    ds_read_b128 v[144:147], v17 offset:36864
    v_mfma_f32_16x16x32_bf16 a[100:103], v[52:55], v[108:111], a[100:103]
    s_add_u32 m0, s51, 65536
    s_add_u32 s54, s45, 8192
    buffer_load_dwordx4 v20, s[12:15], s54 offen offset:0 sc1 lds
    v_mfma_f32_16x16x32_bf16 a[104:107], v[48:51], v[112:115], 0
    ds_read_b64_tr_b16 v[84:85], v14 offset:40960
    v_mfma_f32_16x16x32_bf16 a[104:107], v[52:55], v[116:119], a[104:107]
    ds_read_b64_tr_b16 v[86:87], v14 offset:45056
    v_mfma_f32_16x16x32_bf16 a[108:111], v[48:51], v[120:123], 0
    ds_read_b128 v[148:151], v17 offset:37888
    v_mfma_f32_16x16x32_bf16 a[108:111], v[52:55], v[124:127], a[108:111]
    buffer_load_dwordx4 v20, s[12:15], s54 offen offset:1024 sc1 lds
    v_mfma_f32_16x16x32_bf16 a[112:115], v[56:59], v[96:99], 0
    ds_read_b64_tr_b16 v[88:89], v15 offset:32768
    v_mfma_f32_16x16x32_bf16 a[112:115], v[60:63], v[100:103], a[112:115]
    ds_read_b64_tr_b16 v[90:91], v15 offset:36864
    v_mfma_f32_16x16x32_bf16 a[116:119], v[56:59], v[104:107], 0
    ds_read_b128 v[152:155], v17 offset:38912
    v_mfma_f32_16x16x32_bf16 a[116:119], v[60:63], v[108:111], a[116:119]
    s_add_u32 m0, s51, 67584
    s_add_u32 s55, s46, 8192
    buffer_load_dwordx4 v20, s[12:15], s55 offen offset:0 sc1 lds
    v_mfma_f32_16x16x32_bf16 a[120:123], v[56:59], v[112:115], 0
    ds_read_b64_tr_b16 v[92:93], v15 offset:40960
    v_mfma_f32_16x16x32_bf16 a[120:123], v[60:63], v[116:119], a[120:123]
    buffer_load_dwordx4 v20, s[12:15], s55 offen offset:1024 sc1 lds
    v_mfma_f32_16x16x32_bf16 a[124:127], v[56:59], v[120:123], 0
    ds_read_b64_tr_b16 v[94:95], v15 offset:45056
    v_mfma_f32_16x16x32_bf16 a[124:127], v[60:63], v[124:127], a[124:127]
    buffer_store_dwordx4 v[168:171], v20, s[24:27], s59 offen sc1
    ds_read_b128 v[156:159], v17 offset:39936
    s_waitcnt vmcnt(17) lgkmcnt(0)
    s_barrier
    v_mfma_f32_16x16x32_bf16 a[64:67], v[64:67], v[128:131], a[64:67]
    ds_read_b64_tr_b16 v[32:33], v8 offset:0
    v_accvgpr_read_b32 v172, a32
    v_mfma_f32_16x16x32_bf16 a[64:67], v[68:71], v[132:135], a[64:67]
    ds_read_b64_tr_b16 v[34:35], v8 offset:4096
    v_accvgpr_read_b32 v173, a33
    v_mfma_f32_16x16x32_bf16 a[68:71], v[64:67], v[136:139], a[68:71]
    ds_read_b128 v[96:99], v16 offset:0
    v_accvgpr_read_b32 v174, a34
    v_mfma_f32_16x16x32_bf16 a[68:71], v[68:71], v[140:143], a[68:71]
    buffer_load_dwordx2 v[24:25], v21, s[16:19], s63 offen offset:0
    v_accvgpr_read_b32 v175, a35
    v_mfma_f32_16x16x32_bf16 a[72:75], v[64:67], v[144:147], a[72:75]
    ds_read_b64_tr_b16 v[36:37], v8 offset:8192
    v_accvgpr_read_b32 v176, a48
    v_mfma_f32_16x16x32_bf16 a[72:75], v[68:71], v[148:151], a[72:75]
    ds_read_b64_tr_b16 v[38:39], v8 offset:12288
    v_accvgpr_read_b32 v177, a49
    v_mfma_f32_16x16x32_bf16 a[76:79], v[64:67], v[152:155], a[76:79]
    ds_read_b128 v[100:103], v16 offset:1024
    v_accvgpr_read_b32 v178, a50
    v_mfma_f32_16x16x32_bf16 a[76:79], v[68:71], v[156:159], a[76:79]
    buffer_load_dwordx2 v[26:27], v21, s[16:19], s63 offen offset:32
    v_accvgpr_read_b32 v179, a51
    v_mfma_f32_16x16x32_bf16 a[80:83], v[72:75], v[128:131], a[80:83]
    ds_read_b64_tr_b16 v[40:41], v9 offset:0
    v_cvt_pk_bf16_f32 v180, v172, v173
    v_mfma_f32_16x16x32_bf16 a[80:83], v[76:79], v[132:135], a[80:83]
    ds_read_b64_tr_b16 v[42:43], v9 offset:4096
    v_cvt_pk_bf16_f32 v181, v174, v175
    v_mfma_f32_16x16x32_bf16 a[84:87], v[72:75], v[136:139], a[84:87]
    ds_read_b128 v[104:107], v16 offset:2048
    v_cvt_pk_bf16_f32 v182, v176, v177
    v_mfma_f32_16x16x32_bf16 a[84:87], v[76:79], v[140:143], a[84:87]
    buffer_load_dwordx2 v[28:29], v21, s[16:19], s63 offen offset:64
    v_cvt_pk_bf16_f32 v183, v178, v179
    v_mfma_f32_16x16x32_bf16 a[88:91], v[72:75], v[144:147], a[88:91]
    ds_read_b64_tr_b16 v[44:45], v9 offset:8192
    s_add_u32 s59, s62, 1024
    v_mfma_f32_16x16x32_bf16 a[88:91], v[76:79], v[148:151], a[88:91]
    ds_read_b64_tr_b16 v[46:47], v9 offset:12288
    v_mfma_f32_16x16x32_bf16 a[92:95], v[72:75], v[152:155], a[92:95]
    ds_read_b128 v[108:111], v16 offset:3072
    v_mfma_f32_16x16x32_bf16 a[92:95], v[76:79], v[156:159], a[92:95]
    buffer_load_dwordx2 v[30:31], v21, s[16:19], s63 offen offset:96
    v_mfma_f32_16x16x32_bf16 a[96:99], v[80:83], v[128:131], a[96:99]
    ds_read_b64_tr_b16 v[48:49], v10 offset:0
    v_mfma_f32_16x16x32_bf16 a[96:99], v[84:87], v[132:135], a[96:99]
    ds_read_b64_tr_b16 v[50:51], v10 offset:4096
    v_mfma_f32_16x16x32_bf16 a[100:103], v[80:83], v[136:139], a[100:103]
    ds_read_b128 v[112:115], v16 offset:4096
    v_mfma_f32_16x16x32_bf16 a[100:103], v[84:87], v[140:143], a[100:103]
    ds_read_b64_tr_b16 v[52:53], v10 offset:8192
    v_mfma_f32_16x16x32_bf16 a[104:107], v[80:83], v[144:147], a[104:107]
    ds_read_b64_tr_b16 v[54:55], v10 offset:12288
    v_mfma_f32_16x16x32_bf16 a[104:107], v[84:87], v[148:151], a[104:107]
    ds_read_b128 v[116:119], v16 offset:5120
    v_mfma_f32_16x16x32_bf16 a[108:111], v[80:83], v[152:155], a[108:111]
    ds_read_b64_tr_b16 v[56:57], v11 offset:0
    v_mfma_f32_16x16x32_bf16 a[108:111], v[84:87], v[156:159], a[108:111]
    ds_read_b64_tr_b16 v[58:59], v11 offset:4096
    v_mfma_f32_16x16x32_bf16 a[112:115], v[88:91], v[128:131], a[112:115]
    ds_read_b128 v[120:123], v16 offset:6144
    v_mfma_f32_16x16x32_bf16 a[112:115], v[92:95], v[132:135], a[112:115]
    ds_read_b64_tr_b16 v[60:61], v11 offset:8192
    v_mfma_f32_16x16x32_bf16 a[116:119], v[88:91], v[136:139], a[116:119]
    ds_read_b64_tr_b16 v[62:63], v11 offset:12288
    v_mfma_f32_16x16x32_bf16 a[116:119], v[92:95], v[140:143], a[116:119]
    ds_read_b128 v[124:127], v16 offset:7168
    v_mfma_f32_16x16x32_bf16 a[120:123], v[88:91], v[144:147], a[120:123]
    buffer_store_dwordx4 v[180:183], v20, s[24:27], s59 offen sc1
    v_mfma_f32_16x16x32_bf16 a[120:123], v[92:95], v[148:151], a[120:123]
    v_accvgpr_read_b32 v184, a4
    v_mfma_f32_16x16x32_bf16 a[124:127], v[88:91], v[152:155], a[124:127]
    v_accvgpr_read_b32 v185, a5
    v_mfma_f32_16x16x32_bf16 a[124:127], v[92:95], v[156:159], a[124:127]
    v_accvgpr_read_b32 v186, a6
    s_waitcnt vmcnt(14) lgkmcnt(0)
    s_barrier
    v_mfma_f32_16x16x32_bf16 a[64:67], v[32:35], v[96:99], a[64:67]
    ds_read_b64_tr_b16 v[64:65], v8 offset:32768
    v_accvgpr_read_b32 v187, a7
    v_mfma_f32_16x16x32_bf16 a[64:67], v[36:39], v[100:103], a[64:67]
    ds_read_b64_tr_b16 v[66:67], v8 offset:36864
    v_accvgpr_read_b32 v188, a20
    v_mfma_f32_16x16x32_bf16 a[68:71], v[32:35], v[104:107], a[68:71]
    ds_read_b128 v[128:131], v16 offset:32768
    v_accvgpr_read_b32 v189, a21
    v_mfma_f32_16x16x32_bf16 a[68:71], v[36:39], v[108:111], a[68:71]
    s_getpc_b64 s[56:57]
L_k2_pcb:
    s_add_u32 s56, s56, L_k2_p0-L_k2_pcb
    s_addc_u32 s57, s57, 0
    s_mul_i32 s52, s4, L_k2_p1-L_k2_p0
    s_lshl_b32 s53, s3, 10
    s_add_u32 s52, s52, s53
    v_add_u32 v1, s52, v20
    s_mov_b32 s52, L_k2_codeend-L_k2_p0-16
    v_min_u32 v1, s52, v1
    global_load_dwordx4 v[4:7], v1, s[56:57]
    v_accvgpr_read_b32 v190, a22
    v_mfma_f32_16x16x32_bf16 a[72:75], v[32:35], v[112:115], a[72:75]
    ds_read_b64_tr_b16 v[68:69], v8 offset:40960
    v_accvgpr_read_b32 v191, a23
    v_mfma_f32_16x16x32_bf16 a[72:75], v[36:39], v[116:119], a[72:75]
    ds_read_b64_tr_b16 v[70:71], v8 offset:45056
    v_cvt_pk_bf16_f32 v192, v184, v185
    v_mfma_f32_16x16x32_bf16 a[76:79], v[32:35], v[120:123], a[76:79]
    ds_read_b128 v[132:135], v16 offset:33792
    v_cvt_pk_bf16_f32 v193, v186, v187
    v_mfma_f32_16x16x32_bf16 a[76:79], v[36:39], v[124:127], a[76:79]
    s_lshl_b32 s53, s3, 8
    s_add_u32 s53, s53, L_k2_fin-L_k2_p0
    v_lshrrev_b32 v2, 2, v20
    v_add_u32 v2, s53, v2
    v_and_b32 v2, 0xfffffffc, v2
    v_min_u32 v2, s52, v2
    global_load_dword v3, v2, s[56:57]
    v_cvt_pk_bf16_f32 v194, v188, v189
    v_mfma_f32_16x16x32_bf16 a[80:83], v[40:43], v[96:99], a[80:83]
    ds_read_b64_tr_b16 v[72:73], v9 offset:32768
    v_cvt_pk_bf16_f32 v195, v190, v191
    v_mfma_f32_16x16x32_bf16 a[80:83], v[44:47], v[100:103], a[80:83]
    ds_read_b64_tr_b16 v[74:75], v9 offset:36864
    s_add_u32 s59, s62, 65536
    v_mfma_f32_16x16x32_bf16 a[84:87], v[40:43], v[104:107], a[84:87]
    ds_read_b128 v[136:139], v16 offset:34816
    v_mfma_f32_16x16x32_bf16 a[84:87], v[44:47], v[108:111], a[84:87]
    ds_read_b64_tr_b16 v[76:77], v9 offset:40960
    v_mfma_f32_16x16x32_bf16 a[88:91], v[40:43], v[112:115], a[88:91]
    ds_read_b64_tr_b16 v[78:79], v9 offset:45056
    v_mfma_f32_16x16x32_bf16 a[88:91], v[44:47], v[116:119], a[88:91]
    ds_read_b128 v[140:143], v16 offset:35840
    v_mfma_f32_16x16x32_bf16 a[92:95], v[40:43], v[120:123], a[92:95]
    ds_read_b64_tr_b16 v[80:81], v10 offset:32768
    v_mfma_f32_16x16x32_bf16 a[92:95], v[44:47], v[124:127], a[92:95]
    ds_read_b64_tr_b16 v[82:83], v10 offset:36864
    v_mfma_f32_16x16x32_bf16 a[96:99], v[48:51], v[96:99], a[96:99]
    ds_read_b128 v[144:147], v16 offset:36864
    v_mfma_f32_16x16x32_bf16 a[96:99], v[52:55], v[100:103], a[96:99]
    ds_read_b64_tr_b16 v[84:85], v10 offset:40960
    v_mfma_f32_16x16x32_bf16 a[100:103], v[48:51], v[104:107], a[100:103]
    ds_read_b64_tr_b16 v[86:87], v10 offset:45056
    v_mfma_f32_16x16x32_bf16 a[100:103], v[52:55], v[108:111], a[100:103]
    ds_read_b128 v[148:151], v16 offset:37888
    v_mfma_f32_16x16x32_bf16 a[104:107], v[48:51], v[112:115], a[104:107]
    ds_read_b64_tr_b16 v[88:89], v11 offset:32768
    v_mfma_f32_16x16x32_bf16 a[104:107], v[52:55], v[116:119], a[104:107]
    ds_read_b64_tr_b16 v[90:91], v11 offset:36864
    v_mfma_f32_16x16x32_bf16 a[108:111], v[48:51], v[120:123], a[108:111]
    ds_read_b128 v[152:155], v16 offset:38912
    v_mfma_f32_16x16x32_bf16 a[108:111], v[52:55], v[124:127], a[108:111]
    ds_read_b64_tr_b16 v[92:93], v11 offset:40960
    v_mfma_f32_16x16x32_bf16 a[112:115], v[56:59], v[96:99], a[112:115]
    ds_read_b64_tr_b16 v[94:95], v11 offset:45056
    v_mfma_f32_16x16x32_bf16 a[112:115], v[60:63], v[100:103], a[112:115]
    ds_read_b128 v[156:159], v16 offset:39936
    v_mfma_f32_16x16x32_bf16 a[116:119], v[56:59], v[104:107], a[116:119]
    buffer_store_dwordx4 v[192:195], v20, s[24:27], s59 offen sc1
    v_mfma_f32_16x16x32_bf16 a[116:119], v[60:63], v[108:111], a[116:119]
    v_accvgpr_read_b32 v196, a36
    v_mfma_f32_16x16x32_bf16 a[120:123], v[56:59], v[112:115], a[120:123]
    v_accvgpr_read_b32 v197, a37
    v_mfma_f32_16x16x32_bf16 a[120:123], v[60:63], v[116:119], a[120:123]
    v_accvgpr_read_b32 v198, a38
    v_mfma_f32_16x16x32_bf16 a[124:127], v[56:59], v[120:123], a[124:127]
    v_accvgpr_read_b32 v199, a39
    v_mfma_f32_16x16x32_bf16 a[124:127], v[60:63], v[124:127], a[124:127]
    v_accvgpr_read_b32 v200, a52
    s_waitcnt vmcnt(9) lgkmcnt(0)
    s_barrier
    v_mfma_f32_16x16x32_bf16 a[64:67], v[64:67], v[128:131], a[64:67]
    ds_read_b64_tr_b16 v[32:33], v12 offset:0
    v_accvgpr_read_b32 v201, a53
    v_mfma_f32_16x16x32_bf16 a[64:67], v[68:71], v[132:135], a[64:67]
    ds_read_b64_tr_b16 v[34:35], v12 offset:4096
    v_accvgpr_read_b32 v202, a54
    v_mfma_f32_16x16x32_bf16 a[68:71], v[64:67], v[136:139], a[68:71]
    ds_read_b128 v[96:99], v17 offset:0
    v_accvgpr_read_b32 v203, a55
    v_mfma_f32_16x16x32_bf16 a[68:71], v[68:71], v[140:143], a[68:71]
    ds_read_b64_tr_b16 v[36:37], v12 offset:8192
    v_cvt_pk_bf16_f32 v204, v196, v197
    v_mfma_f32_16x16x32_bf16 a[72:75], v[64:67], v[144:147], a[72:75]
    ds_read_b64_tr_b16 v[38:39], v12 offset:12288
    v_cvt_pk_bf16_f32 v205, v198, v199
    v_mfma_f32_16x16x32_bf16 a[72:75], v[68:71], v[148:151], a[72:75]
    ds_read_b128 v[100:103], v17 offset:1024
    v_cvt_pk_bf16_f32 v206, v200, v201
    v_mfma_f32_16x16x32_bf16 a[76:79], v[64:67], v[152:155], a[76:79]
    ds_read_b64_tr_b16 v[40:41], v13 offset:0
    v_cvt_pk_bf16_f32 v207, v202, v203
    v_mfma_f32_16x16x32_bf16 a[76:79], v[68:71], v[156:159], a[76:79]
    ds_read_b64_tr_b16 v[42:43], v13 offset:4096
    s_add_u32 s59, s62, 66560
    v_mfma_f32_16x16x32_bf16 a[80:83], v[72:75], v[128:131], a[80:83]
    ds_read_b128 v[104:107], v17 offset:2048
    v_mfma_f32_16x16x32_bf16 a[80:83], v[76:79], v[132:135], a[80:83]
    ds_read_b64_tr_b16 v[44:45], v13 offset:8192
    v_mfma_f32_16x16x32_bf16 a[84:87], v[72:75], v[136:139], a[84:87]
    ds_read_b64_tr_b16 v[46:47], v13 offset:12288
    v_mfma_f32_16x16x32_bf16 a[84:87], v[76:79], v[140:143], a[84:87]
    ds_read_b128 v[108:111], v17 offset:3072
    v_mfma_f32_16x16x32_bf16 a[88:91], v[72:75], v[144:147], a[88:91]
    ds_read_b64_tr_b16 v[48:49], v14 offset:0
    v_mfma_f32_16x16x32_bf16 a[88:91], v[76:79], v[148:151], a[88:91]
    ds_read_b64_tr_b16 v[50:51], v14 offset:4096
    v_mfma_f32_16x16x32_bf16 a[92:95], v[72:75], v[152:155], a[92:95]
    ds_read_b128 v[112:115], v17 offset:4096
    v_mfma_f32_16x16x32_bf16 a[92:95], v[76:79], v[156:159], a[92:95]
    ds_read_b64_tr_b16 v[52:53], v14 offset:8192
    v_mfma_f32_16x16x32_bf16 a[96:99], v[80:83], v[128:131], a[96:99]
    ds_read_b64_tr_b16 v[54:55], v14 offset:12288
    v_mfma_f32_16x16x32_bf16 a[96:99], v[84:87], v[132:135], a[96:99]
    ds_read_b128 v[116:119], v17 offset:5120
    v_mfma_f32_16x16x32_bf16 a[100:103], v[80:83], v[136:139], a[100:103]
    ds_read_b64_tr_b16 v[56:57], v15 offset:0
    v_mfma_f32_16x16x32_bf16 a[100:103], v[84:87], v[140:143], a[100:103]
    ds_read_b64_tr_b16 v[58:59], v15 offset:4096
    v_mfma_f32_16x16x32_bf16 a[104:107], v[80:83], v[144:147], a[104:107]
    ds_read_b128 v[120:123], v17 offset:6144
    v_mfma_f32_16x16x32_bf16 a[104:107], v[84:87], v[148:151], a[104:107]
    ds_read_b64_tr_b16 v[60:61], v15 offset:8192
    v_mfma_f32_16x16x32_bf16 a[108:111], v[80:83], v[152:155], a[108:111]
    ds_read_b64_tr_b16 v[62:63], v15 offset:12288
    v_mfma_f32_16x16x32_bf16 a[108:111], v[84:87], v[156:159], a[108:111]
    ds_read_b128 v[124:127], v17 offset:7168
    v_mfma_f32_16x16x32_bf16 a[112:115], v[88:91], v[128:131], a[112:115]
    buffer_store_dwordx4 v[204:207], v20, s[24:27], s59 offen sc1
    v_mfma_f32_16x16x32_bf16 a[112:115], v[92:95], v[132:135], a[112:115]
    v_accvgpr_read_b32 v184, a12
    v_mfma_f32_16x16x32_bf16 a[116:119], v[88:91], v[136:139], a[116:119]
    v_accvgpr_read_b32 v185, a13
    v_mfma_f32_16x16x32_bf16 a[116:119], v[92:95], v[140:143], a[116:119]
    v_accvgpr_read_b32 v186, a14
    v_mfma_f32_16x16x32_bf16 a[120:123], v[88:91], v[144:147], a[120:123]
    v_accvgpr_read_b32 v187, a15
    v_mfma_f32_16x16x32_bf16 a[120:123], v[92:95], v[148:151], a[120:123]
    v_accvgpr_read_b32 v188, a28
    v_mfma_f32_16x16x32_bf16 a[124:127], v[88:91], v[152:155], a[124:127]
    v_accvgpr_read_b32 v189, a29
    v_mfma_f32_16x16x32_bf16 a[124:127], v[92:95], v[156:159], a[124:127]
    v_accvgpr_read_b32 v190, a30
    s_waitcnt lgkmcnt(0)
    s_barrier
    v_mfma_f32_16x16x32_bf16 a[64:67], v[32:35], v[96:99], a[64:67]
    v_accvgpr_read_b32 v191, a31
    v_mfma_f32_16x16x32_bf16 a[64:67], v[36:39], v[100:103], a[64:67]
    v_cvt_pk_bf16_f32 v192, v184, v185
    v_mfma_f32_16x16x32_bf16 a[68:71], v[32:35], v[104:107], a[68:71]
    v_cvt_pk_bf16_f32 v193, v186, v187
    v_mfma_f32_16x16x32_bf16 a[68:71], v[36:39], v[108:111], a[68:71]
    v_cvt_pk_bf16_f32 v194, v188, v189
    v_mfma_f32_16x16x32_bf16 a[72:75], v[32:35], v[112:115], a[72:75]
    v_cvt_pk_bf16_f32 v195, v190, v191
    v_mfma_f32_16x16x32_bf16 a[72:75], v[36:39], v[116:119], a[72:75]
    s_add_u32 s59, s62, 196608
    v_mfma_f32_16x16x32_bf16 a[76:79], v[32:35], v[120:123], a[76:79]
    buffer_store_dwordx4 v[192:195], v20, s[24:27], s59 offen sc1
    v_mfma_f32_16x16x32_bf16 a[76:79], v[36:39], v[124:127], a[76:79]
    v_accvgpr_read_b32 v196, a44
    v_mfma_f32_16x16x32_bf16 a[80:83], v[40:43], v[96:99], a[80:83]
    v_accvgpr_read_b32 v197, a45
    v_mfma_f32_16x16x32_bf16 a[80:83], v[44:47], v[100:103], a[80:83]
    v_accvgpr_read_b32 v198, a46
    v_mfma_f32_16x16x32_bf16 a[84:87], v[40:43], v[104:107], a[84:87]
    v_accvgpr_read_b32 v199, a47
    v_mfma_f32_16x16x32_bf16 a[84:87], v[44:47], v[108:111], a[84:87]
    v_accvgpr_read_b32 v200, a60
    v_mfma_f32_16x16x32_bf16 a[88:91], v[40:43], v[112:115], a[88:91]
    v_accvgpr_read_b32 v201, a61
    v_mfma_f32_16x16x32_bf16 a[88:91], v[44:47], v[116:119], a[88:91]
    v_accvgpr_read_b32 v202, a62
    v_mfma_f32_16x16x32_bf16 a[92:95], v[40:43], v[120:123], a[92:95]
    v_accvgpr_read_b32 v203, a63
    v_mfma_f32_16x16x32_bf16 a[92:95], v[44:47], v[124:127], a[92:95]
    v_cvt_pk_bf16_f32 v204, v196, v197
    v_mfma_f32_16x16x32_bf16 a[96:99], v[48:51], v[96:99], a[96:99]
    v_cvt_pk_bf16_f32 v205, v198, v199
    v_mfma_f32_16x16x32_bf16 a[96:99], v[52:55], v[100:103], a[96:99]
    v_cvt_pk_bf16_f32 v206, v200, v201
    v_mfma_f32_16x16x32_bf16 a[100:103], v[48:51], v[104:107], a[100:103]
    v_cvt_pk_bf16_f32 v207, v202, v203
    v_mfma_f32_16x16x32_bf16 a[100:103], v[52:55], v[108:111], a[100:103]
    s_add_u32 s59, s62, 197632
    v_mfma_f32_16x16x32_bf16 a[104:107], v[48:51], v[112:115], a[104:107]
    buffer_store_dwordx4 v[204:207], v20, s[24:27], s59 offen sc1
    v_mfma_f32_16x16x32_bf16 a[104:107], v[52:55], v[116:119], a[104:107]
    v_mfma_f32_16x16x32_bf16 a[108:111], v[48:51], v[120:123], a[108:111]
    v_mfma_f32_16x16x32_bf16 a[108:111], v[52:55], v[124:127], a[108:111]
    v_mfma_f32_16x16x32_bf16 a[112:115], v[56:59], v[96:99], a[112:115]
    v_mfma_f32_16x16x32_bf16 a[112:115], v[60:63], v[100:103], a[112:115]
    v_mfma_f32_16x16x32_bf16 a[116:119], v[56:59], v[104:107], a[116:119]
    v_mfma_f32_16x16x32_bf16 a[116:119], v[60:63], v[108:111], a[116:119]
    v_mfma_f32_16x16x32_bf16 a[120:123], v[56:59], v[112:115], a[120:123]
    v_mfma_f32_16x16x32_bf16 a[120:123], v[60:63], v[116:119], a[120:123]
    v_mfma_f32_16x16x32_bf16 a[124:127], v[56:59], v[120:123], a[124:127]
    v_mfma_f32_16x16x32_bf16 a[124:127], v[60:63], v[124:127], a[124:127]
    s_branch L_k2_p2
L_k2_p0:
    s_cmp_lg_u32 s4, 0
    s_cbranch_scc1 L_k2_p1
    s_nop 7
    v_accvgpr_read_b32 v184, a4
    v_accvgpr_read_b32 v185, a5
    v_accvgpr_read_b32 v186, a6
    v_accvgpr_read_b32 v187, a7
    v_accvgpr_read_b32 v188, a20
    v_accvgpr_read_b32 v189, a21
    v_accvgpr_read_b32 v190, a22
    v_accvgpr_read_b32 v191, a23
    v_cvt_pk_bf16_f32 v192, v184, v185
    v_cvt_pk_bf16_f32 v193, v186, v187
    v_cvt_pk_bf16_f32 v194, v188, v189
    v_cvt_pk_bf16_f32 v195, v190, v191
    s_add_u32 s59, s62, 65536
    buffer_store_dwordx4 v[192:195], v20, s[24:27], s59 offen sc1
    v_accvgpr_read_b32 v196, a36
    v_accvgpr_read_b32 v197, a37
    v_accvgpr_read_b32 v198, a38
    v_accvgpr_read_b32 v199, a39
    v_accvgpr_read_b32 v200, a52
    v_accvgpr_read_b32 v201, a53
    v_accvgpr_read_b32 v202, a54
    v_accvgpr_read_b32 v203, a55
    v_cvt_pk_bf16_f32 v204, v196, v197
    v_cvt_pk_bf16_f32 v205, v198, v199
    v_cvt_pk_bf16_f32 v206, v200, v201
    v_cvt_pk_bf16_f32 v207, v202, v203
    s_add_u32 s59, s62, 66560
    buffer_store_dwordx4 v[204:207], v20, s[24:27], s59 offen sc1
    v_accvgpr_read_b32 v160, a8
    v_accvgpr_read_b32 v161, a9
    v_accvgpr_read_b32 v162, a10
    v_accvgpr_read_b32 v163, a11
    v_accvgpr_read_b32 v164, a24
    v_accvgpr_read_b32 v165, a25
    v_accvgpr_read_b32 v166, a26
    v_accvgpr_read_b32 v167, a27
    v_cvt_pk_bf16_f32 v168, v160, v161
    v_cvt_pk_bf16_f32 v169, v162, v163
    v_cvt_pk_bf16_f32 v170, v164, v165
    v_cvt_pk_bf16_f32 v171, v166, v167
    s_add_u32 s59, s62, 131072
    buffer_store_dwordx4 v[168:171], v20, s[24:27], s59 offen sc1
    v_accvgpr_read_b32 v172, a40
    v_accvgpr_read_b32 v173, a41
    v_accvgpr_read_b32 v174, a42
    v_accvgpr_read_b32 v175, a43
    v_accvgpr_read_b32 v176, a56
    v_accvgpr_read_b32 v177, a57
    v_accvgpr_read_b32 v178, a58
    v_accvgpr_read_b32 v179, a59
    v_cvt_pk_bf16_f32 v180, v172, v173
    v_cvt_pk_bf16_f32 v181, v174, v175
    v_cvt_pk_bf16_f32 v182, v176, v177
    v_cvt_pk_bf16_f32 v183, v178, v179
    s_add_u32 s59, s62, 132096
    buffer_store_dwordx4 v[180:183], v20, s[24:27], s59 offen sc1
    v_accvgpr_read_b32 v184, a12
    v_accvgpr_read_b32 v185, a13
    v_accvgpr_read_b32 v186, a14
    v_accvgpr_read_b32 v187, a15
    v_accvgpr_read_b32 v188, a28
    v_accvgpr_read_b32 v189, a29
    v_accvgpr_read_b32 v190, a30
    v_accvgpr_read_b32 v191, a31
    v_cvt_pk_bf16_f32 v192, v184, v185
    v_cvt_pk_bf16_f32 v193, v186, v187
    v_cvt_pk_bf16_f32 v194, v188, v189
    v_cvt_pk_bf16_f32 v195, v190, v191
    s_add_u32 s59, s62, 196608
    buffer_store_dwordx4 v[192:195], v20, s[24:27], s59 offen sc1
    v_accvgpr_read_b32 v196, a44
    v_accvgpr_read_b32 v197, a45
    v_accvgpr_read_b32 v198, a46
    v_accvgpr_read_b32 v199, a47
    v_accvgpr_read_b32 v200, a60
    v_accvgpr_read_b32 v201, a61
    v_accvgpr_read_b32 v202, a62
    v_accvgpr_read_b32 v203, a63
    v_cvt_pk_bf16_f32 v204, v196, v197
    v_cvt_pk_bf16_f32 v205, v198, v199
    v_cvt_pk_bf16_f32 v206, v200, v201
    v_cvt_pk_bf16_f32 v207, v202, v203
    s_add_u32 s59, s62, 197632
    buffer_store_dwordx4 v[204:207], v20, s[24:27], s59 offen sc1
    v_accvgpr_read_b32 v32, a0
    v_accvgpr_read_b32 v33, a1
    v_accvgpr_read_b32 v34, a2
    v_accvgpr_read_b32 v35, a3
    v_accvgpr_read_b32 v36, a16
    v_accvgpr_read_b32 v37, a17
    v_accvgpr_read_b32 v38, a18
    v_accvgpr_read_b32 v39, a19
    v_accvgpr_read_b32 v40, a32
    v_accvgpr_read_b32 v41, a33
    v_accvgpr_read_b32 v42, a34
    v_accvgpr_read_b32 v43, a35
    v_accvgpr_read_b32 v44, a48
    v_accvgpr_read_b32 v45, a49
    v_accvgpr_read_b32 v46, a50
    v_accvgpr_read_b32 v47, a51
    v_mov_b32 v48, 0
    v_mov_b32 v49, 0
    v_mov_b32 v50, 0
    v_mov_b32 v51, 0
    v_mov_b32 v52, 0
    v_mov_b32 v53, 0
    v_mov_b32 v54, 0
    v_mov_b32 v55, 0
    v_mov_b32 v56, 0
    v_mov_b32 v57, 0
    v_mov_b32 v58, 0
    v_mov_b32 v59, 0
    v_mov_b32 v60, 0
    v_mov_b32 v61, 0
    v_mov_b32 v62, 0
    v_mov_b32 v63, 0
    s_waitcnt vmcnt(0)
    s_barrier
    s_lshl_b32 s52, s5, 7
    s_add_u32 s52, s52, 29360128
    s_cmp_lg_u32 s3, 0
    s_cbranch_scc1 L_k2_w0
    v_mov_b32 v1, 0
    v_mov_b32 v2, 1
    s_mov_b64 exec, 1
    buffer_store_dword v2, v1, s[24:27], s52 offen sc1
    v_mov_b32 v1, 0
    s_mov_b32 s55, 0
L_k2_poll0:
    buffer_load_dwordx4 v[4:7], v1, s[24:27], s52 offen sc1
    s_waitcnt vmcnt(0)
    v_and_b32 v4, v4, v5
    v_and_b32 v6, v6, v7
    v_and_b32 v4, v4, v6
    s_nop 0
    v_readfirstlane_b32 s53, v4
    s_nop 3
    s_cmp_eq_u32 s53, 1
    s_cbranch_scc1 L_k2_go0
    s_sleep 2
    s_add_u32 s55, s55, 1
    s_cmp_lt_u32 s55, 0x40000
    s_cbranch_scc1 L_k2_poll0
L_k2_go0:
    s_mov_b64 exec, -1
L_k2_w0:
    s_barrier
    s_lshl_b32 s52, s5, 18
    s_lshl_b32 s53, s3, 11
    s_add_u32 s52, s52, s53
    s_add_u32 s52, s52, 0
    s_add_u32 s53, s52, 16384
    buffer_load_dwordx4 v[64:67], v20, s[24:27], s53 offen sc1
    s_add_u32 s53, s52, 17408
    buffer_load_dwordx4 v[68:71], v20, s[24:27], s53 offen sc1
    s_add_u32 s53, s52, 32768
    buffer_load_dwordx4 v[72:75], v20, s[24:27], s53 offen sc1
    s_add_u32 s53, s52, 33792
    buffer_load_dwordx4 v[76:79], v20, s[24:27], s53 offen sc1
    s_add_u32 s53, s52, 40960
    buffer_load_dwordx4 v[80:83], v20, s[24:27], s53 offen sc1
    s_add_u32 s53, s52, 41984
    buffer_load_dwordx4 v[84:87], v20, s[24:27], s53 offen sc1
    s_add_u32 s53, s52, 57344
    buffer_load_dwordx4 v[88:91], v20, s[24:27], s53 offen sc1
    s_add_u32 s53, s52, 58368
    buffer_load_dwordx4 v[92:95], v20, s[24:27], s53 offen sc1
    s_mov_b32 s54, 0xffff0000
    s_waitcnt vmcnt(6)
    v_lshlrev_b32 v1, 16, v64
    v_and_b32 v2, s54, v64
    v_add_f32 v32, v32, v1
    v_add_f32 v33, v33, v2
    v_lshlrev_b32 v1, 16, v65
    v_and_b32 v2, s54, v65
    v_add_f32 v34, v34, v1
    v_add_f32 v35, v35, v2
    v_lshlrev_b32 v1, 16, v66
    v_and_b32 v2, s54, v66
    v_add_f32 v36, v36, v1
    v_add_f32 v37, v37, v2
    v_lshlrev_b32 v1, 16, v67
    v_and_b32 v2, s54, v67
    v_add_f32 v38, v38, v1
    v_add_f32 v39, v39, v2
    v_lshlrev_b32 v1, 16, v68
    v_and_b32 v2, s54, v68
    v_add_f32 v40, v40, v1
    v_add_f32 v41, v41, v2
    v_lshlrev_b32 v1, 16, v69
    v_and_b32 v2, s54, v69
    v_add_f32 v42, v42, v1
    v_add_f32 v43, v43, v2
    v_lshlrev_b32 v1, 16, v70
    v_and_b32 v2, s54, v70
    v_add_f32 v44, v44, v1
    v_add_f32 v45, v45, v2
    v_lshlrev_b32 v1, 16, v71
    v_and_b32 v2, s54, v71
    v_add_f32 v46, v46, v1
    v_add_f32 v47, v47, v2
    s_waitcnt vmcnt(4)
    v_lshlrev_b32 v1, 16, v72
    v_and_b32 v2, s54, v72
    v_add_f32 v32, v32, v1
    v_add_f32 v33, v33, v2
    v_lshlrev_b32 v1, 16, v73
    v_and_b32 v2, s54, v73
    v_add_f32 v34, v34, v1
    v_add_f32 v35, v35, v2
    v_lshlrev_b32 v1, 16, v74
    v_and_b32 v2, s54, v74
    v_add_f32 v36, v36, v1
    v_add_f32 v37, v37, v2
    v_lshlrev_b32 v1, 16, v75
    v_and_b32 v2, s54, v75
    v_add_f32 v38, v38, v1
    v_add_f32 v39, v39, v2
    v_lshlrev_b32 v1, 16, v76
    v_and_b32 v2, s54, v76
    v_add_f32 v40, v40, v1
    v_add_f32 v41, v41, v2
    v_lshlrev_b32 v1, 16, v77
    v_and_b32 v2, s54, v77
    v_add_f32 v42, v42, v1
    v_add_f32 v43, v43, v2
    v_lshlrev_b32 v1, 16, v78
    v_and_b32 v2, s54, v78
    v_add_f32 v44, v44, v1
    v_add_f32 v45, v45, v2
    v_lshlrev_b32 v1, 16, v79
    v_and_b32 v2, s54, v79
    v_add_f32 v46, v46, v1
    v_add_f32 v47, v47, v2
    s_waitcnt vmcnt(2)
    v_lshlrev_b32 v1, 16, v80
    v_and_b32 v2, s54, v80
    v_add_f32 v48, v48, v1
    v_add_f32 v49, v49, v2
    v_lshlrev_b32 v1, 16, v81
    v_and_b32 v2, s54, v81
    v_add_f32 v50, v50, v1
    v_add_f32 v51, v51, v2
    v_lshlrev_b32 v1, 16, v82
    v_and_b32 v2, s54, v82
    v_add_f32 v52, v52, v1
    v_add_f32 v53, v53, v2
    v_lshlrev_b32 v1, 16, v83
    v_and_b32 v2, s54, v83
    v_add_f32 v54, v54, v1
    v_add_f32 v55, v55, v2
    v_lshlrev_b32 v1, 16, v84
    v_and_b32 v2, s54, v84
    v_add_f32 v56, v56, v1
    v_add_f32 v57, v57, v2
    v_lshlrev_b32 v1, 16, v85
    v_and_b32 v2, s54, v85
    v_add_f32 v58, v58, v1
    v_add_f32 v59, v59, v2
    v_lshlrev_b32 v1, 16, v86
    v_and_b32 v2, s54, v86
    v_add_f32 v60, v60, v1
    v_add_f32 v61, v61, v2
    v_lshlrev_b32 v1, 16, v87
    v_and_b32 v2, s54, v87
    v_add_f32 v62, v62, v1
    v_add_f32 v63, v63, v2
    s_waitcnt vmcnt(0)
    v_lshlrev_b32 v1, 16, v88
    v_and_b32 v2, s54, v88
    v_add_f32 v48, v48, v1
    v_add_f32 v49, v49, v2
    v_lshlrev_b32 v1, 16, v89
    v_and_b32 v2, s54, v89
    v_add_f32 v50, v50, v1
    v_add_f32 v51, v51, v2
    v_lshlrev_b32 v1, 16, v90
    v_and_b32 v2, s54, v90
    v_add_f32 v52, v52, v1
    v_add_f32 v53, v53, v2
    v_lshlrev_b32 v1, 16, v91
    v_and_b32 v2, s54, v91
    v_add_f32 v54, v54, v1
    v_add_f32 v55, v55, v2
    v_lshlrev_b32 v1, 16, v92
    v_and_b32 v2, s54, v92
    v_add_f32 v56, v56, v1
    v_add_f32 v57, v57, v2
    v_lshlrev_b32 v1, 16, v93
    v_and_b32 v2, s54, v93
    v_add_f32 v58, v58, v1
    v_add_f32 v59, v59, v2
    v_lshlrev_b32 v1, 16, v94
    v_and_b32 v2, s54, v94
    v_add_f32 v60, v60, v1
    v_add_f32 v61, v61, v2
    v_lshlrev_b32 v1, 16, v95
    v_and_b32 v2, s54, v95
    v_add_f32 v62, v62, v1
    v_add_f32 v63, v63, v2
    s_branch L_k2_fin
L_k2_p1:
    s_cmp_lg_u32 s4, 1
    s_cbranch_scc1 L_k2_p3
    s_nop 7
    v_accvgpr_read_b32 v160, a0
    v_accvgpr_read_b32 v161, a1
    v_accvgpr_read_b32 v162, a2
    v_accvgpr_read_b32 v163, a3
    v_accvgpr_read_b32 v164, a16
    v_accvgpr_read_b32 v165, a17
    v_accvgpr_read_b32 v166, a18
    v_accvgpr_read_b32 v167, a19
    v_cvt_pk_bf16_f32 v168, v160, v161
    v_cvt_pk_bf16_f32 v169, v162, v163
    v_cvt_pk_bf16_f32 v170, v164, v165
    v_cvt_pk_bf16_f32 v171, v166, v167
    s_add_u32 s59, s62, 0
    buffer_store_dwordx4 v[168:171], v20, s[24:27], s59 offen sc1
    v_accvgpr_read_b32 v172, a32
    v_accvgpr_read_b32 v173, a33
    v_accvgpr_read_b32 v174, a34
    v_accvgpr_read_b32 v175, a35
    v_accvgpr_read_b32 v176, a48
    v_accvgpr_read_b32 v177, a49
    v_accvgpr_read_b32 v178, a50
    v_accvgpr_read_b32 v179, a51
    v_cvt_pk_bf16_f32 v180, v172, v173
    v_cvt_pk_bf16_f32 v181, v174, v175
    v_cvt_pk_bf16_f32 v182, v176, v177
    v_cvt_pk_bf16_f32 v183, v178, v179
    s_add_u32 s59, s62, 1024
    buffer_store_dwordx4 v[180:183], v20, s[24:27], s59 offen sc1
    v_accvgpr_read_b32 v160, a8
    v_accvgpr_read_b32 v161, a9
    v_accvgpr_read_b32 v162, a10
    v_accvgpr_read_b32 v163, a11
    v_accvgpr_read_b32 v164, a24
    v_accvgpr_read_b32 v165, a25
    v_accvgpr_read_b32 v166, a26
    v_accvgpr_read_b32 v167, a27
    v_cvt_pk_bf16_f32 v168, v160, v161
    v_cvt_pk_bf16_f32 v169, v162, v163
    v_cvt_pk_bf16_f32 v170, v164, v165
    v_cvt_pk_bf16_f32 v171, v166, v167
    s_add_u32 s59, s62, 131072
    buffer_store_dwordx4 v[168:171], v20, s[24:27], s59 offen sc1
    v_accvgpr_read_b32 v172, a40
    v_accvgpr_read_b32 v173, a41
    v_accvgpr_read_b32 v174, a42
    v_accvgpr_read_b32 v175, a43
    v_accvgpr_read_b32 v176, a56
    v_accvgpr_read_b32 v177, a57
    v_accvgpr_read_b32 v178, a58
    v_accvgpr_read_b32 v179, a59
    v_cvt_pk_bf16_f32 v180, v172, v173
    v_cvt_pk_bf16_f32 v181, v174, v175
    v_cvt_pk_bf16_f32 v182, v176, v177
    v_cvt_pk_bf16_f32 v183, v178, v179
    s_add_u32 s59, s62, 132096
    buffer_store_dwordx4 v[180:183], v20, s[24:27], s59 offen sc1
    v_accvgpr_read_b32 v184, a12
    v_accvgpr_read_b32 v185, a13
    v_accvgpr_read_b32 v186, a14
    v_accvgpr_read_b32 v187, a15
    v_accvgpr_read_b32 v188, a28
    v_accvgpr_read_b32 v189, a29
    v_accvgpr_read_b32 v190, a30
    v_accvgpr_read_b32 v191, a31
    v_cvt_pk_bf16_f32 v192, v184, v185
    v_cvt_pk_bf16_f32 v193, v186, v187
    v_cvt_pk_bf16_f32 v194, v188, v189
    v_cvt_pk_bf16_f32 v195, v190, v191
    s_add_u32 s59, s62, 196608
    buffer_store_dwordx4 v[192:195], v20, s[24:27], s59 offen sc1
    v_accvgpr_read_b32 v196, a44
    v_accvgpr_read_b32 v197, a45
    v_accvgpr_read_b32 v198, a46
    v_accvgpr_read_b32 v199, a47
    v_accvgpr_read_b32 v200, a60
    v_accvgpr_read_b32 v201, a61
    v_accvgpr_read_b32 v202, a62
    v_accvgpr_read_b32 v203, a63
    v_cvt_pk_bf16_f32 v204, v196, v197
    v_cvt_pk_bf16_f32 v205, v198, v199
    v_cvt_pk_bf16_f32 v206, v200, v201
    v_cvt_pk_bf16_f32 v207, v202, v203
    s_add_u32 s59, s62, 197632
    buffer_store_dwordx4 v[204:207], v20, s[24:27], s59 offen sc1
    v_accvgpr_read_b32 v32, a4
    v_accvgpr_read_b32 v33, a5
    v_accvgpr_read_b32 v34, a6
    v_accvgpr_read_b32 v35, a7
    v_accvgpr_read_b32 v36, a20
    v_accvgpr_read_b32 v37, a21
    v_accvgpr_read_b32 v38, a22
    v_accvgpr_read_b32 v39, a23
    v_accvgpr_read_b32 v40, a36
    v_accvgpr_read_b32 v41, a37
    v_accvgpr_read_b32 v42, a38
    v_accvgpr_read_b32 v43, a39
    v_accvgpr_read_b32 v44, a52
    v_accvgpr_read_b32 v45, a53
    v_accvgpr_read_b32 v46, a54
    v_accvgpr_read_b32 v47, a55
    v_mov_b32 v48, 0
    v_mov_b32 v49, 0
    v_mov_b32 v50, 0
    v_mov_b32 v51, 0
    v_mov_b32 v52, 0
    v_mov_b32 v53, 0
    v_mov_b32 v54, 0
    v_mov_b32 v55, 0
    v_mov_b32 v56, 0
    v_mov_b32 v57, 0
    v_mov_b32 v58, 0
    v_mov_b32 v59, 0
    v_mov_b32 v60, 0
    v_mov_b32 v61, 0
    v_mov_b32 v62, 0
    v_mov_b32 v63, 0
    s_waitcnt vmcnt(0)
    s_barrier
    s_lshl_b32 s52, s5, 7
    s_add_u32 s52, s52, 29360128
    s_cmp_lg_u32 s3, 0
    s_cbranch_scc1 L_k2_w1
    v_mov_b32 v1, 4
    v_mov_b32 v2, 1
    s_mov_b64 exec, 1
    buffer_store_dword v2, v1, s[24:27], s52 offen sc1
    v_mov_b32 v1, 0
    s_mov_b32 s55, 0
L_k2_poll1:
    buffer_load_dwordx4 v[4:7], v1, s[24:27], s52 offen sc1
    s_waitcnt vmcnt(0)
    v_and_b32 v4, v4, v5
    v_and_b32 v6, v6, v7
    v_and_b32 v4, v4, v6
    s_nop 0
    v_readfirstlane_b32 s53, v4
    s_nop 3
    s_cmp_eq_u32 s53, 1
    s_cbranch_scc1 L_k2_go1
    s_sleep 2
    s_add_u32 s55, s55, 1
    s_cmp_lt_u32 s55, 0x40000
    s_cbranch_scc1 L_k2_poll1
L_k2_go1:
    s_mov_b64 exec, -1
L_k2_w1:
    s_barrier
    s_lshl_b32 s52, s5, 18
    s_lshl_b32 s53, s3, 11
    s_add_u32 s52, s52, s53
    s_add_u32 s52, s52, 65536
    s_add_u32 s53, s52, 0
    buffer_load_dwordx4 v[64:67], v20, s[24:27], s53 offen sc1
    s_add_u32 s53, s52, 1024
    buffer_load_dwordx4 v[68:71], v20, s[24:27], s53 offen sc1
    s_add_u32 s53, s52, 32768
    buffer_load_dwordx4 v[72:75], v20, s[24:27], s53 offen sc1
    s_add_u32 s53, s52, 33792
    buffer_load_dwordx4 v[76:79], v20, s[24:27], s53 offen sc1
    s_add_u32 s53, s52, 40960
    buffer_load_dwordx4 v[80:83], v20, s[24:27], s53 offen sc1
    s_add_u32 s53, s52, 41984
    buffer_load_dwordx4 v[84:87], v20, s[24:27], s53 offen sc1
    s_add_u32 s53, s52, 57344
    buffer_load_dwordx4 v[88:91], v20, s[24:27], s53 offen sc1
    s_add_u32 s53, s52, 58368
    buffer_load_dwordx4 v[92:95], v20, s[24:27], s53 offen sc1
    s_mov_b32 s54, 0xffff0000
    s_waitcnt vmcnt(6)
    v_lshlrev_b32 v1, 16, v64
    v_and_b32 v2, s54, v64
    v_add_f32 v32, v32, v1
    v_add_f32 v33, v33, v2
    v_lshlrev_b32 v1, 16, v65
    v_and_b32 v2, s54, v65
    v_add_f32 v34, v34, v1
    v_add_f32 v35, v35, v2
    v_lshlrev_b32 v1, 16, v66
    v_and_b32 v2, s54, v66
    v_add_f32 v36, v36, v1
    v_add_f32 v37, v37, v2
    v_lshlrev_b32 v1, 16, v67
    v_and_b32 v2, s54, v67
    v_add_f32 v38, v38, v1
    v_add_f32 v39, v39, v2
    v_lshlrev_b32 v1, 16, v68
    v_and_b32 v2, s54, v68
    v_add_f32 v40, v40, v1
    v_add_f32 v41, v41, v2
    v_lshlrev_b32 v1, 16, v69
    v_and_b32 v2, s54, v69
    v_add_f32 v42, v42, v1
    v_add_f32 v43, v43, v2
    v_lshlrev_b32 v1, 16, v70
    v_and_b32 v2, s54, v70
    v_add_f32 v44, v44, v1
    v_add_f32 v45, v45, v2
    v_lshlrev_b32 v1, 16, v71
    v_and_b32 v2, s54, v71
    v_add_f32 v46, v46, v1
    v_add_f32 v47, v47, v2
    s_waitcnt vmcnt(4)
    v_lshlrev_b32 v1, 16, v72
    v_and_b32 v2, s54, v72
    v_add_f32 v32, v32, v1
    v_add_f32 v33, v33, v2
    v_lshlrev_b32 v1, 16, v73
    v_and_b32 v2, s54, v73
    v_add_f32 v34, v34, v1
    v_add_f32 v35, v35, v2
    v_lshlrev_b32 v1, 16, v74
    v_and_b32 v2, s54, v74
    v_add_f32 v36, v36, v1
    v_add_f32 v37, v37, v2
    v_lshlrev_b32 v1, 16, v75
    v_and_b32 v2, s54, v75
    v_add_f32 v38, v38, v1
    v_add_f32 v39, v39, v2
    v_lshlrev_b32 v1, 16, v76
    v_and_b32 v2, s54, v76
    v_add_f32 v40, v40, v1
    v_add_f32 v41, v41, v2
    v_lshlrev_b32 v1, 16, v77
    v_and_b32 v2, s54, v77
    v_add_f32 v42, v42, v1
    v_add_f32 v43, v43, v2
    v_lshlrev_b32 v1, 16, v78
    v_and_b32 v2, s54, v78
    v_add_f32 v44, v44, v1
    v_add_f32 v45, v45, v2
    v_lshlrev_b32 v1, 16, v79
    v_and_b32 v2, s54, v79
    v_add_f32 v46, v46, v1
    v_add_f32 v47, v47, v2
    s_waitcnt vmcnt(2)
    v_lshlrev_b32 v1, 16, v80
    v_and_b32 v2, s54, v80
    v_add_f32 v48, v48, v1
    v_add_f32 v49, v49, v2
    v_lshlrev_b32 v1, 16, v81
    v_and_b32 v2, s54, v81
    v_add_f32 v50, v50, v1
    v_add_f32 v51, v51, v2
    v_lshlrev_b32 v1, 16, v82
    v_and_b32 v2, s54, v82
    v_add_f32 v52, v52, v1
    v_add_f32 v53, v53, v2
    v_lshlrev_b32 v1, 16, v83
    v_and_b32 v2, s54, v83
    v_add_f32 v54, v54, v1
    v_add_f32 v55, v55, v2
    v_lshlrev_b32 v1, 16, v84
    v_and_b32 v2, s54, v84
    v_add_f32 v56, v56, v1
    v_add_f32 v57, v57, v2
    v_lshlrev_b32 v1, 16, v85
    v_and_b32 v2, s54, v85
    v_add_f32 v58, v58, v1
    v_add_f32 v59, v59, v2
    v_lshlrev_b32 v1, 16, v86
    v_and_b32 v2, s54, v86
    v_add_f32 v60, v60, v1
    v_add_f32 v61, v61, v2
    v_lshlrev_b32 v1, 16, v87
    v_and_b32 v2, s54, v87
    v_add_f32 v62, v62, v1
    v_add_f32 v63, v63, v2
    s_waitcnt vmcnt(0)
    v_lshlrev_b32 v1, 16, v88
    v_and_b32 v2, s54, v88
    v_add_f32 v48, v48, v1
    v_add_f32 v49, v49, v2
    v_lshlrev_b32 v1, 16, v89
    v_and_b32 v2, s54, v89
    v_add_f32 v50, v50, v1
    v_add_f32 v51, v51, v2
    v_lshlrev_b32 v1, 16, v90
    v_and_b32 v2, s54, v90
    v_add_f32 v52, v52, v1
    v_add_f32 v53, v53, v2
    v_lshlrev_b32 v1, 16, v91
    v_and_b32 v2, s54, v91
    v_add_f32 v54, v54, v1
    v_add_f32 v55, v55, v2
    v_lshlrev_b32 v1, 16, v92
    v_and_b32 v2, s54, v92
    v_add_f32 v56, v56, v1
    v_add_f32 v57, v57, v2
    v_lshlrev_b32 v1, 16, v93
    v_and_b32 v2, s54, v93
    v_add_f32 v58, v58, v1
    v_add_f32 v59, v59, v2
    v_lshlrev_b32 v1, 16, v94
    v_and_b32 v2, s54, v94
    v_add_f32 v60, v60, v1
    v_add_f32 v61, v61, v2
    v_lshlrev_b32 v1, 16, v95
    v_and_b32 v2, s54, v95
    v_add_f32 v62, v62, v1
    v_add_f32 v63, v63, v2
    s_branch L_k2_fin
L_k2_p2:
    s_nop 7
    v_accvgpr_read_b32 v160, a64
    v_accvgpr_read_b32 v161, a65
    v_accvgpr_read_b32 v162, a66
    v_accvgpr_read_b32 v163, a67
    v_accvgpr_read_b32 v164, a80
    v_accvgpr_read_b32 v165, a81
    v_accvgpr_read_b32 v166, a82
    v_accvgpr_read_b32 v167, a83
    v_cvt_pk_bf16_f32 v168, v160, v161
    v_cvt_pk_bf16_f32 v169, v162, v163
    v_cvt_pk_bf16_f32 v170, v164, v165
    v_cvt_pk_bf16_f32 v171, v166, v167
    s_add_u32 s59, s62, 8192
    buffer_store_dwordx4 v[168:171], v20, s[24:27], s59 offen sc1
    v_accvgpr_read_b32 v172, a96
    v_accvgpr_read_b32 v173, a97
    v_accvgpr_read_b32 v174, a98
    v_accvgpr_read_b32 v175, a99
    v_accvgpr_read_b32 v176, a112
    v_accvgpr_read_b32 v177, a113
    v_accvgpr_read_b32 v178, a114
    v_accvgpr_read_b32 v179, a115
    v_cvt_pk_bf16_f32 v180, v172, v173
    v_cvt_pk_bf16_f32 v181, v174, v175
    v_cvt_pk_bf16_f32 v182, v176, v177
    v_cvt_pk_bf16_f32 v183, v178, v179
    s_add_u32 s59, s62, 9216
    buffer_store_dwordx4 v[180:183], v20, s[24:27], s59 offen sc1
    v_accvgpr_read_b32 v184, a68
    v_accvgpr_read_b32 v185, a69
    v_accvgpr_read_b32 v186, a70
    v_accvgpr_read_b32 v187, a71
    v_accvgpr_read_b32 v188, a84
    v_accvgpr_read_b32 v189, a85
    v_accvgpr_read_b32 v190, a86
    v_accvgpr_read_b32 v191, a87
    v_cvt_pk_bf16_f32 v192, v184, v185
    v_cvt_pk_bf16_f32 v193, v186, v187
    v_cvt_pk_bf16_f32 v194, v188, v189
    v_cvt_pk_bf16_f32 v195, v190, v191
    s_add_u32 s59, s62, 73728
    buffer_store_dwordx4 v[192:195], v20, s[24:27], s59 offen sc1
    v_accvgpr_read_b32 v196, a100
    v_accvgpr_read_b32 v197, a101
    v_accvgpr_read_b32 v198, a102
    v_accvgpr_read_b32 v199, a103
    v_accvgpr_read_b32 v200, a116
    v_accvgpr_read_b32 v201, a117
    v_accvgpr_read_b32 v202, a118
    v_accvgpr_read_b32 v203, a119
    v_cvt_pk_bf16_f32 v204, v196, v197
    v_cvt_pk_bf16_f32 v205, v198, v199
    v_cvt_pk_bf16_f32 v206, v200, v201
    v_cvt_pk_bf16_f32 v207, v202, v203
    s_add_u32 s59, s62, 74752
    buffer_store_dwordx4 v[204:207], v20, s[24:27], s59 offen sc1
    v_accvgpr_read_b32 v184, a76
    v_accvgpr_read_b32 v185, a77
    v_accvgpr_read_b32 v186, a78
    v_accvgpr_read_b32 v187, a79
    v_accvgpr_read_b32 v188, a92
    v_accvgpr_read_b32 v189, a93
    v_accvgpr_read_b32 v190, a94
    v_accvgpr_read_b32 v191, a95
    v_cvt_pk_bf16_f32 v192, v184, v185
    v_cvt_pk_bf16_f32 v193, v186, v187
    v_cvt_pk_bf16_f32 v194, v188, v189
    v_cvt_pk_bf16_f32 v195, v190, v191
    s_add_u32 s59, s62, 204800
    buffer_store_dwordx4 v[192:195], v20, s[24:27], s59 offen sc1
    v_accvgpr_read_b32 v196, a108
    v_accvgpr_read_b32 v197, a109
    v_accvgpr_read_b32 v198, a110
    v_accvgpr_read_b32 v199, a111
    v_accvgpr_read_b32 v200, a124
    v_accvgpr_read_b32 v201, a125
    v_accvgpr_read_b32 v202, a126
    v_accvgpr_read_b32 v203, a127
    v_cvt_pk_bf16_f32 v204, v196, v197
    v_cvt_pk_bf16_f32 v205, v198, v199
    v_cvt_pk_bf16_f32 v206, v200, v201
    v_cvt_pk_bf16_f32 v207, v202, v203
    s_add_u32 s59, s62, 205824
    buffer_store_dwordx4 v[204:207], v20, s[24:27], s59 offen sc1
    v_accvgpr_read_b32 v32, a8
    v_accvgpr_read_b32 v33, a9
    v_accvgpr_read_b32 v34, a10
    v_accvgpr_read_b32 v35, a11
    v_accvgpr_read_b32 v36, a24
    v_accvgpr_read_b32 v37, a25
    v_accvgpr_read_b32 v38, a26
    v_accvgpr_read_b32 v39, a27
    v_accvgpr_read_b32 v40, a40
    v_accvgpr_read_b32 v41, a41
    v_accvgpr_read_b32 v42, a42
    v_accvgpr_read_b32 v43, a43
    v_accvgpr_read_b32 v44, a56
    v_accvgpr_read_b32 v45, a57
    v_accvgpr_read_b32 v46, a58
    v_accvgpr_read_b32 v47, a59
    v_accvgpr_read_b32 v48, a72
    v_accvgpr_read_b32 v49, a73
    v_accvgpr_read_b32 v50, a74
    v_accvgpr_read_b32 v51, a75
    v_accvgpr_read_b32 v52, a88
    v_accvgpr_read_b32 v53, a89
    v_accvgpr_read_b32 v54, a90
    v_accvgpr_read_b32 v55, a91
    v_accvgpr_read_b32 v56, a104
    v_accvgpr_read_b32 v57, a105
    v_accvgpr_read_b32 v58, a106
    v_accvgpr_read_b32 v59, a107
    v_accvgpr_read_b32 v60, a120
    v_accvgpr_read_b32 v61, a121
    v_accvgpr_read_b32 v62, a122
    v_accvgpr_read_b32 v63, a123
    s_waitcnt vmcnt(0)
    s_barrier
    s_lshl_b32 s52, s5, 7
    s_add_u32 s52, s52, 29360128
    s_cmp_lg_u32 s3, 0
    s_cbranch_scc1 L_k2_w2
    v_mov_b32 v1, 8
    v_mov_b32 v2, 1
    s_mov_b64 exec, 1
    buffer_store_dword v2, v1, s[24:27], s52 offen sc1
    v_mov_b32 v1, 0
    s_mov_b32 s55, 0
L_k2_poll2:
    buffer_load_dwordx4 v[4:7], v1, s[24:27], s52 offen sc1
    s_waitcnt vmcnt(0)
    v_and_b32 v4, v4, v5
    v_and_b32 v6, v6, v7
    v_and_b32 v4, v4, v6
    s_nop 0
    v_readfirstlane_b32 s53, v4
    s_nop 3
    s_cmp_eq_u32 s53, 1
    s_cbranch_scc1 L_k2_go2
    s_sleep 2
    s_add_u32 s55, s55, 1
    s_cmp_lt_u32 s55, 0x40000
    s_cbranch_scc1 L_k2_poll2
L_k2_go2:
    s_mov_b64 exec, -1
L_k2_w2:
    s_barrier
    s_lshl_b32 s52, s5, 18
    s_lshl_b32 s53, s3, 11
    s_add_u32 s52, s52, s53
    s_add_u32 s52, s52, 131072
    s_add_u32 s53, s52, 0
    buffer_load_dwordx4 v[64:67], v20, s[24:27], s53 offen sc1
    s_add_u32 s53, s52, 1024
    buffer_load_dwordx4 v[68:71], v20, s[24:27], s53 offen sc1
    s_add_u32 s53, s52, 16384
    buffer_load_dwordx4 v[72:75], v20, s[24:27], s53 offen sc1
    s_add_u32 s53, s52, 17408
    buffer_load_dwordx4 v[76:79], v20, s[24:27], s53 offen sc1
    s_add_u32 s53, s52, 57344
    buffer_load_dwordx4 v[80:83], v20, s[24:27], s53 offen sc1
    s_add_u32 s53, s52, 58368
    buffer_load_dwordx4 v[84:87], v20, s[24:27], s53 offen sc1
    s_mov_b32 s54, 0xffff0000
    s_waitcnt vmcnt(4)
    v_lshlrev_b32 v1, 16, v64
    v_and_b32 v2, s54, v64
    v_add_f32 v32, v32, v1
    v_add_f32 v33, v33, v2
    v_lshlrev_b32 v1, 16, v65
    v_and_b32 v2, s54, v65
    v_add_f32 v34, v34, v1
    v_add_f32 v35, v35, v2
    v_lshlrev_b32 v1, 16, v66
    v_and_b32 v2, s54, v66
    v_add_f32 v36, v36, v1
    v_add_f32 v37, v37, v2
    v_lshlrev_b32 v1, 16, v67
    v_and_b32 v2, s54, v67
    v_add_f32 v38, v38, v1
    v_add_f32 v39, v39, v2
    v_lshlrev_b32 v1, 16, v68
    v_and_b32 v2, s54, v68
    v_add_f32 v40, v40, v1
    v_add_f32 v41, v41, v2
    v_lshlrev_b32 v1, 16, v69
    v_and_b32 v2, s54, v69
    v_add_f32 v42, v42, v1
    v_add_f32 v43, v43, v2
    v_lshlrev_b32 v1, 16, v70
    v_and_b32 v2, s54, v70
    v_add_f32 v44, v44, v1
    v_add_f32 v45, v45, v2
    v_lshlrev_b32 v1, 16, v71
    v_and_b32 v2, s54, v71
    v_add_f32 v46, v46, v1
    v_add_f32 v47, v47, v2
    s_waitcnt vmcnt(2)
    v_lshlrev_b32 v1, 16, v72
    v_and_b32 v2, s54, v72
    v_add_f32 v32, v32, v1
    v_add_f32 v33, v33, v2
    v_lshlrev_b32 v1, 16, v73
    v_and_b32 v2, s54, v73
    v_add_f32 v34, v34, v1
    v_add_f32 v35, v35, v2
    v_lshlrev_b32 v1, 16, v74
    v_and_b32 v2, s54, v74
    v_add_f32 v36, v36, v1
    v_add_f32 v37, v37, v2
    v_lshlrev_b32 v1, 16, v75
    v_and_b32 v2, s54, v75
    v_add_f32 v38, v38, v1
    v_add_f32 v39, v39, v2
    v_lshlrev_b32 v1, 16, v76
    v_and_b32 v2, s54, v76
    v_add_f32 v40, v40, v1
    v_add_f32 v41, v41, v2
    v_lshlrev_b32 v1, 16, v77
    v_and_b32 v2, s54, v77
    v_add_f32 v42, v42, v1
    v_add_f32 v43, v43, v2
    v_lshlrev_b32 v1, 16, v78
    v_and_b32 v2, s54, v78
    v_add_f32 v44, v44, v1
    v_add_f32 v45, v45, v2
    v_lshlrev_b32 v1, 16, v79
    v_and_b32 v2, s54, v79
    v_add_f32 v46, v46, v1
    v_add_f32 v47, v47, v2
    s_waitcnt vmcnt(0)
    v_lshlrev_b32 v1, 16, v80
    v_and_b32 v2, s54, v80
    v_add_f32 v48, v48, v1
    v_add_f32 v49, v49, v2
    v_lshlrev_b32 v1, 16, v81
    v_and_b32 v2, s54, v81
    v_add_f32 v50, v50, v1
    v_add_f32 v51, v51, v2
    v_lshlrev_b32 v1, 16, v82
    v_and_b32 v2, s54, v82
    v_add_f32 v52, v52, v1
    v_add_f32 v53, v53, v2
    v_lshlrev_b32 v1, 16, v83
    v_and_b32 v2, s54, v83
    v_add_f32 v54, v54, v1
    v_add_f32 v55, v55, v2
    v_lshlrev_b32 v1, 16, v84
    v_and_b32 v2, s54, v84
    v_add_f32 v56, v56, v1
    v_add_f32 v57, v57, v2
    v_lshlrev_b32 v1, 16, v85
    v_and_b32 v2, s54, v85
    v_add_f32 v58, v58, v1
    v_add_f32 v59, v59, v2
    v_lshlrev_b32 v1, 16, v86
    v_and_b32 v2, s54, v86
    v_add_f32 v60, v60, v1
    v_add_f32 v61, v61, v2
    v_lshlrev_b32 v1, 16, v87
    v_and_b32 v2, s54, v87
    v_add_f32 v62, v62, v1
    v_add_f32 v63, v63, v2
    s_branch L_k2_fin
L_k2_p3:
    s_nop 7
    v_accvgpr_read_b32 v160, a0
    v_accvgpr_read_b32 v161, a1
    v_accvgpr_read_b32 v162, a2
    v_accvgpr_read_b32 v163, a3
    v_accvgpr_read_b32 v164, a16
    v_accvgpr_read_b32 v165, a17
    v_accvgpr_read_b32 v166, a18
    v_accvgpr_read_b32 v167, a19
    v_cvt_pk_bf16_f32 v168, v160, v161
    v_cvt_pk_bf16_f32 v169, v162, v163
    v_cvt_pk_bf16_f32 v170, v164, v165
    v_cvt_pk_bf16_f32 v171, v166, v167
    s_add_u32 s59, s62, 8192
    buffer_store_dwordx4 v[168:171], v20, s[24:27], s59 offen sc1
    v_accvgpr_read_b32 v172, a32
    v_accvgpr_read_b32 v173, a33
    v_accvgpr_read_b32 v174, a34
    v_accvgpr_read_b32 v175, a35
    v_accvgpr_read_b32 v176, a48
    v_accvgpr_read_b32 v177, a49
    v_accvgpr_read_b32 v178, a50
    v_accvgpr_read_b32 v179, a51
    v_cvt_pk_bf16_f32 v180, v172, v173
    v_cvt_pk_bf16_f32 v181, v174, v175
    v_cvt_pk_bf16_f32 v182, v176, v177
    v_cvt_pk_bf16_f32 v183, v178, v179
    s_add_u32 s59, s62, 9216
    buffer_store_dwordx4 v[180:183], v20, s[24:27], s59 offen sc1
    v_accvgpr_read_b32 v184, a4
    v_accvgpr_read_b32 v185, a5
    v_accvgpr_read_b32 v186, a6
    v_accvgpr_read_b32 v187, a7
    v_accvgpr_read_b32 v188, a20
    v_accvgpr_read_b32 v189, a21
    v_accvgpr_read_b32 v190, a22
    v_accvgpr_read_b32 v191, a23
    v_cvt_pk_bf16_f32 v192, v184, v185
    v_cvt_pk_bf16_f32 v193, v186, v187
    v_cvt_pk_bf16_f32 v194, v188, v189
    v_cvt_pk_bf16_f32 v195, v190, v191
    s_add_u32 s59, s62, 73728
    buffer_store_dwordx4 v[192:195], v20, s[24:27], s59 offen sc1
    v_accvgpr_read_b32 v196, a36
    v_accvgpr_read_b32 v197, a37
    v_accvgpr_read_b32 v198, a38
    v_accvgpr_read_b32 v199, a39
    v_accvgpr_read_b32 v200, a52
    v_accvgpr_read_b32 v201, a53
    v_accvgpr_read_b32 v202, a54
    v_accvgpr_read_b32 v203, a55
    v_cvt_pk_bf16_f32 v204, v196, v197
    v_cvt_pk_bf16_f32 v205, v198, v199
    v_cvt_pk_bf16_f32 v206, v200, v201
    v_cvt_pk_bf16_f32 v207, v202, v203
    s_add_u32 s59, s62, 74752
    buffer_store_dwordx4 v[204:207], v20, s[24:27], s59 offen sc1
    v_accvgpr_read_b32 v160, a8
    v_accvgpr_read_b32 v161, a9
    v_accvgpr_read_b32 v162, a10
    v_accvgpr_read_b32 v163, a11
    v_accvgpr_read_b32 v164, a24
    v_accvgpr_read_b32 v165, a25
    v_accvgpr_read_b32 v166, a26
    v_accvgpr_read_b32 v167, a27
    v_cvt_pk_bf16_f32 v168, v160, v161
    v_cvt_pk_bf16_f32 v169, v162, v163
    v_cvt_pk_bf16_f32 v170, v164, v165
    v_cvt_pk_bf16_f32 v171, v166, v167
    s_add_u32 s59, s62, 139264
    buffer_store_dwordx4 v[168:171], v20, s[24:27], s59 offen sc1
    v_accvgpr_read_b32 v172, a40
    v_accvgpr_read_b32 v173, a41
    v_accvgpr_read_b32 v174, a42
    v_accvgpr_read_b32 v175, a43
    v_accvgpr_read_b32 v176, a56
    v_accvgpr_read_b32 v177, a57
    v_accvgpr_read_b32 v178, a58
    v_accvgpr_read_b32 v179, a59
    v_cvt_pk_bf16_f32 v180, v172, v173
    v_cvt_pk_bf16_f32 v181, v174, v175
    v_cvt_pk_bf16_f32 v182, v176, v177
    v_cvt_pk_bf16_f32 v183, v178, v179
    s_add_u32 s59, s62, 140288
    buffer_store_dwordx4 v[180:183], v20, s[24:27], s59 offen sc1
    v_accvgpr_read_b32 v48, a12
    v_accvgpr_read_b32 v49, a13
    v_accvgpr_read_b32 v50, a14
    v_accvgpr_read_b32 v51, a15
    v_accvgpr_read_b32 v52, a28
    v_accvgpr_read_b32 v53, a29
    v_accvgpr_read_b32 v54, a30
    v_accvgpr_read_b32 v55, a31
    v_accvgpr_read_b32 v56, a44
    v_accvgpr_read_b32 v57, a45
    v_accvgpr_read_b32 v58, a46
    v_accvgpr_read_b32 v59, a47
    v_accvgpr_read_b32 v60, a60
    v_accvgpr_read_b32 v61, a61
    v_accvgpr_read_b32 v62, a62
    v_accvgpr_read_b32 v63, a63
    v_mov_b32 v32, 0
    v_mov_b32 v33, 0
    v_mov_b32 v34, 0
    v_mov_b32 v35, 0
    v_mov_b32 v36, 0
    v_mov_b32 v37, 0
    v_mov_b32 v38, 0
    v_mov_b32 v39, 0
    v_mov_b32 v40, 0
    v_mov_b32 v41, 0
    v_mov_b32 v42, 0
    v_mov_b32 v43, 0
    v_mov_b32 v44, 0
    v_mov_b32 v45, 0
    v_mov_b32 v46, 0
    v_mov_b32 v47, 0
    s_waitcnt vmcnt(0)
    s_barrier
    s_lshl_b32 s52, s5, 7
    s_add_u32 s52, s52, 29360128
    s_cmp_lg_u32 s3, 0
    s_cbranch_scc1 L_k2_w3
    v_mov_b32 v1, 12
    v_mov_b32 v2, 1
    s_mov_b64 exec, 1
    buffer_store_dword v2, v1, s[24:27], s52 offen sc1
    v_mov_b32 v1, 0
    s_mov_b32 s55, 0
L_k2_poll3:
    buffer_load_dwordx4 v[4:7], v1, s[24:27], s52 offen sc1
    s_waitcnt vmcnt(0)
    v_and_b32 v4, v4, v5
    v_and_b32 v6, v6, v7
    v_and_b32 v4, v4, v6
    s_nop 0
    v_readfirstlane_b32 s53, v4
    s_nop 3
    s_cmp_eq_u32 s53, 1
    s_cbranch_scc1 L_k2_go3
    s_sleep 2
    s_add_u32 s55, s55, 1
    s_cmp_lt_u32 s55, 0x40000
    s_cbranch_scc1 L_k2_poll3
L_k2_go3:
    s_mov_b64 exec, -1
L_k2_w3:
    s_barrier
    s_lshl_b32 s52, s5, 18
    s_lshl_b32 s53, s3, 11
    s_add_u32 s52, s52, s53
    s_add_u32 s52, s52, 196608
    s_add_u32 s53, s52, 0
    buffer_load_dwordx4 v[64:67], v20, s[24:27], s53 offen sc1
    s_add_u32 s53, s52, 1024
    buffer_load_dwordx4 v[68:71], v20, s[24:27], s53 offen sc1
    s_add_u32 s53, s52, 16384
    buffer_load_dwordx4 v[72:75], v20, s[24:27], s53 offen sc1
    s_add_u32 s53, s52, 17408
    buffer_load_dwordx4 v[76:79], v20, s[24:27], s53 offen sc1
    s_add_u32 s53, s52, 32768
    buffer_load_dwordx4 v[80:83], v20, s[24:27], s53 offen sc1
    s_add_u32 s53, s52, 33792
    buffer_load_dwordx4 v[84:87], v20, s[24:27], s53 offen sc1
    s_add_u32 s53, s52, 40960
    buffer_load_dwordx4 v[88:91], v20, s[24:27], s53 offen sc1
    s_add_u32 s53, s52, 41984
    buffer_load_dwordx4 v[92:95], v20, s[24:27], s53 offen sc1
    s_mov_b32 s54, 0xffff0000
    s_waitcnt vmcnt(6)
    v_lshlrev_b32 v1, 16, v64
    v_and_b32 v2, s54, v64
    v_add_f32 v32, v32, v1
    v_add_f32 v33, v33, v2
    v_lshlrev_b32 v1, 16, v65
    v_and_b32 v2, s54, v65
    v_add_f32 v34, v34, v1
    v_add_f32 v35, v35, v2
    v_lshlrev_b32 v1, 16, v66
    v_and_b32 v2, s54, v66
    v_add_f32 v36, v36, v1
    v_add_f32 v37, v37, v2
    v_lshlrev_b32 v1, 16, v67
    v_and_b32 v2, s54, v67
    v_add_f32 v38, v38, v1
    v_add_f32 v39, v39, v2
    v_lshlrev_b32 v1, 16, v68
    v_and_b32 v2, s54, v68
    v_add_f32 v40, v40, v1
    v_add_f32 v41, v41, v2
    v_lshlrev_b32 v1, 16, v69
    v_and_b32 v2, s54, v69
    v_add_f32 v42, v42, v1
    v_add_f32 v43, v43, v2
    v_lshlrev_b32 v1, 16, v70
    v_and_b32 v2, s54, v70
    v_add_f32 v44, v44, v1
    v_add_f32 v45, v45, v2
    v_lshlrev_b32 v1, 16, v71
    v_and_b32 v2, s54, v71
    v_add_f32 v46, v46, v1
    v_add_f32 v47, v47, v2
    s_waitcnt vmcnt(4)
    v_lshlrev_b32 v1, 16, v72
    v_and_b32 v2, s54, v72
    v_add_f32 v32, v32, v1
    v_add_f32 v33, v33, v2
    v_lshlrev_b32 v1, 16, v73
    v_and_b32 v2, s54, v73
    v_add_f32 v34, v34, v1
    v_add_f32 v35, v35, v2
    v_lshlrev_b32 v1, 16, v74
    v_and_b32 v2, s54, v74
    v_add_f32 v36, v36, v1
    v_add_f32 v37, v37, v2
    v_lshlrev_b32 v1, 16, v75
    v_and_b32 v2, s54, v75
    v_add_f32 v38, v38, v1
    v_add_f32 v39, v39, v2
    v_lshlrev_b32 v1, 16, v76
    v_and_b32 v2, s54, v76
    v_add_f32 v40, v40, v1
    v_add_f32 v41, v41, v2
    v_lshlrev_b32 v1, 16, v77
    v_and_b32 v2, s54, v77
    v_add_f32 v42, v42, v1
    v_add_f32 v43, v43, v2
    v_lshlrev_b32 v1, 16, v78
    v_and_b32 v2, s54, v78
    v_add_f32 v44, v44, v1
    v_add_f32 v45, v45, v2
    v_lshlrev_b32 v1, 16, v79
    v_and_b32 v2, s54, v79
    v_add_f32 v46, v46, v1
    v_add_f32 v47, v47, v2
    s_waitcnt vmcnt(2)
    v_lshlrev_b32 v1, 16, v80
    v_and_b32 v2, s54, v80
    v_add_f32 v32, v32, v1
    v_add_f32 v33, v33, v2
    v_lshlrev_b32 v1, 16, v81
    v_and_b32 v2, s54, v81
    v_add_f32 v34, v34, v1
    v_add_f32 v35, v35, v2
    v_lshlrev_b32 v1, 16, v82
    v_and_b32 v2, s54, v82
    v_add_f32 v36, v36, v1
    v_add_f32 v37, v37, v2
    v_lshlrev_b32 v1, 16, v83
    v_and_b32 v2, s54, v83
    v_add_f32 v38, v38, v1
    v_add_f32 v39, v39, v2
    v_lshlrev_b32 v1, 16, v84
    v_and_b32 v2, s54, v84
    v_add_f32 v40, v40, v1
    v_add_f32 v41, v41, v2
    v_lshlrev_b32 v1, 16, v85
    v_and_b32 v2, s54, v85
    v_add_f32 v42, v42, v1
    v_add_f32 v43, v43, v2
    v_lshlrev_b32 v1, 16, v86
    v_and_b32 v2, s54, v86
    v_add_f32 v44, v44, v1
    v_add_f32 v45, v45, v2
    v_lshlrev_b32 v1, 16, v87
    v_and_b32 v2, s54, v87
    v_add_f32 v46, v46, v1
    v_add_f32 v47, v47, v2
    s_waitcnt vmcnt(0)
    v_lshlrev_b32 v1, 16, v88
    v_and_b32 v2, s54, v88
    v_add_f32 v48, v48, v1
    v_add_f32 v49, v49, v2
    v_lshlrev_b32 v1, 16, v89
    v_and_b32 v2, s54, v89
    v_add_f32 v50, v50, v1
    v_add_f32 v51, v51, v2
    v_lshlrev_b32 v1, 16, v90
    v_and_b32 v2, s54, v90
    v_add_f32 v52, v52, v1
    v_add_f32 v53, v53, v2
    v_lshlrev_b32 v1, 16, v91
    v_and_b32 v2, s54, v91
    v_add_f32 v54, v54, v1
    v_add_f32 v55, v55, v2
    v_lshlrev_b32 v1, 16, v92
    v_and_b32 v2, s54, v92
    v_add_f32 v56, v56, v1
    v_add_f32 v57, v57, v2
    v_lshlrev_b32 v1, 16, v93
    v_and_b32 v2, s54, v93
    v_add_f32 v58, v58, v1
    v_add_f32 v59, v59, v2
    v_lshlrev_b32 v1, 16, v94
    v_and_b32 v2, s54, v94
    v_add_f32 v60, v60, v1
    v_add_f32 v61, v61, v2
    v_lshlrev_b32 v1, 16, v95
    v_and_b32 v2, s54, v95
    v_add_f32 v62, v62, v1
    v_add_f32 v63, v63, v2
L_k2_fin:
    s_mov_b32 s54, 0xffff0000
    v_mul_f32 v48, 0x4275fdf0, v48
    v_mul_f32 v49, 0x4275fdf0, v49
    v_mul_f32 v50, 0x4275fdf0, v50
    v_mul_f32 v51, 0x4275fdf0, v51
    v_mul_f32 v160, 0xbfb8aa3b, v48
    v_mul_f32 v161, 0xbfb8aa3b, v49
    v_mul_f32 v162, 0xbfb8aa3b, v50
    v_mul_f32 v163, 0xbfb8aa3b, v51
    v_exp_f32 v160, v160
    v_exp_f32 v161, v161
    v_exp_f32 v162, v162
    v_exp_f32 v163, v163
    v_add_f32 v160, 1.0, v160
    v_add_f32 v161, 1.0, v161
    v_add_f32 v162, 1.0, v162
    v_add_f32 v163, 1.0, v163
    v_rcp_f32 v160, v160
    v_rcp_f32 v161, v161
    v_rcp_f32 v162, v162
    v_rcp_f32 v163, v163
    v_lshlrev_b32 v164, 16, v24
    v_and_b32 v165, s54, v24
    v_lshlrev_b32 v166, 16, v25
    v_and_b32 v167, s54, v25
    v_mul_f32 v160, v48, v160
    v_mul_f32 v161, v49, v161
    v_mul_f32 v162, v50, v162
    v_mul_f32 v163, v51, v163
    v_fma_f32 v164, v32, v160, v164
    v_fma_f32 v165, v33, v161, v165
    v_fma_f32 v166, v34, v162, v166
    v_fma_f32 v167, v35, v163, v167
    v_cvt_pk_bf16_f32 v176, v164, v165
    v_cvt_pk_bf16_f32 v177, v166, v167
    buffer_store_dwordx2 v[176:177], v21, s[20:23], s63 offen offset:0
    v_mul_f32 v52, 0x4275fdf0, v52
    v_mul_f32 v53, 0x4275fdf0, v53
    v_mul_f32 v54, 0x4275fdf0, v54
    v_mul_f32 v55, 0x4275fdf0, v55
    v_mul_f32 v160, 0xbfb8aa3b, v52
    v_mul_f32 v161, 0xbfb8aa3b, v53
    v_mul_f32 v162, 0xbfb8aa3b, v54
    v_mul_f32 v163, 0xbfb8aa3b, v55
    v_exp_f32 v160, v160
    v_exp_f32 v161, v161
    v_exp_f32 v162, v162
    v_exp_f32 v163, v163
    v_add_f32 v160, 1.0, v160
    v_add_f32 v161, 1.0, v161
    v_add_f32 v162, 1.0, v162
    v_add_f32 v163, 1.0, v163
    v_rcp_f32 v160, v160
    v_rcp_f32 v161, v161
    v_rcp_f32 v162, v162
    v_rcp_f32 v163, v163
    v_lshlrev_b32 v164, 16, v26
    v_and_b32 v165, s54, v26
    v_lshlrev_b32 v166, 16, v27
    v_and_b32 v167, s54, v27
    v_mul_f32 v160, v52, v160
    v_mul_f32 v161, v53, v161
    v_mul_f32 v162, v54, v162
    v_mul_f32 v163, v55, v163
    v_fma_f32 v164, v36, v160, v164
    v_fma_f32 v165, v37, v161, v165
    v_fma_f32 v166, v38, v162, v166
    v_fma_f32 v167, v39, v163, v167
    v_cvt_pk_bf16_f32 v178, v164, v165
    v_cvt_pk_bf16_f32 v179, v166, v167
    buffer_store_dwordx2 v[178:179], v21, s[20:23], s63 offen offset:32
    v_mul_f32 v56, 0x4275fdf0, v56
    v_mul_f32 v57, 0x4275fdf0, v57
    v_mul_f32 v58, 0x4275fdf0, v58
    v_mul_f32 v59, 0x4275fdf0, v59
    v_mul_f32 v160, 0xbfb8aa3b, v56
    v_mul_f32 v161, 0xbfb8aa3b, v57
    v_mul_f32 v162, 0xbfb8aa3b, v58
    v_mul_f32 v163, 0xbfb8aa3b, v59
    v_exp_f32 v160, v160
    v_exp_f32 v161, v161
    v_exp_f32 v162, v162
    v_exp_f32 v163, v163
    v_add_f32 v160, 1.0, v160
    v_add_f32 v161, 1.0, v161
    v_add_f32 v162, 1.0, v162
    v_add_f32 v163, 1.0, v163
    v_rcp_f32 v160, v160
    v_rcp_f32 v161, v161
    v_rcp_f32 v162, v162
    v_rcp_f32 v163, v163
    v_lshlrev_b32 v164, 16, v28
    v_and_b32 v165, s54, v28
    v_lshlrev_b32 v166, 16, v29
    v_and_b32 v167, s54, v29
    v_mul_f32 v160, v56, v160
    v_mul_f32 v161, v57, v161
    v_mul_f32 v162, v58, v162
    v_mul_f32 v163, v59, v163
    v_fma_f32 v164, v40, v160, v164
    v_fma_f32 v165, v41, v161, v165
    v_fma_f32 v166, v42, v162, v166
    v_fma_f32 v167, v43, v163, v167
    v_cvt_pk_bf16_f32 v180, v164, v165
    v_cvt_pk_bf16_f32 v181, v166, v167
    buffer_store_dwordx2 v[180:181], v21, s[20:23], s63 offen offset:64
    v_mul_f32 v60, 0x4275fdf0, v60
    v_mul_f32 v61, 0x4275fdf0, v61
    v_mul_f32 v62, 0x4275fdf0, v62
    v_mul_f32 v63, 0x4275fdf0, v63
    v_mul_f32 v160, 0xbfb8aa3b, v60
    v_mul_f32 v161, 0xbfb8aa3b, v61
    v_mul_f32 v162, 0xbfb8aa3b, v62
    v_mul_f32 v163, 0xbfb8aa3b, v63
    v_exp_f32 v160, v160
    v_exp_f32 v161, v161
    v_exp_f32 v162, v162
    v_exp_f32 v163, v163
    v_add_f32 v160, 1.0, v160
    v_add_f32 v161, 1.0, v161
    v_add_f32 v162, 1.0, v162
    v_add_f32 v163, 1.0, v163
    v_rcp_f32 v160, v160
    v_rcp_f32 v161, v161
    v_rcp_f32 v162, v162
    v_rcp_f32 v163, v163
    v_lshlrev_b32 v164, 16, v30
    v_and_b32 v165, s54, v30
    v_lshlrev_b32 v166, 16, v31
    v_and_b32 v167, s54, v31
    v_mul_f32 v160, v60, v160
    v_mul_f32 v161, v61, v161
    v_mul_f32 v162, v62, v162
    v_mul_f32 v163, v63, v163
    v_fma_f32 v164, v44, v160, v164
    v_fma_f32 v165, v45, v161, v165
    v_fma_f32 v166, v46, v162, v166
    v_fma_f32 v167, v47, v163, v167
    v_cvt_pk_bf16_f32 v182, v164, v165
    v_cvt_pk_bf16_f32 v183, v166, v167
    buffer_store_dwordx2 v[182:183], v21, s[20:23], s63 offen offset:96
L_k2_end:
    s_endpgm
L_k2_codeend:
L_k1_end:
    s_endpgm
L_k1_fallback:
    s_load_dwordx4 s[8:11], s[0:1], 8
    s_waitcnt vmcnt(0) lgkmcnt(0)
    s_lshl_b32 s50, s4, 19
    s_add_u32 s12, s10, s50
    s_addc_u32 s13, s11, 0
    s_mov_b32 s14, 0x80000
    s_mov_b32 s15, 0x20000
    s_add_u32 s8, s8, s50
    s_addc_u32 s9, s9, 0
    s_mov_b32 s10, 0x80000
    s_mov_b32 s11, 0x20000
    s_mul_i32 s51, s3, 49152
    s_cmp_eq_u32 s3, 3
    s_cselect_b32 s51, 114688, s51
    v_subrev_u32 v1, s44, v44
    v_subrev_u32 v2, s44, v45
    v_subrev_u32 v3, s44, v46
    v_subrev_u32 v4, s44, v47
    v_subrev_u32 v5, s44, v48
    v_subrev_u32 v6, s44, v49
    v_add_u32 v8, s51, v40
    v_add_u32 v9, s51, v41
    v_add_u32 v10, s51, v42
    v_add_u32 v11, s51, v43
    s_add_u32 s52, s51, 8192
    v_add_u32 v16, s52, v24
    v_add_u32 v17, s52, v25
    v_add_u32 v18, s52, v26
    v_add_u32 v19, s52, v27
    v_add_u32 v20, s52, v28
    v_add_u32 v21, s52, v29
    v_add_u32 v22, s52, v30
    v_add_u32 v23, s52, v31
    v_accvgpr_write_b32 a0, 0
    v_accvgpr_write_b32 a1, 0
    v_accvgpr_write_b32 a2, 0
    v_accvgpr_write_b32 a3, 0
    v_accvgpr_write_b32 a4, 0
    v_accvgpr_write_b32 a5, 0
    v_accvgpr_write_b32 a6, 0
    v_accvgpr_write_b32 a7, 0
    v_accvgpr_write_b32 a8, 0
    v_accvgpr_write_b32 a9, 0
    v_accvgpr_write_b32 a10, 0
    v_accvgpr_write_b32 a11, 0
    v_accvgpr_write_b32 a12, 0
    v_accvgpr_write_b32 a13, 0
    v_accvgpr_write_b32 a14, 0
    v_accvgpr_write_b32 a15, 0
    v_accvgpr_write_b32 a16, 0
    v_accvgpr_write_b32 a17, 0
    v_accvgpr_write_b32 a18, 0
    v_accvgpr_write_b32 a19, 0
    v_accvgpr_write_b32 a20, 0
    v_accvgpr_write_b32 a21, 0
    v_accvgpr_write_b32 a22, 0
    v_accvgpr_write_b32 a23, 0
    v_accvgpr_write_b32 a24, 0
    v_accvgpr_write_b32 a25, 0
    v_accvgpr_write_b32 a26, 0
    v_accvgpr_write_b32 a27, 0
    v_accvgpr_write_b32 a28, 0
    v_accvgpr_write_b32 a29, 0
    v_accvgpr_write_b32 a30, 0
    v_accvgpr_write_b32 a31, 0
    v_accvgpr_write_b32 a32, 0
    v_accvgpr_write_b32 a33, 0
    v_accvgpr_write_b32 a34, 0
    v_accvgpr_write_b32 a35, 0
    v_accvgpr_write_b32 a36, 0
    v_accvgpr_write_b32 a37, 0
    v_accvgpr_write_b32 a38, 0
    v_accvgpr_write_b32 a39, 0
    v_accvgpr_write_b32 a40, 0
    v_accvgpr_write_b32 a41, 0
    v_accvgpr_write_b32 a42, 0
    v_accvgpr_write_b32 a43, 0
    v_accvgpr_write_b32 a44, 0
    v_accvgpr_write_b32 a45, 0
    v_accvgpr_write_b32 a46, 0
    v_accvgpr_write_b32 a47, 0
    v_accvgpr_write_b32 a48, 0
    v_accvgpr_write_b32 a49, 0
    v_accvgpr_write_b32 a50, 0
    v_accvgpr_write_b32 a51, 0
    v_accvgpr_write_b32 a52, 0
    v_accvgpr_write_b32 a53, 0
    v_accvgpr_write_b32 a54, 0
    v_accvgpr_write_b32 a55, 0
    v_accvgpr_write_b32 a56, 0
    v_accvgpr_write_b32 a57, 0
    v_accvgpr_write_b32 a58, 0
    v_accvgpr_write_b32 a59, 0
    v_accvgpr_write_b32 a60, 0
    v_accvgpr_write_b32 a61, 0
    v_accvgpr_write_b32 a62, 0
    v_accvgpr_write_b32 a63, 0
    v_accvgpr_write_b32 a64, 0
    v_accvgpr_write_b32 a65, 0
    v_accvgpr_write_b32 a66, 0
    v_accvgpr_write_b32 a67, 0
    v_accvgpr_write_b32 a68, 0
    v_accvgpr_write_b32 a69, 0
    v_accvgpr_write_b32 a70, 0
    v_accvgpr_write_b32 a71, 0
    v_accvgpr_write_b32 a72, 0
    v_accvgpr_write_b32 a73, 0
    v_accvgpr_write_b32 a74, 0
    v_accvgpr_write_b32 a75, 0
    v_accvgpr_write_b32 a76, 0
    v_accvgpr_write_b32 a77, 0
    v_accvgpr_write_b32 a78, 0
    v_accvgpr_write_b32 a79, 0
    v_accvgpr_write_b32 a80, 0
    v_accvgpr_write_b32 a81, 0
    v_accvgpr_write_b32 a82, 0
    v_accvgpr_write_b32 a83, 0
    v_accvgpr_write_b32 a84, 0
    v_accvgpr_write_b32 a85, 0
    v_accvgpr_write_b32 a86, 0
    v_accvgpr_write_b32 a87, 0
    v_accvgpr_write_b32 a88, 0
    v_accvgpr_write_b32 a89, 0
    v_accvgpr_write_b32 a90, 0
    v_accvgpr_write_b32 a91, 0
    v_accvgpr_write_b32 a92, 0
    v_accvgpr_write_b32 a93, 0
    v_accvgpr_write_b32 a94, 0
    v_accvgpr_write_b32 a95, 0
    v_accvgpr_write_b32 a96, 0
    v_accvgpr_write_b32 a97, 0
    v_accvgpr_write_b32 a98, 0
    v_accvgpr_write_b32 a99, 0
    v_accvgpr_write_b32 a100, 0
    v_accvgpr_write_b32 a101, 0
    v_accvgpr_write_b32 a102, 0
    v_accvgpr_write_b32 a103, 0
    v_accvgpr_write_b32 a104, 0
    v_accvgpr_write_b32 a105, 0
    v_accvgpr_write_b32 a106, 0
    v_accvgpr_write_b32 a107, 0
    v_accvgpr_write_b32 a108, 0
    v_accvgpr_write_b32 a109, 0
    v_accvgpr_write_b32 a110, 0
    v_accvgpr_write_b32 a111, 0
    v_accvgpr_write_b32 a112, 0
    v_accvgpr_write_b32 a113, 0
    v_accvgpr_write_b32 a114, 0
    v_accvgpr_write_b32 a115, 0
    v_accvgpr_write_b32 a116, 0
    v_accvgpr_write_b32 a117, 0
    v_accvgpr_write_b32 a118, 0
    v_accvgpr_write_b32 a119, 0
    v_accvgpr_write_b32 a120, 0
    v_accvgpr_write_b32 a121, 0
    v_accvgpr_write_b32 a122, 0
    v_accvgpr_write_b32 a123, 0
    v_accvgpr_write_b32 a124, 0
    v_accvgpr_write_b32 a125, 0
    v_accvgpr_write_b32 a126, 0
    v_accvgpr_write_b32 a127, 0
    v_mov_b32 v224, 0xff61b1e6
    v_mov_b32 v240, 0
    v_mov_b32 v225, 0xff61b1e6
    v_mov_b32 v241, 0
    v_mov_b32 v226, 0xff61b1e6
    v_mov_b32 v242, 0
    v_mov_b32 v227, 0xff61b1e6
    v_mov_b32 v243, 0
    s_mov_b32 s53, 0
L_k1_fb_loop:
    s_add_u32 m0, s51, 0
    s_add_u32 s54, s53, 0
    buffer_load_dwordx4 v1, s[8:11], s54 offen offset:0 lds
    buffer_load_dwordx4 v2, s[8:11], s54 offen offset:1024 lds
    buffer_load_dwordx4 v3, s[8:11], s54 offen offset:2048 lds
    buffer_load_dwordx4 v4, s[8:11], s54 offen offset:3072 lds
    s_add_u32 m0, s52, 0
    s_nop 0
    buffer_load_dwordx4 v5, s[12:15], s54 offen offset:0 lds
    buffer_load_dwordx4 v6, s[12:15], s54 offen offset:1024 lds
    buffer_load_dwordx4 v5, s[12:15], s54 offen offset:2048 lds
    buffer_load_dwordx4 v6, s[12:15], s54 offen offset:3072 lds
    s_add_u32 m0, s51, 4096
    s_add_u32 s54, s53, 4096
    buffer_load_dwordx4 v1, s[8:11], s54 offen offset:0 lds
    buffer_load_dwordx4 v2, s[8:11], s54 offen offset:1024 lds
    buffer_load_dwordx4 v3, s[8:11], s54 offen offset:2048 lds
    buffer_load_dwordx4 v4, s[8:11], s54 offen offset:3072 lds
    s_add_u32 m0, s52, 4096
    s_nop 0
    buffer_load_dwordx4 v5, s[12:15], s54 offen offset:0 lds
    buffer_load_dwordx4 v6, s[12:15], s54 offen offset:1024 lds
    buffer_load_dwordx4 v5, s[12:15], s54 offen offset:2048 lds
    buffer_load_dwordx4 v6, s[12:15], s54 offen offset:3072 lds
    s_waitcnt vmcnt(0)
    ds_read_b128 a[192:195], v8 offset:0
    ds_read_b128 a[196:199], v9 offset:0
    ds_read_b128 a[200:203], v10 offset:0
    ds_read_b128 a[204:207], v11 offset:0
    ds_read_b128 a[208:211], v8 offset:4096
    ds_read_b128 a[212:215], v9 offset:4096
    ds_read_b128 a[216:219], v10 offset:4096
    ds_read_b128 a[220:223], v11 offset:4096
    ds_read_b64_tr_b16 v[64:65], v16
    ds_read_b64_tr_b16 v[66:67], v16 offset:4096
    ds_read_b64_tr_b16 v[68:69], v17
    ds_read_b64_tr_b16 v[70:71], v17 offset:4096
    ds_read_b64_tr_b16 v[72:73], v18
    ds_read_b64_tr_b16 v[74:75], v18 offset:4096
    ds_read_b64_tr_b16 v[76:77], v19
    ds_read_b64_tr_b16 v[78:79], v19 offset:4096
    ds_read_b64_tr_b16 v[80:81], v20
    ds_read_b64_tr_b16 v[82:83], v20 offset:4096
    ds_read_b64_tr_b16 v[84:85], v21
    ds_read_b64_tr_b16 v[86:87], v21 offset:4096
    ds_read_b64_tr_b16 v[88:89], v22
    ds_read_b64_tr_b16 v[90:91], v22 offset:4096
    ds_read_b64_tr_b16 v[92:93], v23
    ds_read_b64_tr_b16 v[94:95], v23 offset:4096
    s_waitcnt lgkmcnt(0)
    v_mfma_f32_16x16x32_bf16 v[128:131], a[192:195], a[128:131], 0
    v_mfma_f32_16x16x32_bf16 v[128:131], a[196:199], a[132:135], v[128:131]
    v_mfma_f32_16x16x32_bf16 v[128:131], a[200:203], a[136:139], v[128:131]
    v_mfma_f32_16x16x32_bf16 v[128:131], a[204:207], a[140:143], v[128:131]
    v_mfma_f32_16x16x32_bf16 v[132:135], a[192:195], a[144:147], 0
    v_mfma_f32_16x16x32_bf16 v[132:135], a[196:199], a[148:151], v[132:135]
    v_mfma_f32_16x16x32_bf16 v[132:135], a[200:203], a[152:155], v[132:135]
    v_mfma_f32_16x16x32_bf16 v[132:135], a[204:207], a[156:159], v[132:135]
    v_mfma_f32_16x16x32_bf16 v[136:139], a[192:195], a[160:163], 0
    v_mfma_f32_16x16x32_bf16 v[136:139], a[196:199], a[164:167], v[136:139]
    v_mfma_f32_16x16x32_bf16 v[136:139], a[200:203], a[168:171], v[136:139]
    v_mfma_f32_16x16x32_bf16 v[136:139], a[204:207], a[172:175], v[136:139]
    v_mfma_f32_16x16x32_bf16 v[140:143], a[192:195], a[176:179], 0
    v_mfma_f32_16x16x32_bf16 v[140:143], a[196:199], a[180:183], v[140:143]
    v_mfma_f32_16x16x32_bf16 v[140:143], a[200:203], a[184:187], v[140:143]
    v_mfma_f32_16x16x32_bf16 v[140:143], a[204:207], a[188:191], v[140:143]
    v_mfma_f32_16x16x32_bf16 v[144:147], a[208:211], a[128:131], 0
    v_mfma_f32_16x16x32_bf16 v[144:147], a[212:215], a[132:135], v[144:147]
    v_mfma_f32_16x16x32_bf16 v[144:147], a[216:219], a[136:139], v[144:147]
    v_mfma_f32_16x16x32_bf16 v[144:147], a[220:223], a[140:143], v[144:147]
    v_mfma_f32_16x16x32_bf16 v[148:151], a[208:211], a[144:147], 0
    v_mfma_f32_16x16x32_bf16 v[148:151], a[212:215], a[148:151], v[148:151]
    v_mfma_f32_16x16x32_bf16 v[148:151], a[216:219], a[152:155], v[148:151]
    v_mfma_f32_16x16x32_bf16 v[148:151], a[220:223], a[156:159], v[148:151]
    v_mfma_f32_16x16x32_bf16 v[152:155], a[208:211], a[160:163], 0
    v_mfma_f32_16x16x32_bf16 v[152:155], a[212:215], a[164:167], v[152:155]
    v_mfma_f32_16x16x32_bf16 v[152:155], a[216:219], a[168:171], v[152:155]
    v_mfma_f32_16x16x32_bf16 v[152:155], a[220:223], a[172:175], v[152:155]
    v_mfma_f32_16x16x32_bf16 v[156:159], a[208:211], a[176:179], 0
    v_mfma_f32_16x16x32_bf16 v[156:159], a[212:215], a[180:183], v[156:159]
    v_mfma_f32_16x16x32_bf16 v[156:159], a[216:219], a[184:187], v[156:159]
    v_mfma_f32_16x16x32_bf16 v[156:159], a[220:223], a[188:191], v[156:159]
    s_nop 7
    v_max3_f32 v244, v128, v129, v130
    v_max3_f32 v244, v244, v131, v144
    v_max3_f32 v244, v244, v145, v146
    v_max_f32 v244, v244, v147
    v_mov_b32 v245, v244
    s_nop 1
    v_permlane32_swap_b32 v245, v244
    s_nop 1
    v_max_f32 v244, v244, v245
    v_mov_b32 v245, v244
    s_nop 1
    v_permlane16_swap_b32 v245, v244
    s_nop 1
    v_max_f32 v244, v244, v245
    v_max_f32 v244, v244, v224
    v_sub_f32 v228, v224, v244
    v_exp_f32 v228, v228
    v_mov_b32 v224, v244
    v_mul_f32 v240, v240, v228
    v_sub_f32 v128, v128, v224
    v_sub_f32 v129, v129, v224
    v_sub_f32 v130, v130, v224
    v_sub_f32 v131, v131, v224
    v_exp_f32 v128, v128
    v_exp_f32 v129, v129
    v_exp_f32 v130, v130
    v_exp_f32 v131, v131
    s_nop 0
    v_add_f32 v240, v240, v128
    v_add_f32 v240, v240, v129
    v_add_f32 v240, v240, v130
    v_add_f32 v240, v240, v131
    v_sub_f32 v144, v144, v224
    v_sub_f32 v145, v145, v224
    v_sub_f32 v146, v146, v224
    v_sub_f32 v147, v147, v224
    v_exp_f32 v144, v144
    v_exp_f32 v145, v145
    v_exp_f32 v146, v146
    v_exp_f32 v147, v147
    s_nop 0
    v_add_f32 v240, v240, v144
    v_add_f32 v240, v240, v145
    v_add_f32 v240, v240, v146
    v_add_f32 v240, v240, v147
    v_cvt_pk_bf16_f32 v192, v128, v129
    v_cvt_pk_bf16_f32 v193, v130, v131
    v_cvt_pk_bf16_f32 v194, v144, v145
    v_cvt_pk_bf16_f32 v195, v146, v147
    v_max3_f32 v244, v132, v133, v134
    v_max3_f32 v244, v244, v135, v148
    v_max3_f32 v244, v244, v149, v150
    v_max_f32 v244, v244, v151
    v_mov_b32 v245, v244
    s_nop 1
    v_permlane32_swap_b32 v245, v244
    s_nop 1
    v_max_f32 v244, v244, v245
    v_mov_b32 v245, v244
    s_nop 1
    v_permlane16_swap_b32 v245, v244
    s_nop 1
    v_max_f32 v244, v244, v245
    v_max_f32 v244, v244, v225
    v_sub_f32 v229, v225, v244
    v_exp_f32 v229, v229
    v_mov_b32 v225, v244
    v_mul_f32 v241, v241, v229
    v_sub_f32 v132, v132, v225
    v_sub_f32 v133, v133, v225
    v_sub_f32 v134, v134, v225
    v_sub_f32 v135, v135, v225
    v_exp_f32 v132, v132
    v_exp_f32 v133, v133
    v_exp_f32 v134, v134
    v_exp_f32 v135, v135
    s_nop 0
    v_add_f32 v241, v241, v132
    v_add_f32 v241, v241, v133
    v_add_f32 v241, v241, v134
    v_add_f32 v241, v241, v135
    v_sub_f32 v148, v148, v225
    v_sub_f32 v149, v149, v225
    v_sub_f32 v150, v150, v225
    v_sub_f32 v151, v151, v225
    v_exp_f32 v148, v148
    v_exp_f32 v149, v149
    v_exp_f32 v150, v150
    v_exp_f32 v151, v151
    s_nop 0
    v_add_f32 v241, v241, v148
    v_add_f32 v241, v241, v149
    v_add_f32 v241, v241, v150
    v_add_f32 v241, v241, v151
    v_cvt_pk_bf16_f32 v196, v132, v133
    v_cvt_pk_bf16_f32 v197, v134, v135
    v_cvt_pk_bf16_f32 v198, v148, v149
    v_cvt_pk_bf16_f32 v199, v150, v151
    v_max3_f32 v244, v136, v137, v138
    v_max3_f32 v244, v244, v139, v152
    v_max3_f32 v244, v244, v153, v154
    v_max_f32 v244, v244, v155
    v_mov_b32 v245, v244
    s_nop 1
    v_permlane32_swap_b32 v245, v244
    s_nop 1
    v_max_f32 v244, v244, v245
    v_mov_b32 v245, v244
    s_nop 1
    v_permlane16_swap_b32 v245, v244
    s_nop 1
    v_max_f32 v244, v244, v245
    v_max_f32 v244, v244, v226
    v_sub_f32 v230, v226, v244
    v_exp_f32 v230, v230
    v_mov_b32 v226, v244
    v_mul_f32 v242, v242, v230
    v_sub_f32 v136, v136, v226
    v_sub_f32 v137, v137, v226
    v_sub_f32 v138, v138, v226
    v_sub_f32 v139, v139, v226
    v_exp_f32 v136, v136
    v_exp_f32 v137, v137
    v_exp_f32 v138, v138
    v_exp_f32 v139, v139
    s_nop 0
    v_add_f32 v242, v242, v136
    v_add_f32 v242, v242, v137
    v_add_f32 v242, v242, v138
    v_add_f32 v242, v242, v139
    v_sub_f32 v152, v152, v226
    v_sub_f32 v153, v153, v226
    v_sub_f32 v154, v154, v226
    v_sub_f32 v155, v155, v226
    v_exp_f32 v152, v152
    v_exp_f32 v153, v153
    v_exp_f32 v154, v154
    v_exp_f32 v155, v155
    s_nop 0
    v_add_f32 v242, v242, v152
    v_add_f32 v242, v242, v153
    v_add_f32 v242, v242, v154
    v_add_f32 v242, v242, v155
    v_cvt_pk_bf16_f32 v200, v136, v137
    v_cvt_pk_bf16_f32 v201, v138, v139
    v_cvt_pk_bf16_f32 v202, v152, v153
    v_cvt_pk_bf16_f32 v203, v154, v155
    v_max3_f32 v244, v140, v141, v142
    v_max3_f32 v244, v244, v143, v156
    v_max3_f32 v244, v244, v157, v158
    v_max_f32 v244, v244, v159
    v_mov_b32 v245, v244
    s_nop 1
    v_permlane32_swap_b32 v245, v244
    s_nop 1
    v_max_f32 v244, v244, v245
    v_mov_b32 v245, v244
    s_nop 1
    v_permlane16_swap_b32 v245, v244
    s_nop 1
    v_max_f32 v244, v244, v245
    v_max_f32 v244, v244, v227
    v_sub_f32 v231, v227, v244
    v_exp_f32 v231, v231
    v_mov_b32 v227, v244
    v_mul_f32 v243, v243, v231
    v_sub_f32 v140, v140, v227
    v_sub_f32 v141, v141, v227
    v_sub_f32 v142, v142, v227
    v_sub_f32 v143, v143, v227
    v_exp_f32 v140, v140
    v_exp_f32 v141, v141
    v_exp_f32 v142, v142
    v_exp_f32 v143, v143
    s_nop 0
    v_add_f32 v243, v243, v140
    v_add_f32 v243, v243, v141
    v_add_f32 v243, v243, v142
    v_add_f32 v243, v243, v143
    v_sub_f32 v156, v156, v227
    v_sub_f32 v157, v157, v227
    v_sub_f32 v158, v158, v227
    v_sub_f32 v159, v159, v227
    v_exp_f32 v156, v156
    v_exp_f32 v157, v157
    v_exp_f32 v158, v158
    v_exp_f32 v159, v159
    s_nop 0
    v_add_f32 v243, v243, v156
    v_add_f32 v243, v243, v157
    v_add_f32 v243, v243, v158
    v_add_f32 v243, v243, v159
    v_cvt_pk_bf16_f32 v204, v140, v141
    v_cvt_pk_bf16_f32 v205, v142, v143
    v_cvt_pk_bf16_f32 v206, v156, v157
    v_cvt_pk_bf16_f32 v207, v158, v159
    v_accvgpr_read_b32 v244, a0
    v_accvgpr_read_b32 v245, a1
    v_accvgpr_read_b32 v246, a2
    v_accvgpr_read_b32 v247, a3
    v_mul_f32 v244, v244, v228
    v_mul_f32 v245, v245, v228
    v_mul_f32 v246, v246, v228
    v_mul_f32 v247, v247, v228
    v_accvgpr_write_b32 a0, v244
    v_accvgpr_write_b32 a1, v245
    v_accvgpr_write_b32 a2, v246
    v_accvgpr_write_b32 a3, v247
    v_accvgpr_read_b32 v244, a4
    v_accvgpr_read_b32 v245, a5
    v_accvgpr_read_b32 v246, a6
    v_accvgpr_read_b32 v247, a7
    v_mul_f32 v244, v244, v229
    v_mul_f32 v245, v245, v229
    v_mul_f32 v246, v246, v229
    v_mul_f32 v247, v247, v229
    v_accvgpr_write_b32 a4, v244
    v_accvgpr_write_b32 a5, v245
    v_accvgpr_write_b32 a6, v246
    v_accvgpr_write_b32 a7, v247
    v_accvgpr_read_b32 v244, a8
    v_accvgpr_read_b32 v245, a9
    v_accvgpr_read_b32 v246, a10
    v_accvgpr_read_b32 v247, a11
    v_mul_f32 v244, v244, v230
    v_mul_f32 v245, v245, v230
    v_mul_f32 v246, v246, v230
    v_mul_f32 v247, v247, v230
    v_accvgpr_write_b32 a8, v244
    v_accvgpr_write_b32 a9, v245
    v_accvgpr_write_b32 a10, v246
    v_accvgpr_write_b32 a11, v247
    v_accvgpr_read_b32 v244, a12
    v_accvgpr_read_b32 v245, a13
    v_accvgpr_read_b32 v246, a14
    v_accvgpr_read_b32 v247, a15
    v_mul_f32 v244, v244, v231
    v_mul_f32 v245, v245, v231
    v_mul_f32 v246, v246, v231
    v_mul_f32 v247, v247, v231
    v_accvgpr_write_b32 a12, v244
    v_accvgpr_write_b32 a13, v245
    v_accvgpr_write_b32 a14, v246
    v_accvgpr_write_b32 a15, v247
    v_accvgpr_read_b32 v244, a16
    v_accvgpr_read_b32 v245, a17
    v_accvgpr_read_b32 v246, a18
    v_accvgpr_read_b32 v247, a19
    v_mul_f32 v244, v244, v228
    v_mul_f32 v245, v245, v228
    v_mul_f32 v246, v246, v228
    v_mul_f32 v247, v247, v228
    v_accvgpr_write_b32 a16, v244
    v_accvgpr_write_b32 a17, v245
    v_accvgpr_write_b32 a18, v246
    v_accvgpr_write_b32 a19, v247
    v_accvgpr_read_b32 v244, a20
    v_accvgpr_read_b32 v245, a21
    v_accvgpr_read_b32 v246, a22
    v_accvgpr_read_b32 v247, a23
    v_mul_f32 v244, v244, v229
    v_mul_f32 v245, v245, v229
    v_mul_f32 v246, v246, v229
    v_mul_f32 v247, v247, v229
    v_accvgpr_write_b32 a20, v244
    v_accvgpr_write_b32 a21, v245
    v_accvgpr_write_b32 a22, v246
    v_accvgpr_write_b32 a23, v247
    v_accvgpr_read_b32 v244, a24
    v_accvgpr_read_b32 v245, a25
    v_accvgpr_read_b32 v246, a26
    v_accvgpr_read_b32 v247, a27
    v_mul_f32 v244, v244, v230
    v_mul_f32 v245, v245, v230
    v_mul_f32 v246, v246, v230
    v_mul_f32 v247, v247, v230
    v_accvgpr_write_b32 a24, v244
    v_accvgpr_write_b32 a25, v245
    v_accvgpr_write_b32 a26, v246
    v_accvgpr_write_b32 a27, v247
    v_accvgpr_read_b32 v244, a28
    v_accvgpr_read_b32 v245, a29
    v_accvgpr_read_b32 v246, a30
    v_accvgpr_read_b32 v247, a31
    v_mul_f32 v244, v244, v231
    v_mul_f32 v245, v245, v231
    v_mul_f32 v246, v246, v231
    v_mul_f32 v247, v247, v231
    v_accvgpr_write_b32 a28, v244
    v_accvgpr_write_b32 a29, v245
    v_accvgpr_write_b32 a30, v246
    v_accvgpr_write_b32 a31, v247
    v_accvgpr_read_b32 v244, a32
    v_accvgpr_read_b32 v245, a33
    v_accvgpr_read_b32 v246, a34
    v_accvgpr_read_b32 v247, a35
    v_mul_f32 v244, v244, v228
    v_mul_f32 v245, v245, v228
    v_mul_f32 v246, v246, v228
    v_mul_f32 v247, v247, v228
    v_accvgpr_write_b32 a32, v244
    v_accvgpr_write_b32 a33, v245
    v_accvgpr_write_b32 a34, v246
    v_accvgpr_write_b32 a35, v247
    v_accvgpr_read_b32 v244, a36
    v_accvgpr_read_b32 v245, a37
    v_accvgpr_read_b32 v246, a38
    v_accvgpr_read_b32 v247, a39
    v_mul_f32 v244, v244, v229
    v_mul_f32 v245, v245, v229
    v_mul_f32 v246, v246, v229
    v_mul_f32 v247, v247, v229
    v_accvgpr_write_b32 a36, v244
    v_accvgpr_write_b32 a37, v245
    v_accvgpr_write_b32 a38, v246
    v_accvgpr_write_b32 a39, v247
    v_accvgpr_read_b32 v244, a40
    v_accvgpr_read_b32 v245, a41
    v_accvgpr_read_b32 v246, a42
    v_accvgpr_read_b32 v247, a43
    v_mul_f32 v244, v244, v230
    v_mul_f32 v245, v245, v230
    v_mul_f32 v246, v246, v230
    v_mul_f32 v247, v247, v230
    v_accvgpr_write_b32 a40, v244
    v_accvgpr_write_b32 a41, v245
    v_accvgpr_write_b32 a42, v246
    v_accvgpr_write_b32 a43, v247
    v_accvgpr_read_b32 v244, a44
    v_accvgpr_read_b32 v245, a45
    v_accvgpr_read_b32 v246, a46
    v_accvgpr_read_b32 v247, a47
    v_mul_f32 v244, v244, v231
    v_mul_f32 v245, v245, v231
    v_mul_f32 v246, v246, v231
    v_mul_f32 v247, v247, v231
    v_accvgpr_write_b32 a44, v244
    v_accvgpr_write_b32 a45, v245
    v_accvgpr_write_b32 a46, v246
    v_accvgpr_write_b32 a47, v247
    v_accvgpr_read_b32 v244, a48
    v_accvgpr_read_b32 v245, a49
    v_accvgpr_read_b32 v246, a50
    v_accvgpr_read_b32 v247, a51
    v_mul_f32 v244, v244, v228
    v_mul_f32 v245, v245, v228
    v_mul_f32 v246, v246, v228
    v_mul_f32 v247, v247, v228
    v_accvgpr_write_b32 a48, v244
    v_accvgpr_write_b32 a49, v245
    v_accvgpr_write_b32 a50, v246
    v_accvgpr_write_b32 a51, v247
    v_accvgpr_read_b32 v244, a52
    v_accvgpr_read_b32 v245, a53
    v_accvgpr_read_b32 v246, a54
    v_accvgpr_read_b32 v247, a55
    v_mul_f32 v244, v244, v229
    v_mul_f32 v245, v245, v229
    v_mul_f32 v246, v246, v229
    v_mul_f32 v247, v247, v229
    v_accvgpr_write_b32 a52, v244
    v_accvgpr_write_b32 a53, v245
    v_accvgpr_write_b32 a54, v246
    v_accvgpr_write_b32 a55, v247
    v_accvgpr_read_b32 v244, a56
    v_accvgpr_read_b32 v245, a57
    v_accvgpr_read_b32 v246, a58
    v_accvgpr_read_b32 v247, a59
    v_mul_f32 v244, v244, v230
    v_mul_f32 v245, v245, v230
    v_mul_f32 v246, v246, v230
    v_mul_f32 v247, v247, v230
    v_accvgpr_write_b32 a56, v244
    v_accvgpr_write_b32 a57, v245
    v_accvgpr_write_b32 a58, v246
    v_accvgpr_write_b32 a59, v247
    v_accvgpr_read_b32 v244, a60
    v_accvgpr_read_b32 v245, a61
    v_accvgpr_read_b32 v246, a62
    v_accvgpr_read_b32 v247, a63
    v_mul_f32 v244, v244, v231
    v_mul_f32 v245, v245, v231
    v_mul_f32 v246, v246, v231
    v_mul_f32 v247, v247, v231
    v_accvgpr_write_b32 a60, v244
    v_accvgpr_write_b32 a61, v245
    v_accvgpr_write_b32 a62, v246
    v_accvgpr_write_b32 a63, v247
    v_accvgpr_read_b32 v244, a64
    v_accvgpr_read_b32 v245, a65
    v_accvgpr_read_b32 v246, a66
    v_accvgpr_read_b32 v247, a67
    v_mul_f32 v244, v244, v228
    v_mul_f32 v245, v245, v228
    v_mul_f32 v246, v246, v228
    v_mul_f32 v247, v247, v228
    v_accvgpr_write_b32 a64, v244
    v_accvgpr_write_b32 a65, v245
    v_accvgpr_write_b32 a66, v246
    v_accvgpr_write_b32 a67, v247
    v_accvgpr_read_b32 v244, a68
    v_accvgpr_read_b32 v245, a69
    v_accvgpr_read_b32 v246, a70
    v_accvgpr_read_b32 v247, a71
    v_mul_f32 v244, v244, v229
    v_mul_f32 v245, v245, v229
    v_mul_f32 v246, v246, v229
    v_mul_f32 v247, v247, v229
    v_accvgpr_write_b32 a68, v244
    v_accvgpr_write_b32 a69, v245
    v_accvgpr_write_b32 a70, v246
    v_accvgpr_write_b32 a71, v247
    v_accvgpr_read_b32 v244, a72
    v_accvgpr_read_b32 v245, a73
    v_accvgpr_read_b32 v246, a74
    v_accvgpr_read_b32 v247, a75
    v_mul_f32 v244, v244, v230
    v_mul_f32 v245, v245, v230
    v_mul_f32 v246, v246, v230
    v_mul_f32 v247, v247, v230
    v_accvgpr_write_b32 a72, v244
    v_accvgpr_write_b32 a73, v245
    v_accvgpr_write_b32 a74, v246
    v_accvgpr_write_b32 a75, v247
    v_accvgpr_read_b32 v244, a76
    v_accvgpr_read_b32 v245, a77
    v_accvgpr_read_b32 v246, a78
    v_accvgpr_read_b32 v247, a79
    v_mul_f32 v244, v244, v231
    v_mul_f32 v245, v245, v231
    v_mul_f32 v246, v246, v231
    v_mul_f32 v247, v247, v231
    v_accvgpr_write_b32 a76, v244
    v_accvgpr_write_b32 a77, v245
    v_accvgpr_write_b32 a78, v246
    v_accvgpr_write_b32 a79, v247
    v_accvgpr_read_b32 v244, a80
    v_accvgpr_read_b32 v245, a81
    v_accvgpr_read_b32 v246, a82
    v_accvgpr_read_b32 v247, a83
    v_mul_f32 v244, v244, v228
    v_mul_f32 v245, v245, v228
    v_mul_f32 v246, v246, v228
    v_mul_f32 v247, v247, v228
    v_accvgpr_write_b32 a80, v244
    v_accvgpr_write_b32 a81, v245
    v_accvgpr_write_b32 a82, v246
    v_accvgpr_write_b32 a83, v247
    v_accvgpr_read_b32 v244, a84
    v_accvgpr_read_b32 v245, a85
    v_accvgpr_read_b32 v246, a86
    v_accvgpr_read_b32 v247, a87
    v_mul_f32 v244, v244, v229
    v_mul_f32 v245, v245, v229
    v_mul_f32 v246, v246, v229
    v_mul_f32 v247, v247, v229
    v_accvgpr_write_b32 a84, v244
    v_accvgpr_write_b32 a85, v245
    v_accvgpr_write_b32 a86, v246
    v_accvgpr_write_b32 a87, v247
    v_accvgpr_read_b32 v244, a88
    v_accvgpr_read_b32 v245, a89
    v_accvgpr_read_b32 v246, a90
    v_accvgpr_read_b32 v247, a91
    v_mul_f32 v244, v244, v230
    v_mul_f32 v245, v245, v230
    v_mul_f32 v246, v246, v230
    v_mul_f32 v247, v247, v230
    v_accvgpr_write_b32 a88, v244
    v_accvgpr_write_b32 a89, v245
    v_accvgpr_write_b32 a90, v246
    v_accvgpr_write_b32 a91, v247
    v_accvgpr_read_b32 v244, a92
    v_accvgpr_read_b32 v245, a93
    v_accvgpr_read_b32 v246, a94
    v_accvgpr_read_b32 v247, a95
    v_mul_f32 v244, v244, v231
    v_mul_f32 v245, v245, v231
    v_mul_f32 v246, v246, v231
    v_mul_f32 v247, v247, v231
    v_accvgpr_write_b32 a92, v244
    v_accvgpr_write_b32 a93, v245
    v_accvgpr_write_b32 a94, v246
    v_accvgpr_write_b32 a95, v247
    v_accvgpr_read_b32 v244, a96
    v_accvgpr_read_b32 v245, a97
    v_accvgpr_read_b32 v246, a98
    v_accvgpr_read_b32 v247, a99
    v_mul_f32 v244, v244, v228
    v_mul_f32 v245, v245, v228
    v_mul_f32 v246, v246, v228
    v_mul_f32 v247, v247, v228
    v_accvgpr_write_b32 a96, v244
    v_accvgpr_write_b32 a97, v245
    v_accvgpr_write_b32 a98, v246
    v_accvgpr_write_b32 a99, v247
    v_accvgpr_read_b32 v244, a100
    v_accvgpr_read_b32 v245, a101
    v_accvgpr_read_b32 v246, a102
    v_accvgpr_read_b32 v247, a103
    v_mul_f32 v244, v244, v229
    v_mul_f32 v245, v245, v229
    v_mul_f32 v246, v246, v229
    v_mul_f32 v247, v247, v229
    v_accvgpr_write_b32 a100, v244
    v_accvgpr_write_b32 a101, v245
    v_accvgpr_write_b32 a102, v246
    v_accvgpr_write_b32 a103, v247
    v_accvgpr_read_b32 v244, a104
    v_accvgpr_read_b32 v245, a105
    v_accvgpr_read_b32 v246, a106
    v_accvgpr_read_b32 v247, a107
    v_mul_f32 v244, v244, v230
    v_mul_f32 v245, v245, v230
    v_mul_f32 v246, v246, v230
    v_mul_f32 v247, v247, v230
    v_accvgpr_write_b32 a104, v244
    v_accvgpr_write_b32 a105, v245
    v_accvgpr_write_b32 a106, v246
    v_accvgpr_write_b32 a107, v247
    v_accvgpr_read_b32 v244, a108
    v_accvgpr_read_b32 v245, a109
    v_accvgpr_read_b32 v246, a110
    v_accvgpr_read_b32 v247, a111
    v_mul_f32 v244, v244, v231
    v_mul_f32 v245, v245, v231
    v_mul_f32 v246, v246, v231
    v_mul_f32 v247, v247, v231
    v_accvgpr_write_b32 a108, v244
    v_accvgpr_write_b32 a109, v245
    v_accvgpr_write_b32 a110, v246
    v_accvgpr_write_b32 a111, v247
    v_accvgpr_read_b32 v244, a112
    v_accvgpr_read_b32 v245, a113
    v_accvgpr_read_b32 v246, a114
    v_accvgpr_read_b32 v247, a115
    v_mul_f32 v244, v244, v228
    v_mul_f32 v245, v245, v228
    v_mul_f32 v246, v246, v228
    v_mul_f32 v247, v247, v228
    v_accvgpr_write_b32 a112, v244
    v_accvgpr_write_b32 a113, v245
    v_accvgpr_write_b32 a114, v246
    v_accvgpr_write_b32 a115, v247
    v_accvgpr_read_b32 v244, a116
    v_accvgpr_read_b32 v245, a117
    v_accvgpr_read_b32 v246, a118
    v_accvgpr_read_b32 v247, a119
    v_mul_f32 v244, v244, v229
    v_mul_f32 v245, v245, v229
    v_mul_f32 v246, v246, v229
    v_mul_f32 v247, v247, v229
    v_accvgpr_write_b32 a116, v244
    v_accvgpr_write_b32 a117, v245
    v_accvgpr_write_b32 a118, v246
    v_accvgpr_write_b32 a119, v247
    v_accvgpr_read_b32 v244, a120
    v_accvgpr_read_b32 v245, a121
    v_accvgpr_read_b32 v246, a122
    v_accvgpr_read_b32 v247, a123
    v_mul_f32 v244, v244, v230
    v_mul_f32 v245, v245, v230
    v_mul_f32 v246, v246, v230
    v_mul_f32 v247, v247, v230
    v_accvgpr_write_b32 a120, v244
    v_accvgpr_write_b32 a121, v245
    v_accvgpr_write_b32 a122, v246
    v_accvgpr_write_b32 a123, v247
    v_accvgpr_read_b32 v244, a124
    v_accvgpr_read_b32 v245, a125
    v_accvgpr_read_b32 v246, a126
    v_accvgpr_read_b32 v247, a127
    v_mul_f32 v244, v244, v231
    v_mul_f32 v245, v245, v231
    v_mul_f32 v246, v246, v231
    v_mul_f32 v247, v247, v231
    v_accvgpr_write_b32 a124, v244
    v_accvgpr_write_b32 a125, v245
    v_accvgpr_write_b32 a126, v246
    v_accvgpr_write_b32 a127, v247
    s_nop 1
    v_mfma_f32_16x16x32_bf16 a[0:3], v[64:67], v[192:195], a[0:3]
    v_mfma_f32_16x16x32_bf16 a[4:7], v[64:67], v[196:199], a[4:7]
    v_mfma_f32_16x16x32_bf16 a[8:11], v[64:67], v[200:203], a[8:11]
    v_mfma_f32_16x16x32_bf16 a[12:15], v[64:67], v[204:207], a[12:15]
    v_mfma_f32_16x16x32_bf16 a[16:19], v[68:71], v[192:195], a[16:19]
    v_mfma_f32_16x16x32_bf16 a[20:23], v[68:71], v[196:199], a[20:23]
    v_mfma_f32_16x16x32_bf16 a[24:27], v[68:71], v[200:203], a[24:27]
    v_mfma_f32_16x16x32_bf16 a[28:31], v[68:71], v[204:207], a[28:31]
    v_mfma_f32_16x16x32_bf16 a[32:35], v[72:75], v[192:195], a[32:35]
    v_mfma_f32_16x16x32_bf16 a[36:39], v[72:75], v[196:199], a[36:39]
    v_mfma_f32_16x16x32_bf16 a[40:43], v[72:75], v[200:203], a[40:43]
    v_mfma_f32_16x16x32_bf16 a[44:47], v[72:75], v[204:207], a[44:47]
    v_mfma_f32_16x16x32_bf16 a[48:51], v[76:79], v[192:195], a[48:51]
    v_mfma_f32_16x16x32_bf16 a[52:55], v[76:79], v[196:199], a[52:55]
    v_mfma_f32_16x16x32_bf16 a[56:59], v[76:79], v[200:203], a[56:59]
    v_mfma_f32_16x16x32_bf16 a[60:63], v[76:79], v[204:207], a[60:63]
    v_mfma_f32_16x16x32_bf16 a[64:67], v[80:83], v[192:195], a[64:67]
    v_mfma_f32_16x16x32_bf16 a[68:71], v[80:83], v[196:199], a[68:71]
    v_mfma_f32_16x16x32_bf16 a[72:75], v[80:83], v[200:203], a[72:75]
    v_mfma_f32_16x16x32_bf16 a[76:79], v[80:83], v[204:207], a[76:79]
    v_mfma_f32_16x16x32_bf16 a[80:83], v[84:87], v[192:195], a[80:83]
    v_mfma_f32_16x16x32_bf16 a[84:87], v[84:87], v[196:199], a[84:87]
    v_mfma_f32_16x16x32_bf16 a[88:91], v[84:87], v[200:203], a[88:91]
    v_mfma_f32_16x16x32_bf16 a[92:95], v[84:87], v[204:207], a[92:95]
    v_mfma_f32_16x16x32_bf16 a[96:99], v[88:91], v[192:195], a[96:99]
    v_mfma_f32_16x16x32_bf16 a[100:103], v[88:91], v[196:199], a[100:103]
    v_mfma_f32_16x16x32_bf16 a[104:107], v[88:91], v[200:203], a[104:107]
    v_mfma_f32_16x16x32_bf16 a[108:111], v[88:91], v[204:207], a[108:111]
    v_mfma_f32_16x16x32_bf16 a[112:115], v[92:95], v[192:195], a[112:115]
    v_mfma_f32_16x16x32_bf16 a[116:119], v[92:95], v[196:199], a[116:119]
    v_mfma_f32_16x16x32_bf16 a[120:123], v[92:95], v[200:203], a[120:123]
    v_mfma_f32_16x16x32_bf16 a[124:127], v[92:95], v[204:207], a[124:127]
    s_nop 7
    s_add_u32 s53, s53, 8192
    s_cmp_lt_u32 s53, 0x80000
    s_cbranch_scc1 L_k1_fb_loop
    v_mov_b32 v244, v240
    s_nop 1
    v_permlane32_swap_b32 v244, v240
    s_nop 1
    v_add_f32 v240, v240, v244
    v_mov_b32 v244, v240
    s_nop 1
    v_permlane16_swap_b32 v244, v240
    s_nop 1
    v_add_f32 v240, v240, v244
    v_mov_b32 v244, v241
    s_nop 1
    v_permlane32_swap_b32 v244, v241
    s_nop 1
    v_add_f32 v241, v241, v244
    v_mov_b32 v244, v241
    s_nop 1
    v_permlane16_swap_b32 v244, v241
    s_nop 1
    v_add_f32 v241, v241, v244
    v_mov_b32 v244, v242
    s_nop 1
    v_permlane32_swap_b32 v244, v242
    s_nop 1
    v_add_f32 v242, v242, v244
    v_mov_b32 v244, v242
    s_nop 1
    v_permlane16_swap_b32 v244, v242
    s_nop 1
    v_add_f32 v242, v242, v244
    v_mov_b32 v244, v243
    s_nop 1
    v_permlane32_swap_b32 v244, v243
    s_nop 1
    v_add_f32 v243, v243, v244
    v_mov_b32 v244, v243
    s_nop 1
    v_permlane16_swap_b32 v244, v243
    s_nop 1
    v_add_f32 v243, v243, v244
    v_mov_b32 v232, v240
    v_mov_b32 v233, v241
    v_mov_b32 v234, v242
    v_mov_b32 v235, v243
    v_mov_b32 v240, v232
    v_mov_b32 v244, v233
    v_mov_b32 v58, v234
    v_mov_b32 v59, v235
    v_mov_b32 v208, 0
    v_mov_b32 v209, 0
    v_mov_b32 v210, 0
    v_mov_b32 v211, 0
    v_mov_b32 v212, 0
    v_mov_b32 v213, 0
    v_mov_b32 v214, 0
    v_mov_b32 v215, 0
    v_mov_b32 v216, 0
    v_mov_b32 v217, 0
    v_mov_b32 v218, 0
    v_mov_b32 v219, 0
    v_mov_b32 v220, 0
    v_mov_b32 v221, 0
    v_mov_b32 v222, 0
    v_mov_b32 v223, 0
    v_mov_b32 v96, 0
    v_mov_b32 v97, 0
    v_mov_b32 v98, 0
    v_mov_b32 v99, 0
    v_mov_b32 v100, 0
    v_mov_b32 v101, 0
    v_mov_b32 v102, 0
    v_mov_b32 v103, 0
    v_mov_b32 v104, 0
    v_mov_b32 v105, 0
    v_mov_b32 v106, 0
    v_mov_b32 v107, 0
    v_mov_b32 v108, 0
    v_mov_b32 v109, 0
    v_mov_b32 v110, 0
    v_mov_b32 v111, 0
    v_mov_b32 v112, 0
    v_mov_b32 v113, 0
    v_mov_b32 v114, 0
    v_mov_b32 v115, 0
    v_mov_b32 v116, 0
    v_mov_b32 v117, 0
    v_mov_b32 v118, 0
    v_mov_b32 v119, 0
    v_mov_b32 v120, 0
    v_mov_b32 v121, 0
    v_mov_b32 v122, 0
    v_mov_b32 v123, 0
    v_mov_b32 v124, 0
    v_mov_b32 v125, 0
    v_mov_b32 v126, 0
    v_mov_b32 v127, 0
    s_branch L_k1_norm

.section .rodata,"a"
.p2align 6
.amdhsa_kernel ln_kernel
  .amdhsa_next_free_vgpr 208
  .amdhsa_next_free_sgpr 72
  .amdhsa_accum_offset 208
  .amdhsa_group_segment_fixed_size 0
  .amdhsa_kernarg_size 96
  .amdhsa_user_sgpr_count 2
  .amdhsa_user_sgpr_kernarg_segment_ptr 1
  .amdhsa_system_sgpr_workgroup_id_x 1
  .amdhsa_float_denorm_mode_32 3
.end_amdhsa_kernel

.section .rodata,"a"
.p2align 6
.amdhsa_kernel attn_kernel
  .amdhsa_next_free_vgpr 512
  .amdhsa_next_free_sgpr 102
  .amdhsa_accum_offset 256
  .amdhsa_group_segment_fixed_size 0
  .amdhsa_kernarg_size 96
  .amdhsa_user_sgpr_count 2
  .amdhsa_user_sgpr_kernarg_segment_ptr 1
  .amdhsa_system_sgpr_workgroup_id_x 1
  .amdhsa_float_denorm_mode_32 3
.end_amdhsa_kernel
```
